```python
import torch

def _softmax(x, axis=-1):
    return torch.softmax(x, dim=axis)
def _gelu(x):
    return torch.nn.functional.gelu(x, approximate="tanh")
def _silu(x):
    return torch.nn.functional.silu(x)
def _sigmoid(x):
    return torch.sigmoid(x)
def _layernorm(x, axis=-1, eps=1e-5):
    m = x.mean(dim=axis, keepdim=True)
    v = x.var(dim=axis, keepdim=True, unbiased=False)
    return (x - m) / torch.sqrt(v + eps)
def _scatter_add(tgt, idx, src, axis=0):
    return tgt.clone().index_add_(axis, idx, src)
def _segment_sum(src, seg, n):
    out = torch.zeros((n,) + src.shape[1:], dtype=src.dtype)
    return out.index_add_(0, seg, src)
def _pad(x, pw):
    flat = tuple(v for pair in reversed(pw) for v in pair)
    return torch.nn.functional.pad(x, flat)

kernel_name = 'standalone__modern_conv_block_convnext_v2__vision'

def setup_inputs():

    _w = (lambda a: (lambda t: t.to(torch.bfloat16) if t.is_floating_point() else t)(torch.as_tensor(a)))
    H = W = 224
    C = 192
    K = 3
    return {
        "x": _w((lambda *s: torch.randn(*s, dtype=torch.bfloat16) * 0.05)(1, H, W, C)),
        "dw": _w((lambda *s: torch.randn(*s, dtype=torch.bfloat16) * 0.05)(K, K, C)),
        "w1": _w((lambda *s: torch.randn(*s, dtype=torch.bfloat16) * 0.05)(C, 4 * C)),
        "w2": _w((lambda *s: torch.randn(*s, dtype=torch.bfloat16) * 0.05)(4 * C, C)),
        "grn_gamma": _w((lambda *s: torch.randn(*s, dtype=torch.bfloat16) * 0.05)(4 * C)),
        "grn_beta": _w((lambda *s: torch.randn(*s, dtype=torch.bfloat16) * 0.05)(4 * C)),
    }

def reference(x, dw, w1, w2, grn_gamma, grn_beta):
    B, H, W, C = x.shape
    K = dw.shape[0]
    pad = K // 2
    xp = _pad(x, ((0,0),(pad,pad),(pad,pad),(0,0)))
    out = torch.zeros_like(x)
    for i in range(K):
        for j in range(K):
            out = out + xp[:, i:i+H, j:j+W, :] * dw[i, j][None, None, None, :]
    h = _layernorm(out, axis=-1)
    h = torch.einsum('bhwc,ce->bhwe', h, w1)
    h = _gelu(h)
    gx = torch.sqrt((h * h).sum(axis=(1, 2), keepdims=True) + 1e-6)
    nx = gx / (gx.mean(axis=-1, keepdims=True) + 1e-6)
    h = grn_gamma * (h * nx) + grn_beta + h
    h = torch.einsum('bhwe,ec->bhwc', h, w2)
    return x + h
```

```asm
; @launch grid=(256,1,1) block=(256,1,1) lds=163840
.amdgcn_target "amdgcn-amd-amdhsa--gfx950"
.text
.globl standalone__modern_conv_block_convnext_v2__vision_kernel
.p2align 12
.p2align 8
.type standalone__modern_conv_block_convnext_v2__vision_kernel,@function
standalone__modern_conv_block_convnext_v2__vision_kernel:
s_load_dwordx16 s[4:19], s[0:1], 0
s_getpc_b64 s[88:89]
L_pf:
s_nop 0
s_and_b32 s89, s89, 0xffff
s_mov_b32 s90, L_end-L_pf
s_mov_b32 s91, 0x00020000
s_bfe_u32 s85, s2, 0x20003
s_lshl_b32 s85, s85, 15
v_lshlrev_b32 v9, 7, v0
buffer_load_dword v255, v9, s[88:91], s85 offen
s_load_dwordx2 s[20:21], s[0:1], 64
s_cmp_ge_u32 s2, 256
s_cbranch_scc1 L_exit
v_lshrrev_b32 v1, 6, v0
v_and_b32 v0, 63, v0
v_readfirstlane_b32 s3, v1
v_lshlrev_b32 v1, 4, v0
s_cmp_lt_u32 s2, 32
s_cbranch_scc1 L_help
s_sub_u32 s50, s2, 32
s_lshr_b32 s50, s50, 3
s_and_b32 s51, s2, 7
s_lshl_b32 s51, s51, 1
s_cmp_ge_u32 s50, 14
s_cselect_b32 s52, 1, 0
s_cselect_b32 s53, 14, 0
s_add_u32 s51, s51, s52
s_sub_u32 s50, s50, s53
s_mul_i32 s48, s51, 14
s_lshl_b32 s49, s50, 4
s_lshr_b32 s52, s3, 1
s_and_b32 s53, s3, 1
s_mul_i32 s82, s52, 7168
s_mul_i32 s54, s53, 3072
s_add_u32 s82, s82, s54
s_add_u32 s83, s48, s52
s_sub_u32 s83, s83, 1
s_mul_i32 s84, s83, 86016
s_cmp_lt_u32 s83, 224
s_cselect_b32 s86, s84, 0x40000000
s_add_u32 s87, s84, 1204224
s_cmp_lt_i32 s83, 210
s_cselect_b32 s87, s87, 0x40000000
s_mul_i32 s55, s53, 192
s_mul_i32 s54, s49, 384
v_add_u32 v3, s55, v0
v_mul_u32_u24 v4, 1366, v3
v_bfe_u32 v5, v4, 16, 3
v_xor_b32_e64 v5, v5, v3
v_lshl_add_u32 v204, v5, 4, s54
v_add_u32 v4, 87424, v4
v_bfe_u32 v5, v4, 16, 3
v_xor_b32_e64 v5, v5, v3
v_lshl_add_u32 v205, v5, 4, s54
v_add_u32 v4, 87424, v4
v_bfe_u32 v5, v4, 16, 3
v_xor_b32_e64 v5, v5, v3
v_lshl_add_u32 v206, v5, 4, s54
v_add_u32 v4, 87424, v4
v_bfe_u32 v5, v4, 16, 3
v_xor_b32_e64 v5, v5, v3
v_lshl_add_u32 v207, v5, 4, s54
s_lshl_b32 s55, s53, 4
s_add_u32 s55, s55, s50
s_mov_b32 s89, 0
s_cmp_eq_u32 s55, 0
s_cselect_b32 s88, 0xffffff, 0
s_cmp_eq_u32 s55, 29
s_cselect_b64 s[80:81], 0xffffff, -1
v_mov_b32 v44, 0x40000000
v_cndmask_b32_e64 v204, v204, v44, s[88:89]
v_cndmask_b32_e64 v207, v44, v207, s[80:81]
v_min_u32 v6, 53, v0
v_mul_u32_u24 v8, 43, v6
v_lshrrev_b32_e64 v8, 8, v8
s_mul_i32 s52, s3, 96
v_lshl_add_u32 v7, v6, 4, s52
v_mul_u32_u24 v9, 288, v8
v_add_u32 v7, v7, v9
v_mov_b32 v40, 0
v_mov_b32 v41, 0
v_mov_b32 v42, 0
v_mov_b32 v43, 0
s_lshl_b32 s53, s3, 13
s_add_u32 s53, s53, 114688
v_add_u32_e64 v2, s53, v1
s_waitcnt lgkmcnt(0)
s_mov_b32 s40, s6
s_and_b32 s41, s7, 0xffff
s_mov_b32 s42, 3456
s_mov_b32 s43, 0x00020000
buffer_load_dwordx4 v[48:51], v7, s[40:43], 0 offen
s_sub_u32 s24, s4, 384
s_subb_u32 s25, s5, 0
s_nop 0
s_and_b32 s25, s25, 0xffff
s_mov_b32 s26, 19267968
s_mov_b32 s27, 0x00020000
s_add_u32 m0, s82, 0
s_nop 0
buffer_load_dwordx4 v204, s[24:27], s86 offen lds
buffer_load_dwordx4 v205, s[24:27], s86 offen offset:1024 lds
buffer_load_dwordx4 v206, s[24:27], s86 offen offset:2048 lds
buffer_load_dwordx4 v207, s[24:27], s86 offen offset:3072 lds
s_add_u32 m0, s82, 14336
s_add_u32 s84, s84, 172032
buffer_load_dwordx4 v204, s[24:27], s84 offen lds
buffer_load_dwordx4 v205, s[24:27], s84 offen offset:1024 lds
buffer_load_dwordx4 v206, s[24:27], s84 offen offset:2048 lds
buffer_load_dwordx4 v207, s[24:27], s84 offen offset:3072 lds
ds_write_b128 v2, v[40:43] offset:0
ds_write_b128 v2, v[40:43] offset:1024
ds_write_b128 v2, v[40:43] offset:2048
ds_write_b128 v2, v[40:43] offset:3072
ds_write_b128 v2, v[40:43] offset:4096
ds_write_b128 v2, v[40:43] offset:5120
ds_write_b128 v2, v[40:43] offset:6144
ds_write_b128 v2, v[40:43] offset:7168
s_mov_b32 s28, s16
s_nop 0
s_and_b32 s29, s17, 0xffff
s_mov_b32 s30, 19267584
s_mov_b32 s31, 0x00020000
s_mov_b32 s32, s20
s_nop 0
s_and_b32 s33, s21, 0xffff
s_mov_b32 s34, 1048576
s_mov_b32 s35, 0x00020000
s_mov_b32 s36, s18
s_nop 0
s_and_b32 s37, s19, 0xffff
s_mov_b32 s38, 256
s_mov_b32 s39, 0x00020000
s_mov_b32 s44, s12
s_nop 0
s_and_b32 s45, s13, 0xffff
s_mov_b32 s46, 1536
s_mov_b32 s47, 0x00020000
s_add_u32 s53, s53, 32
v_mul_u32_u24 v9, 6, v8
v_sub_u32_e64 v6, v6, v9
v_mul_u32_u24 v9, 86, v8
v_lshrrev_b32_e64 v9, 8, v9
v_mul_u32_u24 v8, 2592, v8
v_mul_u32_u24 v9, 7488, v9
v_sub_u32 v8, v8, v9
v_lshrrev_b32 v9, 1, v6
v_mul_u32_u24 v9, 608, v9
v_lshl_add_u32 v9, v6, 7, v9
v_add3_u32 v8, v8, v9, s53
v_and_b32 v10, 15, v0
v_lshrrev_b32 v11, 4, v0
v_and_b32 v3, 1, v11
v_lshrrev_b32 v4, 1, v11
v_lshl_add_u32 v9, v10, 4, s53
s_sub_u32 s54, s53, 16
v_mov_b32 v2, s54
v_mul_u32_u24 v5, 272, v4
v_add_u32 v2, v2, v5
v_lshrrev_b32 v5, 3, v10
v_cmp_eq_u32_e64 vcc, v5, v4
v_mul_u32_u24 v5, 2592, v3
v_add_u32 v5, v5, v9
v_cndmask_b32 v22, v2, v5, vcc
v_add_u32 v9, 5184, v9
v_mul_u32_u24 v5, 288, v3
v_add_u32 v5, v5, v9
v_cndmask_b32 v23, v2, v5, vcc
v_cmp_eq_u32 s[88:89], 0, v3
s_nop 0
s_and_b64 s[80:81], vcc, s[88:89]
s_andn2_b64 s[88:89], vcc, s[88:89]
s_nop 0
v_add_u32 v5, 576, v9
v_cndmask_b32_e64 v24, v2, v5, s[80:81]
v_cndmask_b32_e64 v25, v2, v9, s[88:89]
s_mul_i32 s52, s3, 6
v_add_u32 v5, s52, v4
v_add_u32_e64 v2, v3, v10
v_mul_u32_u24 v9, 384, v2
v_bfe_u32 v2, v2, 1, 3
v_add_u32 v16, 0, v5
v_xor_b32 v16, v16, v2
v_lshl_add_u32 v16, v16, 4, v9
v_add_u32 v17, 2, v5
v_xor_b32 v17, v17, v2
v_lshl_add_u32 v17, v17, 4, v9
v_add_u32 v18, 4, v5
v_xor_b32 v18, v18, v2
v_lshl_add_u32 v18, v18, 4, v9
v_add_u32_e64 v2, 2, v10
v_mul_u32_u24 v9, 384, v2
v_mul_u32_u24 v7, 7168, v3
v_add_u32_e64 v9, v9, v7
v_bfe_u32 v2, v2, 1, 3
v_add_u32 v19, 0, v5
v_xor_b32 v19, v19, v2
v_lshl_add_u32 v19, v19, 4, v9
v_add_u32 v20, 2, v5
v_xor_b32 v20, v20, v2
v_lshl_add_u32 v20, v20, 4, v9
v_add_u32 v21, 4, v5
v_xor_b32 v21, v21, v2
v_lshl_add_u32 v21, v21, 4, v9
s_waitcnt vmcnt(8)
s_nop 0
ds_write_b16 v8, v48 offset:0
ds_write_b16_d16_hi v8, v48 offset:18
ds_write_b16 v8, v49 offset:36
ds_write_b16_d16_hi v8, v49 offset:54
ds_write_b16 v8, v50 offset:72
ds_write_b16_d16_hi v8, v50 offset:90
ds_write_b16 v8, v51 offset:108
ds_write_b16_d16_hi v8, v51 offset:126
ds_read_b128 a[48:51], v22 offset:0
v_lshlrev_b32_e64 v30, 9, v4
ds_read_b128 a[52:55], v22 offset:864
v_lshl_add_u32 v30, v10, 4, v30
ds_read_b128 a[56:59], v22 offset:1728
v_lshl_add_u32 v30, v3, 3, v30
ds_read_b128 a[72:75], v25 offset:0
s_mul_i32 s52, s3, 3072
ds_read_b128 a[76:79], v25 offset:864
v_add_u32_e64 v30, s52, v30
ds_read_b128 a[80:83], v25 offset:1728
v_add_u32 v29, 114688, v30
ds_read_b128 a[60:63], v23 offset:0
s_lshl_b32 s52, s3, 2
s_nop 0
ds_read_b128 a[64:67], v23 offset:864
s_add_u32 s52, s52, 114688
ds_read_b128 a[68:71], v23 offset:1728
v_add_u32_e64 v31, s52, v1
ds_read_b128 a[0:3], v22 offset:288
v_mov_b32 v13, 0x383ef424
ds_read_b128 a[4:7], v22 offset:1152
s_mov_b32 s76, 0x3cc23f85
ds_read_b128 a[8:11], v22 offset:2016
s_mov_b32 s77, 0xbc361376
s_mov_b32 s78, 0x3eeff558
s_mov_b32 s79, 0xffff0000
s_add_u32 m0, s82, 28672
s_add_u32 s84, s84, 172032
buffer_load_dwordx4 v204, s[24:27], s84 offen lds
buffer_load_dwordx4 v205, s[24:27], s84 offen offset:1024 lds
buffer_load_dwordx4 v206, s[24:27], s84 offen offset:2048 lds
buffer_load_dwordx4 v207, s[24:27], s84 offen offset:3072 lds
s_waitcnt vmcnt(8)
s_barrier
ds_read_b128 v[32:35], v16 offset:0
ds_read_b128 v[36:39], v17 offset:0
ds_read_b128 v[40:43], v18 offset:0
ds_read_b128 v[56:59], v19 offset:0
ds_read_b128 v[60:63], v20 offset:0
ds_read_b128 v[64:67], v21 offset:0
ds_read_b128 v[44:47], v16 offset:7168
ds_read_b128 v[48:51], v17 offset:7168
ds_read_b128 v[52:55], v18 offset:7168
ds_read_b128 a[12:15], v22 offset:576
ds_read_b128 a[16:19], v22 offset:1440
ds_read_b128 a[20:23], v22 offset:2304
ds_read_b128 a[24:27], v24 offset:0
ds_read_b128 a[28:31], v24 offset:864
ds_read_b128 a[32:35], v24 offset:1728
ds_read_b128 a[36:39], v23 offset:288
ds_read_b128 a[40:43], v23 offset:1152
ds_read_b128 a[44:47], v23 offset:2016
v_add_u32 v2, 4096, v1
v_add_u32 v3, 8192, v1
v_add_u32 v4, 114688, v1
s_mul_i32 s52, s3, 14336
s_add_u32 s52, s52, 36864
v_lshl_add_u32 v5, v10, 4, s52
v_and_b32_e64 v6, 1, v11
v_lshl_add_u32 v5, v6, 10, v5
v_lshrrev_b32_e64 v6, 1, v11
v_lshl_add_u32 v5, v6, 8, v5
v_add_u32 v6, 57344, v5
s_mul_i32 s52, s3, 73728
s_add_u32 s53, s52, 12288
s_add_u32 s54, s52, 24576
s_add_u32 s55, s52, 36864
s_add_u32 s56, s52, 49152
s_add_u32 s57, s52, 61440
s_mov_b32 s68, 0x409d30fc
s_mov_b32 s69, 0x409d30fc
s_mov_b32 s70, 1.0
s_mov_b32 s71, 1.0
s_mov_b32 s72, 0xaaaaaaaa
s_mov_b32 s73, 0xaaaaaaaa
v_and_b32 v8, 24, v0
s_waitcnt vmcnt(4)
s_barrier
s_waitcnt lgkmcnt(15)
v_mfma_f32_16x16x32_bf16 v[104:107], a[48:51], v[32:35], 0
ds_read_b128 v[68:71], v16 offset:14336
v_lshrrev_b32_e64 v9, 3, v0
v_mfma_f32_16x16x32_bf16 v[108:111], a[52:55], v[36:39], 0
ds_read_b128 v[72:75], v17 offset:14336
ds_read_b128 v[76:79], v18 offset:14336
v_mfma_f32_16x16x32_bf16 v[112:115], a[56:59], v[40:43], 0
ds_read_b128 v[92:95], v19 offset:14336
v_and_b32 v9, 4, v9
s_waitcnt lgkmcnt(15)
v_mfma_f32_16x16x32_bf16 v[116:119], a[72:75], v[56:59], 0
ds_read_b128 v[96:99], v20 offset:14336
ds_read_b128 v[100:103], v21 offset:14336
v_mfma_f32_16x16x32_bf16 v[120:123], a[76:79], v[60:63], 0
ds_read_b128 v[80:83], v16 offset:21504
v_or_b32_e64 v8, v8, v9
v_mfma_f32_16x16x32_bf16 v[124:127], a[80:83], v[64:67], 0
ds_read_b128 v[84:87], v17 offset:21504
ds_read_b128 v[88:91], v18 offset:21504
v_mfma_f32_16x16x32_bf16 v[104:107], a[60:63], v[56:59], v[104:107]
s_add_u32 m0, s82, 43008
s_add_u32 s84, s84, 172032
buffer_load_dwordx4 v204, s[24:27], s84 offen lds
v_mfma_f32_16x16x32_bf16 v[108:111], a[64:67], v[60:63], v[108:111]
v_mfma_f32_16x16x32_bf16 v[112:115], a[68:71], v[64:67], v[112:115]
v_lshrrev_b32 v9, 1, v0
v_and_b32 v9, 2, v9
v_mfma_f32_16x16x32_bf16 v[116:119], a[48:51], v[44:47], v[116:119]
buffer_load_dwordx4 v205, s[24:27], s84 offen offset:1024 lds
s_waitcnt lgkmcnt(15)
s_nop 0
v_mfma_f32_16x16x32_bf16 v[120:123], a[52:55], v[48:51], v[120:123]
buffer_load_dwordx4 v206, s[24:27], s84 offen offset:2048 lds
v_mfma_f32_16x16x32_bf16 v[124:127], a[56:59], v[52:55], v[124:127]
buffer_load_dwordx4 v207, s[24:27], s84 offen offset:3072 lds
v_or_b32_e64 v8, v8, v9
v_mfma_f32_16x16x32_bf16 v[104:107], a[0:3], v[44:47], v[104:107]
v_and_b32_e64 v9, 1, v0
v_mfma_f32_16x16x32_bf16 v[108:111], a[4:7], v[48:51], v[108:111]
v_lshlrev_b32 v15, 3, v8
v_or_b32 v8, v8, v9
v_mfma_f32_16x16x32_bf16 v[112:115], a[8:11], v[52:55], v[112:115]
v_lshlrev_b32 v8, 2, v8
v_and_b32 v10, 2, v0
v_lshlrev_b32 v10, 29, v10
v_or_b32 v7, v8, v10
v_and_b32 v9, 3, v0
v_lshlrev_b32 v9, 3, v9
s_mov_b32 s50, 0x80000c08
v_lshrrev_b32_e64 v9, v9, s50
v_bfe_i32 v9, v9, 0, 8
v_add_u32 v15, 512, v15
v_or_b32_e64 v15, v15, v9
s_and_b32 s66, s2, 3
s_lshl_b32 s66, s66, 2
s_add_u32 s66, s66, s3
s_lshl_b32 s66, s66, 10
s_add_u32 s66, s66, 590848
s_mov_b32 s92, 0xcccccccc
s_mov_b32 s93, 0xcccccccc
s_mov_b32 s95, 623616
s_cmp_eq_u32 s3, 0
s_cselect_b32 s95, s95, 0x40000000
s_and_b32 s50, s3, 1
s_lshr_b32 s51, s3, 1
s_mul_i32 s74, s51, 3
s_lshl_b32 s75, s50, 1
s_add_u32 s75, s75, s74
s_add_u32 s74, s74, 1
s_mul_i32 s62, s48, 224
s_add_u32 s62, s62, s49
s_mul_i32 s62, s62, 384
s_lshl_b32 s63, s75, 6
s_add_u32 s63, s63, s62
s_waitcnt vmcnt(4) lgkmcnt(0)
s_barrier
v_mfma_f32_16x16x32_bf16 v[104:107], a[12:15], v[68:71], v[104:107]
ds_read_b128 v[32:35], v16 offset:28672
s_lshl_b32 s64, s74, 6
v_mfma_f32_16x16x32_bf16 v[108:111], a[16:19], v[72:75], v[108:111]
ds_read_b128 v[36:39], v17 offset:28672
ds_read_b128 v[40:43], v18 offset:28672
v_mfma_f32_16x16x32_bf16 v[112:115], a[20:23], v[76:79], v[112:115]
ds_read_b128 v[56:59], v19 offset:28672
ds_read_b128 v[60:63], v20 offset:28672
v_mfma_f32_16x16x32_bf16 v[104:107], a[24:27], v[92:95], v[104:107]
ds_read_b128 v[64:67], v21 offset:28672
ds_read_b128 v[44:47], v16 offset:35840
v_mfma_f32_16x16x32_bf16 v[108:111], a[28:31], v[96:99], v[108:111]
ds_read_b128 v[48:51], v17 offset:35840
ds_read_b128 v[52:55], v18 offset:35840
v_mfma_f32_16x16x32_bf16 v[112:115], a[32:35], v[100:103], v[112:115]
s_add_u32 s64, s64, s62
s_mul_i32 s51, s50, 602112
v_mfma_f32_16x16x32_bf16 v[116:119], a[0:3], v[68:71], v[116:119]
s_add_u32 s4, s63, s51
s_sub_u32 s11, s63, s51
v_mfma_f32_16x16x32_bf16 v[120:123], a[4:7], v[72:75], v[120:123]
s_add_u32 s11, s11, 602112
s_add_u32 s18, s64, s51
v_mfma_f32_16x16x32_bf16 v[124:127], a[8:11], v[76:79], v[124:127]
s_add_u32 s5, s4, 86016
s_add_u32 s12, s11, 86016
v_mfma_f32_16x16x32_bf16 v[116:119], a[36:39], v[92:95], v[116:119]
s_add_u32 s19, s18, 86016
s_add_u32 s6, s5, 86016
v_mfma_f32_16x16x32_bf16 v[120:123], a[40:43], v[96:99], v[120:123]
s_add_u32 s13, s12, 86016
s_add_u32 s20, s19, 86016
v_mfma_f32_16x16x32_bf16 v[124:127], a[44:47], v[100:103], v[124:127]
s_add_u32 s7, s6, 86016
s_add_u32 s14, s13, 86016
v_mfma_f32_16x16x32_bf16 v[116:119], a[12:15], v[80:83], v[116:119]
s_add_u32 s21, s20, 86016
s_add_u32 s8, s7, 86016
v_mfma_f32_16x16x32_bf16 v[120:123], a[16:19], v[84:87], v[120:123]
s_add_u32 s15, s14, 86016
s_add_u32 s58, s21, 86016
v_mfma_f32_16x16x32_bf16 v[124:127], a[20:23], v[88:91], v[124:127]
s_add_u32 s9, s8, 86016
s_add_u32 s16, s15, 86016
s_add_u32 s59, s58, 86016
s_add_u32 s10, s9, 86016
v_pk_mul_f32 v[200:201], v[104:105], v[104:105]
v_pk_fma_f32 v[200:201], v[106:107], v[106:107], v[200:201]
v_pk_add_f32 v[196:197], v[104:105], v[106:107]
v_pk_fma_f32 v[200:201], v[108:109], v[108:109], v[200:201]
v_pk_add_f32 v[196:197], v[196:197], v[108:109]
v_pk_fma_f32 v[200:201], v[110:111], v[110:111], v[200:201]
v_pk_add_f32 v[196:197], v[196:197], v[110:111]
v_pk_fma_f32 v[200:201], v[112:113], v[112:113], v[200:201]
v_pk_add_f32 v[196:197], v[196:197], v[112:113]
v_pk_fma_f32 v[200:201], v[114:115], v[114:115], v[200:201]
v_pk_add_f32 v[196:197], v[196:197], v[114:115]
v_pk_mul_f32 v[202:203], v[116:117], v[116:117]
v_pk_fma_f32 v[202:203], v[118:119], v[118:119], v[202:203]
v_pk_add_f32 v[198:199], v[116:117], v[118:119]
v_pk_fma_f32 v[202:203], v[120:121], v[120:121], v[202:203]
v_pk_add_f32 v[198:199], v[198:199], v[120:121]
v_pk_fma_f32 v[202:203], v[122:123], v[122:123], v[202:203]
v_pk_add_f32 v[198:199], v[198:199], v[122:123]
v_pk_fma_f32 v[202:203], v[124:125], v[124:125], v[202:203]
v_pk_add_f32 v[198:199], v[198:199], v[124:125]
v_pk_fma_f32 v[202:203], v[126:127], v[126:127], v[202:203]
v_pk_add_f32 v[198:199], v[198:199], v[126:127]
v_mfma_f32_16x16x32_bf16 v[128:131], a[48:51], v[68:71], 0
v_add_f32_e64 v200, v200, v201
s_add_u32 s17, s16, 86016
v_mfma_f32_16x16x32_bf16 v[132:135], a[52:55], v[72:75], 0
s_add_u32 m0, s82, 57344
s_add_u32 s84, s84, 172032
buffer_load_dwordx4 v204, s[24:27], s84 offen lds
v_mfma_f32_16x16x32_bf16 v[136:139], a[56:59], v[76:79], 0
v_mfma_f32_16x16x32_bf16 v[140:143], a[72:75], v[92:95], 0
v_add_f32 v202, v202, v203
v_add_f32 v196, v196, v197
v_mfma_f32_16x16x32_bf16 v[144:147], a[76:79], v[96:99], 0
v_add_f32_e64 v198, v198, v199
s_add_u32 s60, s59, 86016
v_mfma_f32_16x16x32_bf16 v[148:151], a[80:83], v[100:103], 0
v_permlane32_swap_b32 v200, v202
s_lshl_b32 s63, s75, 7
v_mfma_f32_16x16x32_bf16 v[128:131], a[60:63], v[92:95], v[128:131]
v_permlane32_swap_b32 v196, v198
v_add_f32 v200, v200, v202
v_mfma_f32_16x16x32_bf16 v[132:135], a[64:67], v[96:99], v[132:135]
v_add_f32_e64 v196, v196, v198
s_add_u32 s63, s63, 589824
v_mfma_f32_16x16x32_bf16 v[136:139], a[68:71], v[100:103], v[136:139]
v_permlane16_swap_b32 v196, v200
v_add_f32 v196, v196, v200
v_mfma_f32_16x16x32_bf16 v[140:143], a[48:51], v[80:83], v[140:143]
ds_write_b32 v31, v196 offset:36864
s_lshl_b32 s64, s74, 7
s_nop 0
v_mfma_f32_16x16x32_bf16 v[144:147], a[52:55], v[84:87], v[144:147]
s_add_u32 s64, s64, 589824
s_mul_i32 s65, s50, 7168
v_mfma_f32_16x16x32_bf16 v[148:151], a[56:59], v[88:91], v[148:151]
s_sub_u32 s94, 36864, s65
s_add_u32 s65, s65, 36864
v_mfma_f32_16x16x32_bf16 v[128:131], a[0:3], v[80:83], v[128:131]
buffer_load_dwordx4 v205, s[24:27], s84 offen offset:1024 lds
v_mfma_f32_16x16x32_bf16 v[132:135], a[4:7], v[84:87], v[132:135]
s_mul_i32 s62, s3, 9216
v_lshrrev_b32_e64 v11, 2, v0
v_mfma_f32_16x16x32_bf16 v[136:139], a[8:11], v[88:91], v[136:139]
v_mul_u32_u24 v11, 384, v11
v_lshrrev_b32_e64 v10, 4, v0
buffer_load_dwordx4 v206, s[24:27], s84 offen offset:2048 lds
buffer_load_dwordx4 v207, s[24:27], s84 offen offset:3072 lds
v_xor_b32 v10, v10, v0
v_and_b32 v10, 3, v10
v_lshl_add_u32 v11, v10, 4, v11
s_mul_i32 s51, s75, 49152
v_add_u32_e64 v9, s51, v1
s_mul_i32 s51, s74, 49152
v_add_u32 v10, s51, v1
v_lshrrev_b32 v8, 4, v0
v_lshlrev_b32_e64 v8, 5, v8
v_add_u32 v8, 151552, v8
s_waitcnt vmcnt(4) lgkmcnt(0)
s_barrier
v_mfma_f32_16x16x32_bf16 v[128:131], a[12:15], v[32:35], v[128:131]
ds_read_b128 v[176:179], v4 offset:36864
ds_read_b128 v[68:71], v16 offset:43008
v_mfma_f32_16x16x32_bf16 v[132:135], a[16:19], v[36:39], v[132:135]
ds_read_b128 v[72:75], v17 offset:43008
ds_read_b128 v[76:79], v18 offset:43008
v_mfma_f32_16x16x32_bf16 v[136:139], a[20:23], v[40:43], v[136:139]
ds_read_b128 v[92:95], v19 offset:43008
ds_read_b128 v[96:99], v20 offset:43008
v_mfma_f32_16x16x32_bf16 v[128:131], a[24:27], v[56:59], v[128:131]
ds_read_b128 v[100:103], v21 offset:43008
ds_read_b128 v[80:83], v16 offset:50176
v_mfma_f32_16x16x32_bf16 v[132:135], a[28:31], v[60:63], v[132:135]
ds_read_b128 v[84:87], v17 offset:50176
ds_read_b128 v[88:91], v18 offset:50176
v_mfma_f32_16x16x32_bf16 v[136:139], a[32:35], v[64:67], v[136:139]
v_mfma_f32_16x16x32_bf16 v[140:143], a[0:3], v[32:35], v[140:143]
s_waitcnt lgkmcnt(9)
v_add_f32 v176, v176, v177
v_mfma_f32_16x16x32_bf16 v[144:147], a[4:7], v[36:39], v[144:147]
v_add_f32 v178, v178, v179
v_add_f32 v177, v176, v178
v_mfma_f32_16x16x32_bf16 v[148:151], a[8:11], v[40:43], v[148:151]
v_add_f32_e64 v176, v176, v178
v_mfma_f32_16x16x32_bf16 v[140:143], a[36:39], v[56:59], v[140:143]
s_nop 0
v_permlane16_swap_b32 v176, v177
v_mul_f32_e64 v176, s77, v176
v_mfma_f32_16x16x32_bf16 v[144:147], a[40:43], v[60:63], v[144:147]
v_fma_f32 v177, v177, s76, v13
v_fma_f32 v177, -v176, v176, v177
v_mfma_f32_16x16x32_bf16 v[148:151], a[44:47], v[64:67], v[148:151]
v_max_f32 v177, v177, v13
v_rsq_f32 v180, v177
v_mfma_f32_16x16x32_bf16 v[140:143], a[12:15], v[44:47], v[140:143]
v_mul_f32_e64 v176, s78, v176
v_mfma_f32_16x16x32_bf16 v[144:147], a[16:19], v[48:51], v[144:147]
v_mov_b32 v182, v180
v_mul_f32 v181, v176, v180
v_mfma_f32_16x16x32_bf16 v[148:151], a[20:23], v[52:55], v[148:151]
v_mul_f32 v183, v176, v180
v_permlane32_swap_b32 v180, v182
s_nop 0
v_permlane32_swap_b32 v181, v183
v_pk_fma_f32 v[104:105], v[104:105], v[180:181], v[180:181] op_sel:[0,0,1] op_sel_hi:[1,0,1]
v_pk_fma_f32 v[106:107], v[106:107], v[180:181], v[180:181] op_sel:[0,0,1] op_sel_hi:[1,0,1]
v_pk_fma_f32 v[108:109], v[108:109], v[180:181], v[180:181] op_sel:[0,0,1] op_sel_hi:[1,0,1]
v_pk_fma_f32 v[110:111], v[110:111], v[180:181], v[180:181] op_sel:[0,0,1] op_sel_hi:[1,0,1]
v_pk_fma_f32 v[112:113], v[112:113], v[180:181], v[180:181] op_sel:[0,0,1] op_sel_hi:[1,0,1]
v_pk_fma_f32 v[114:115], v[114:115], v[180:181], v[180:181] op_sel:[0,0,1] op_sel_hi:[1,0,1]
v_pk_fma_f32 v[116:117], v[116:117], v[182:183], v[182:183] op_sel:[0,0,1] op_sel_hi:[1,0,1]
v_pk_fma_f32 v[118:119], v[118:119], v[182:183], v[182:183] op_sel:[0,0,1] op_sel_hi:[1,0,1]
v_pk_fma_f32 v[120:121], v[120:121], v[182:183], v[182:183] op_sel:[0,0,1] op_sel_hi:[1,0,1]
v_pk_fma_f32 v[122:123], v[122:123], v[182:183], v[182:183] op_sel:[0,0,1] op_sel_hi:[1,0,1]
v_pk_fma_f32 v[124:125], v[124:125], v[182:183], v[182:183] op_sel:[0,0,1] op_sel_hi:[1,0,1]
v_pk_fma_f32 v[126:127], v[126:127], v[182:183], v[182:183] op_sel:[0,0,1] op_sel_hi:[1,0,1]
v_pk_mul_f32 v[200:201], v[128:129], v[128:129]
v_pk_fma_f32 v[200:201], v[130:131], v[130:131], v[200:201]
v_pk_add_f32 v[196:197], v[128:129], v[130:131]
v_pk_fma_f32 v[200:201], v[132:133], v[132:133], v[200:201]
v_pk_add_f32 v[196:197], v[196:197], v[132:133]
v_pk_fma_f32 v[200:201], v[134:135], v[134:135], v[200:201]
v_pk_add_f32 v[196:197], v[196:197], v[134:135]
v_pk_fma_f32 v[200:201], v[136:137], v[136:137], v[200:201]
v_pk_add_f32 v[196:197], v[196:197], v[136:137]
v_pk_fma_f32 v[200:201], v[138:139], v[138:139], v[200:201]
v_pk_add_f32 v[196:197], v[196:197], v[138:139]
v_pk_mul_f32 v[202:203], v[140:141], v[140:141]
v_pk_fma_f32 v[202:203], v[142:143], v[142:143], v[202:203]
v_pk_add_f32 v[198:199], v[140:141], v[142:143]
v_pk_fma_f32 v[202:203], v[144:145], v[144:145], v[202:203]
v_pk_add_f32 v[198:199], v[198:199], v[144:145]
v_pk_fma_f32 v[202:203], v[146:147], v[146:147], v[202:203]
v_pk_add_f32 v[198:199], v[198:199], v[146:147]
v_pk_fma_f32 v[202:203], v[148:149], v[148:149], v[202:203]
v_pk_add_f32 v[198:199], v[198:199], v[148:149]
v_pk_fma_f32 v[202:203], v[150:151], v[150:151], v[202:203]
v_pk_add_f32 v[198:199], v[198:199], v[150:151]
v_mfma_f32_16x16x32_bf16 v[152:155], a[48:51], v[32:35], 0
v_add_f32_e64 v200, v200, v201
v_cvt_pk_bf16_f32 v184, v104, v105
v_mfma_f32_16x16x32_bf16 v[156:159], a[52:55], v[36:39], 0
s_add_u32 m0, s82, 71680
s_add_u32 s84, s84, 172032
buffer_load_dwordx4 v204, s[24:27], s84 offen lds
v_mfma_f32_16x16x32_bf16 v[160:163], a[56:59], v[40:43], 0
v_mfma_f32_16x16x32_bf16 v[164:167], a[72:75], v[56:59], 0
v_add_f32 v202, v202, v203
v_add_f32 v196, v196, v197
v_mfma_f32_16x16x32_bf16 v[168:171], a[76:79], v[60:63], 0
v_add_f32_e64 v198, v198, v199
v_cvt_pk_bf16_f32 v185, v106, v107
v_mfma_f32_16x16x32_bf16 v[172:175], a[80:83], v[64:67], 0
ds_write_b64 v29, v[184:185] offset:0
v_permlane32_swap_b32_e64 v200, v202
v_mfma_f32_16x16x32_bf16 v[152:155], a[60:63], v[56:59], v[152:155]
v_permlane32_swap_b32_e64 v196, v198
v_mfma_f32_16x16x32_bf16 v[156:159], a[64:67], v[60:63], v[156:159]
v_add_f32 v200, v200, v202
v_add_f32 v196, v196, v198
v_mfma_f32_16x16x32_bf16 v[160:163], a[68:71], v[64:67], v[160:163]
v_cvt_pk_bf16_f32 v186, v108, v109
v_cvt_pk_bf16_f32 v187, v110, v111
v_mfma_f32_16x16x32_bf16 v[164:167], a[48:51], v[44:47], v[164:167]
v_permlane16_swap_b32 v196, v200
v_add_f32 v196, v196, v200
v_mfma_f32_16x16x32_bf16 v[168:171], a[52:55], v[48:51], v[168:171]
ds_write_b32 v31, v196 offset:37888
ds_write_b64 v29, v[186:187] offset:1024
v_mfma_f32_16x16x32_bf16 v[172:175], a[56:59], v[52:55], v[172:175]
v_cvt_pk_bf16_f32 v188, v112, v113
v_mfma_f32_16x16x32_bf16 v[152:155], a[0:3], v[44:47], v[152:155]
buffer_load_dwordx4 v205, s[24:27], s84 offen offset:1024 lds
v_mfma_f32_16x16x32_bf16 v[156:159], a[4:7], v[48:51], v[156:159]
v_cvt_pk_bf16_f32 v189, v114, v115
v_mfma_f32_16x16x32_bf16 v[160:163], a[8:11], v[52:55], v[160:163]
ds_write_b64 v29, v[188:189] offset:2048
v_cvt_pk_bf16_f32 v190, v116, v117
buffer_load_dwordx4 v206, s[24:27], s84 offen offset:2048 lds
v_cvt_pk_bf16_f32 v191, v118, v119
v_cvt_pk_bf16_f32 v192, v120, v121
v_cvt_pk_bf16_f32 v193, v122, v123
v_cvt_pk_bf16_f32 v194, v124, v125
v_cvt_pk_bf16_f32 v195, v126, v127
ds_write_b64 v29, v[190:191] offset:256
buffer_load_dwordx4 v207, s[24:27], s84 offen offset:3072 lds
ds_write_b64 v29, v[192:193] offset:1280
ds_write_b64 v29, v[194:195] offset:2304
s_waitcnt vmcnt(4) lgkmcnt(5)
s_barrier
v_mfma_f32_16x16x32_bf16 v[152:155], a[12:15], v[68:71], v[152:155]
ds_read_b128 v[176:179], v4 offset:37888
ds_read_b128 v[32:35], v16 offset:57344
v_mfma_f32_16x16x32_bf16 v[156:159], a[16:19], v[72:75], v[156:159]
ds_read_b128 v[36:39], v17 offset:57344
ds_read_b128 v[40:43], v18 offset:57344
v_mfma_f32_16x16x32_bf16 v[160:163], a[20:23], v[76:79], v[160:163]
ds_read_b128 v[56:59], v19 offset:57344
ds_read_b128 v[60:63], v20 offset:57344
v_mfma_f32_16x16x32_bf16 v[152:155], a[24:27], v[92:95], v[152:155]
ds_read_b128 v[64:67], v21 offset:57344
ds_read_b128 v[44:47], v16 offset:64512
v_mfma_f32_16x16x32_bf16 v[156:159], a[28:31], v[96:99], v[156:159]
ds_read_b128 v[48:51], v17 offset:64512
ds_read_b128 v[52:55], v18 offset:64512
v_mfma_f32_16x16x32_bf16 v[160:163], a[32:35], v[100:103], v[160:163]
v_mfma_f32_16x16x32_bf16 v[164:167], a[0:3], v[68:71], v[164:167]
s_waitcnt lgkmcnt(9)
v_add_f32 v176, v176, v177
v_mfma_f32_16x16x32_bf16 v[168:171], a[4:7], v[72:75], v[168:171]
v_add_f32 v178, v178, v179
v_add_f32 v177, v176, v178
v_mfma_f32_16x16x32_bf16 v[172:175], a[8:11], v[76:79], v[172:175]
v_add_f32_e64 v176, v176, v178
v_mfma_f32_16x16x32_bf16 v[164:167], a[36:39], v[92:95], v[164:167]
s_nop 0
v_permlane16_swap_b32 v176, v177
v_mul_f32_e64 v176, s77, v176
v_mfma_f32_16x16x32_bf16 v[168:171], a[40:43], v[96:99], v[168:171]
v_fma_f32 v177, v177, s76, v13
v_fma_f32 v177, -v176, v176, v177
v_mfma_f32_16x16x32_bf16 v[172:175], a[44:47], v[100:103], v[172:175]
v_max_f32 v177, v177, v13
v_rsq_f32 v180, v177
v_mfma_f32_16x16x32_bf16 v[164:167], a[12:15], v[80:83], v[164:167]
v_mul_f32_e64 v176, s78, v176
v_mfma_f32_16x16x32_bf16 v[168:171], a[16:19], v[84:87], v[168:171]
v_mov_b32 v182, v180
v_mul_f32 v181, v176, v180
v_mfma_f32_16x16x32_bf16 v[172:175], a[20:23], v[88:91], v[172:175]
v_mul_f32 v183, v176, v180
v_permlane32_swap_b32 v180, v182
s_nop 0
v_permlane32_swap_b32 v181, v183
v_pk_fma_f32 v[128:129], v[128:129], v[180:181], v[180:181] op_sel:[0,0,1] op_sel_hi:[1,0,1]
v_pk_fma_f32 v[130:131], v[130:131], v[180:181], v[180:181] op_sel:[0,0,1] op_sel_hi:[1,0,1]
v_pk_fma_f32 v[132:133], v[132:133], v[180:181], v[180:181] op_sel:[0,0,1] op_sel_hi:[1,0,1]
v_pk_fma_f32 v[134:135], v[134:135], v[180:181], v[180:181] op_sel:[0,0,1] op_sel_hi:[1,0,1]
v_pk_fma_f32 v[136:137], v[136:137], v[180:181], v[180:181] op_sel:[0,0,1] op_sel_hi:[1,0,1]
v_pk_fma_f32 v[138:139], v[138:139], v[180:181], v[180:181] op_sel:[0,0,1] op_sel_hi:[1,0,1]
v_pk_fma_f32 v[140:141], v[140:141], v[182:183], v[182:183] op_sel:[0,0,1] op_sel_hi:[1,0,1]
v_pk_fma_f32 v[142:143], v[142:143], v[182:183], v[182:183] op_sel:[0,0,1] op_sel_hi:[1,0,1]
v_pk_fma_f32 v[144:145], v[144:145], v[182:183], v[182:183] op_sel:[0,0,1] op_sel_hi:[1,0,1]
v_pk_fma_f32 v[146:147], v[146:147], v[182:183], v[182:183] op_sel:[0,0,1] op_sel_hi:[1,0,1]
v_pk_fma_f32 v[148:149], v[148:149], v[182:183], v[182:183] op_sel:[0,0,1] op_sel_hi:[1,0,1]
v_pk_fma_f32 v[150:151], v[150:151], v[182:183], v[182:183] op_sel:[0,0,1] op_sel_hi:[1,0,1]
v_pk_mul_f32 v[200:201], v[152:153], v[152:153]
v_pk_fma_f32 v[200:201], v[154:155], v[154:155], v[200:201]
v_pk_add_f32 v[196:197], v[152:153], v[154:155]
v_pk_fma_f32 v[200:201], v[156:157], v[156:157], v[200:201]
v_pk_add_f32 v[196:197], v[196:197], v[156:157]
v_pk_fma_f32 v[200:201], v[158:159], v[158:159], v[200:201]
v_pk_add_f32 v[196:197], v[196:197], v[158:159]
v_pk_fma_f32 v[200:201], v[160:161], v[160:161], v[200:201]
v_pk_add_f32 v[196:197], v[196:197], v[160:161]
v_pk_fma_f32 v[200:201], v[162:163], v[162:163], v[200:201]
v_pk_add_f32 v[196:197], v[196:197], v[162:163]
v_pk_mul_f32 v[202:203], v[164:165], v[164:165]
v_pk_fma_f32 v[202:203], v[166:167], v[166:167], v[202:203]
v_pk_add_f32 v[198:199], v[164:165], v[166:167]
v_pk_fma_f32 v[202:203], v[168:169], v[168:169], v[202:203]
v_pk_add_f32 v[198:199], v[198:199], v[168:169]
v_pk_fma_f32 v[202:203], v[170:171], v[170:171], v[202:203]
v_pk_add_f32 v[198:199], v[198:199], v[170:171]
v_pk_fma_f32 v[202:203], v[172:173], v[172:173], v[202:203]
v_pk_add_f32 v[198:199], v[198:199], v[172:173]
v_pk_fma_f32 v[202:203], v[174:175], v[174:175], v[202:203]
v_pk_add_f32 v[198:199], v[198:199], v[174:175]
v_mfma_f32_16x16x32_bf16 v[104:107], a[48:51], v[68:71], 0
v_add_f32_e64 v200, v200, v201
v_cvt_pk_bf16_f32 v184, v128, v129
v_mfma_f32_16x16x32_bf16 v[108:111], a[52:55], v[72:75], 0
s_add_u32 m0, s82, 86016
s_add_u32 s84, s84, 172032
buffer_load_dwordx4 v204, s[24:27], s84 offen lds
v_mfma_f32_16x16x32_bf16 v[112:115], a[56:59], v[76:79], 0
v_mfma_f32_16x16x32_bf16 v[116:119], a[72:75], v[92:95], 0
v_add_f32 v202, v202, v203
v_add_f32 v196, v196, v197
v_mfma_f32_16x16x32_bf16 v[120:123], a[76:79], v[96:99], 0
v_add_f32_e64 v198, v198, v199
v_cvt_pk_bf16_f32 v185, v130, v131
v_mfma_f32_16x16x32_bf16 v[124:127], a[80:83], v[100:103], 0
ds_write_b64 v29, v[184:185] offset:12288
v_permlane32_swap_b32_e64 v200, v202
v_mfma_f32_16x16x32_bf16 v[104:107], a[60:63], v[92:95], v[104:107]
v_permlane32_swap_b32_e64 v196, v198
v_mfma_f32_16x16x32_bf16 v[108:111], a[64:67], v[96:99], v[108:111]
v_add_f32 v200, v200, v202
v_add_f32 v196, v196, v198
v_mfma_f32_16x16x32_bf16 v[112:115], a[68:71], v[100:103], v[112:115]
v_cvt_pk_bf16_f32 v186, v132, v133
v_cvt_pk_bf16_f32 v187, v134, v135
v_mfma_f32_16x16x32_bf16 v[116:119], a[48:51], v[80:83], v[116:119]
v_permlane16_swap_b32 v196, v200
v_add_f32 v196, v196, v200
v_mfma_f32_16x16x32_bf16 v[120:123], a[52:55], v[84:87], v[120:123]
ds_write_b32 v31, v196 offset:38912
ds_write_b64 v29, v[186:187] offset:13312
v_mfma_f32_16x16x32_bf16 v[124:127], a[56:59], v[88:91], v[124:127]
v_cvt_pk_bf16_f32 v188, v136, v137
v_mfma_f32_16x16x32_bf16 v[104:107], a[0:3], v[80:83], v[104:107]
buffer_load_dwordx4 v205, s[24:27], s84 offen offset:1024 lds
v_mfma_f32_16x16x32_bf16 v[108:111], a[4:7], v[84:87], v[108:111]
v_cvt_pk_bf16_f32 v189, v138, v139
v_mfma_f32_16x16x32_bf16 v[112:115], a[8:11], v[88:91], v[112:115]
ds_write_b64 v29, v[188:189] offset:14336
v_cvt_pk_bf16_f32 v190, v140, v141
buffer_load_dwordx4 v206, s[24:27], s84 offen offset:2048 lds
v_cvt_pk_bf16_f32 v191, v142, v143
v_cvt_pk_bf16_f32 v192, v144, v145
v_cvt_pk_bf16_f32 v193, v146, v147
v_cvt_pk_bf16_f32 v194, v148, v149
v_cvt_pk_bf16_f32 v195, v150, v151
ds_write_b64 v29, v[190:191] offset:12544
buffer_load_dwordx4 v207, s[24:27], s84 offen offset:3072 lds
ds_write_b64 v29, v[192:193] offset:13568
ds_write_b64 v29, v[194:195] offset:14592
s_waitcnt vmcnt(4) lgkmcnt(5)
s_barrier
v_mfma_f32_16x16x32_bf16 v[104:107], a[12:15], v[32:35], v[104:107]
ds_read_b128 v[176:179], v4 offset:38912
v_add_u32 v16, 71680, v16
v_mfma_f32_16x16x32_bf16 v[108:111], a[16:19], v[36:39], v[108:111]
v_add_u32 v17, 71680, v17
v_add_u32 v18, 71680, v18
v_mfma_f32_16x16x32_bf16 v[112:115], a[20:23], v[40:43], v[112:115]
v_add_u32 v19, 71680, v19
v_add_u32 v20, 71680, v20
v_mfma_f32_16x16x32_bf16 v[104:107], a[24:27], v[56:59], v[104:107]
v_add_u32 v21, 71680, v21
v_subrev_u32 v31, 114688, v31
v_mfma_f32_16x16x32_bf16 v[108:111], a[28:31], v[60:63], v[108:111]
buffer_load_dword v28, off, s[36:39], 0 sc1
ds_read_b128 v[68:71], v16 offset:0
v_mfma_f32_16x16x32_bf16 v[112:115], a[32:35], v[64:67], v[112:115]
ds_read_b128 v[72:75], v17 offset:0
ds_read_b128 v[76:79], v18 offset:0
v_mfma_f32_16x16x32_bf16 v[116:119], a[0:3], v[32:35], v[116:119]
s_waitcnt lgkmcnt(3)
v_add_f32 v176, v176, v177
v_mfma_f32_16x16x32_bf16 v[120:123], a[4:7], v[36:39], v[120:123]
ds_read_b128 v[92:95], v19 offset:0
ds_read_b128 v[96:99], v20 offset:0
v_mfma_f32_16x16x32_bf16 v[124:127], a[8:11], v[40:43], v[124:127]
ds_read_b128 v[100:103], v21 offset:0
v_add_f32_e64 v178, v178, v179
v_mfma_f32_16x16x32_bf16 v[116:119], a[36:39], v[56:59], v[116:119]
v_add_f32 v177, v176, v178
v_add_f32 v176, v176, v178
v_mfma_f32_16x16x32_bf16 v[120:123], a[40:43], v[60:63], v[120:123]
ds_read_b128 v[80:83], v16 offset:7168
ds_read_b128 v[84:87], v17 offset:7168
v_mfma_f32_16x16x32_bf16 v[124:127], a[44:47], v[64:67], v[124:127]
v_permlane16_swap_b32 v176, v177
v_mul_f32 v176, s77, v176
v_mfma_f32_16x16x32_bf16 v[116:119], a[12:15], v[44:47], v[116:119]
v_fma_f32 v177, v177, s76, v13
v_fma_f32 v177, -v176, v176, v177
v_mfma_f32_16x16x32_bf16 v[120:123], a[16:19], v[48:51], v[120:123]
v_max_f32 v177, v177, v13
v_rsq_f32 v180, v177
v_mfma_f32_16x16x32_bf16 v[124:127], a[20:23], v[52:55], v[124:127]
v_mul_f32_e64 v176, s78, v176
ds_read_b128 v[88:91], v18 offset:7168
v_mov_b32 v182, v180
v_mul_f32 v181, v176, v180
v_mul_f32 v183, v176, v180
v_permlane32_swap_b32 v180, v182
s_nop 0
v_permlane32_swap_b32 v181, v183
v_pk_fma_f32 v[152:153], v[152:153], v[180:181], v[180:181] op_sel:[0,0,1] op_sel_hi:[1,0,1]
v_pk_fma_f32 v[154:155], v[154:155], v[180:181], v[180:181] op_sel:[0,0,1] op_sel_hi:[1,0,1]
v_pk_fma_f32 v[156:157], v[156:157], v[180:181], v[180:181] op_sel:[0,0,1] op_sel_hi:[1,0,1]
v_pk_fma_f32 v[158:159], v[158:159], v[180:181], v[180:181] op_sel:[0,0,1] op_sel_hi:[1,0,1]
v_pk_fma_f32 v[160:161], v[160:161], v[180:181], v[180:181] op_sel:[0,0,1] op_sel_hi:[1,0,1]
v_pk_fma_f32 v[162:163], v[162:163], v[180:181], v[180:181] op_sel:[0,0,1] op_sel_hi:[1,0,1]
v_pk_fma_f32 v[164:165], v[164:165], v[182:183], v[182:183] op_sel:[0,0,1] op_sel_hi:[1,0,1]
v_pk_fma_f32 v[166:167], v[166:167], v[182:183], v[182:183] op_sel:[0,0,1] op_sel_hi:[1,0,1]
v_pk_fma_f32 v[168:169], v[168:169], v[182:183], v[182:183] op_sel:[0,0,1] op_sel_hi:[1,0,1]
v_pk_fma_f32 v[170:171], v[170:171], v[182:183], v[182:183] op_sel:[0,0,1] op_sel_hi:[1,0,1]
v_pk_fma_f32 v[172:173], v[172:173], v[182:183], v[182:183] op_sel:[0,0,1] op_sel_hi:[1,0,1]
v_pk_fma_f32 v[174:175], v[174:175], v[182:183], v[182:183] op_sel:[0,0,1] op_sel_hi:[1,0,1]
v_pk_mul_f32 v[200:201], v[104:105], v[104:105]
v_pk_fma_f32 v[200:201], v[106:107], v[106:107], v[200:201]
v_pk_add_f32 v[196:197], v[104:105], v[106:107]
v_pk_fma_f32 v[200:201], v[108:109], v[108:109], v[200:201]
v_pk_add_f32 v[196:197], v[196:197], v[108:109]
v_pk_fma_f32 v[200:201], v[110:111], v[110:111], v[200:201]
v_pk_add_f32 v[196:197], v[196:197], v[110:111]
v_pk_fma_f32 v[200:201], v[112:113], v[112:113], v[200:201]
v_pk_add_f32 v[196:197], v[196:197], v[112:113]
v_pk_fma_f32 v[200:201], v[114:115], v[114:115], v[200:201]
v_pk_add_f32 v[196:197], v[196:197], v[114:115]
v_pk_mul_f32 v[202:203], v[116:117], v[116:117]
v_pk_fma_f32 v[202:203], v[118:119], v[118:119], v[202:203]
v_pk_add_f32 v[198:199], v[116:117], v[118:119]
v_pk_fma_f32 v[202:203], v[120:121], v[120:121], v[202:203]
v_pk_add_f32 v[198:199], v[198:199], v[120:121]
v_pk_fma_f32 v[202:203], v[122:123], v[122:123], v[202:203]
v_pk_add_f32 v[198:199], v[198:199], v[122:123]
v_pk_fma_f32 v[202:203], v[124:125], v[124:125], v[202:203]
v_pk_add_f32 v[198:199], v[198:199], v[124:125]
v_pk_fma_f32 v[202:203], v[126:127], v[126:127], v[202:203]
v_pk_add_f32 v[198:199], v[198:199], v[126:127]
v_mfma_f32_16x16x32_bf16 v[128:131], a[48:51], v[32:35], 0
v_add_f32_e64 v200, v200, v201
v_cvt_pk_bf16_f32 v184, v152, v153
v_mfma_f32_16x16x32_bf16 v[132:135], a[52:55], v[36:39], 0
s_add_u32 m0, s82, 100352
s_add_u32 s84, s84, 172032
buffer_load_dwordx4 v204, s[24:27], s87 offen lds
v_mfma_f32_16x16x32_bf16 v[136:139], a[56:59], v[40:43], 0
v_mfma_f32_16x16x32_bf16 v[140:143], a[72:75], v[56:59], 0
v_add_f32 v202, v202, v203
v_add_f32 v196, v196, v197
v_mfma_f32_16x16x32_bf16 v[144:147], a[76:79], v[60:63], 0
v_add_f32_e64 v198, v198, v199
v_cvt_pk_bf16_f32 v185, v154, v155
v_mfma_f32_16x16x32_bf16 v[148:151], a[80:83], v[64:67], 0
ds_write_b64 v29, v[184:185] offset:24576
v_permlane32_swap_b32_e64 v200, v202
v_mfma_f32_16x16x32_bf16 v[128:131], a[60:63], v[56:59], v[128:131]
v_permlane32_swap_b32_e64 v196, v198
v_mfma_f32_16x16x32_bf16 v[132:135], a[64:67], v[60:63], v[132:135]
v_add_f32 v200, v200, v202
v_add_f32 v196, v196, v198
v_mfma_f32_16x16x32_bf16 v[136:139], a[68:71], v[64:67], v[136:139]
v_cvt_pk_bf16_f32 v186, v156, v157
v_cvt_pk_bf16_f32 v187, v158, v159
v_mfma_f32_16x16x32_bf16 v[140:143], a[48:51], v[44:47], v[140:143]
v_permlane16_swap_b32 v196, v200
v_add_f32 v196, v196, v200
v_mfma_f32_16x16x32_bf16 v[144:147], a[52:55], v[48:51], v[144:147]
ds_write_b32 v31, v196 offset:36864
ds_write_b64 v29, v[186:187] offset:25600
v_mfma_f32_16x16x32_bf16 v[148:151], a[56:59], v[52:55], v[148:151]
v_cvt_pk_bf16_f32 v188, v160, v161
v_mfma_f32_16x16x32_bf16 v[128:131], a[0:3], v[44:47], v[128:131]
buffer_load_dwordx4 v205, s[24:27], s87 offen offset:1024 lds
v_mfma_f32_16x16x32_bf16 v[132:135], a[4:7], v[48:51], v[132:135]
v_cvt_pk_bf16_f32 v189, v162, v163
v_mfma_f32_16x16x32_bf16 v[136:139], a[8:11], v[52:55], v[136:139]
ds_write_b64 v29, v[188:189] offset:26624
v_cvt_pk_bf16_f32 v190, v164, v165
buffer_load_dwordx4 v206, s[24:27], s87 offen offset:2048 lds
v_cvt_pk_bf16_f32 v191, v166, v167
v_cvt_pk_bf16_f32 v192, v168, v169
v_cvt_pk_bf16_f32 v193, v170, v171
v_cvt_pk_bf16_f32 v194, v172, v173
v_cvt_pk_bf16_f32 v195, v174, v175
ds_write_b64 v29, v[190:191] offset:24832
buffer_load_dwordx4 v207, s[24:27], s87 offen offset:3072 lds
ds_write_b64 v29, v[192:193] offset:25856
ds_write_b64 v29, v[194:195] offset:26880
s_waitcnt vmcnt(5) lgkmcnt(5)
s_barrier
s_waitcnt vmcnt(4)
v_readfirstlane_b32 s50, v28
s_nop 0
s_cmp_lt_u32 s50, 26
s_cbranch_scc1 L_c1_cold
L_c1_done:
s_nop 0
v_mfma_f32_16x16x32_bf16 v[128:131], a[12:15], v[68:71], v[128:131]
ds_read_b128 v[176:179], v1 offset:36864
ds_read_b128 v[32:35], v16 offset:14336
v_mfma_f32_16x16x32_bf16 v[132:135], a[16:19], v[72:75], v[132:135]
ds_read_b128 v[36:39], v17 offset:14336
ds_read_b128 v[40:43], v18 offset:14336
v_mfma_f32_16x16x32_bf16 v[136:139], a[20:23], v[76:79], v[136:139]
ds_read_b128 v[56:59], v19 offset:14336
ds_read_b128 v[60:63], v20 offset:14336
v_mfma_f32_16x16x32_bf16 v[128:131], a[24:27], v[92:95], v[128:131]
buffer_load_dwordx4 v[208:211], v1, s[32:35], s52 offen offset:0 sc1
v_mfma_f32_16x16x32_bf16 v[132:135], a[28:31], v[96:99], v[132:135]
ds_read_b128 v[64:67], v21 offset:14336
ds_read_b128 v[44:47], v16 offset:21504
v_mfma_f32_16x16x32_bf16 v[136:139], a[32:35], v[100:103], v[136:139]
ds_read_b128 v[48:51], v17 offset:21504
ds_read_b128 v[52:55], v18 offset:21504
v_mfma_f32_16x16x32_bf16 v[140:143], a[0:3], v[68:71], v[140:143]
s_waitcnt lgkmcnt(9)
v_add_f32 v176, v176, v177
v_mfma_f32_16x16x32_bf16 v[144:147], a[4:7], v[72:75], v[144:147]
v_add_f32 v178, v178, v179
v_add_f32 v177, v176, v178
v_mfma_f32_16x16x32_bf16 v[148:151], a[8:11], v[76:79], v[148:151]
v_add_f32_e64 v176, v176, v178
v_mfma_f32_16x16x32_bf16 v[140:143], a[36:39], v[92:95], v[140:143]
s_nop 0
v_permlane16_swap_b32 v176, v177
v_mul_f32_e64 v176, s77, v176
v_mfma_f32_16x16x32_bf16 v[144:147], a[40:43], v[96:99], v[144:147]
v_fma_f32 v177, v177, s76, v13
v_fma_f32 v177, -v176, v176, v177
v_mfma_f32_16x16x32_bf16 v[148:151], a[44:47], v[100:103], v[148:151]
buffer_load_dwordx4 v[212:215], v1, s[32:35], s52 offen offset:1024 sc1
v_mfma_f32_16x16x32_bf16 v[140:143], a[12:15], v[80:83], v[140:143]
v_max_f32 v177, v177, v13
v_rsq_f32 v180, v177
v_mfma_f32_16x16x32_bf16 v[144:147], a[16:19], v[84:87], v[144:147]
v_mul_f32_e64 v176, s78, v176
v_mfma_f32_16x16x32_bf16 v[148:151], a[20:23], v[88:91], v[148:151]
v_mov_b32 v182, v180
v_mul_f32 v181, v176, v180
v_mul_f32 v183, v176, v180
v_permlane32_swap_b32 v180, v182
s_nop 0
v_permlane32_swap_b32 v181, v183
v_pk_fma_f32 v[104:105], v[104:105], v[180:181], v[180:181] op_sel:[0,0,1] op_sel_hi:[1,0,1]
v_pk_fma_f32 v[106:107], v[106:107], v[180:181], v[180:181] op_sel:[0,0,1] op_sel_hi:[1,0,1]
v_pk_fma_f32 v[108:109], v[108:109], v[180:181], v[180:181] op_sel:[0,0,1] op_sel_hi:[1,0,1]
v_pk_fma_f32 v[110:111], v[110:111], v[180:181], v[180:181] op_sel:[0,0,1] op_sel_hi:[1,0,1]
v_pk_fma_f32 v[112:113], v[112:113], v[180:181], v[180:181] op_sel:[0,0,1] op_sel_hi:[1,0,1]
v_pk_fma_f32 v[114:115], v[114:115], v[180:181], v[180:181] op_sel:[0,0,1] op_sel_hi:[1,0,1]
v_pk_fma_f32 v[116:117], v[116:117], v[182:183], v[182:183] op_sel:[0,0,1] op_sel_hi:[1,0,1]
v_pk_fma_f32 v[118:119], v[118:119], v[182:183], v[182:183] op_sel:[0,0,1] op_sel_hi:[1,0,1]
v_pk_fma_f32 v[120:121], v[120:121], v[182:183], v[182:183] op_sel:[0,0,1] op_sel_hi:[1,0,1]
v_pk_fma_f32 v[122:123], v[122:123], v[182:183], v[182:183] op_sel:[0,0,1] op_sel_hi:[1,0,1]
v_pk_fma_f32 v[124:125], v[124:125], v[182:183], v[182:183] op_sel:[0,0,1] op_sel_hi:[1,0,1]
v_pk_fma_f32 v[126:127], v[126:127], v[182:183], v[182:183] op_sel:[0,0,1] op_sel_hi:[1,0,1]
v_pk_mul_f32 v[200:201], v[128:129], v[128:129]
v_pk_fma_f32 v[200:201], v[130:131], v[130:131], v[200:201]
v_pk_add_f32 v[196:197], v[128:129], v[130:131]
v_pk_fma_f32 v[200:201], v[132:133], v[132:133], v[200:201]
v_pk_add_f32 v[196:197], v[196:197], v[132:133]
buffer_load_dwordx4 v[216:219], v1, s[32:35], s52 offen offset:2048 sc1
v_pk_fma_f32 v[200:201], v[134:135], v[134:135], v[200:201]
v_pk_add_f32 v[196:197], v[196:197], v[134:135]
v_pk_fma_f32 v[200:201], v[136:137], v[136:137], v[200:201]
v_pk_add_f32 v[196:197], v[196:197], v[136:137]
v_pk_fma_f32 v[200:201], v[138:139], v[138:139], v[200:201]
v_pk_add_f32 v[196:197], v[196:197], v[138:139]
v_pk_mul_f32 v[202:203], v[140:141], v[140:141]
v_pk_fma_f32 v[202:203], v[142:143], v[142:143], v[202:203]
v_pk_add_f32 v[198:199], v[140:141], v[142:143]
v_pk_fma_f32 v[202:203], v[144:145], v[144:145], v[202:203]
v_pk_add_f32 v[198:199], v[198:199], v[144:145]
v_pk_fma_f32 v[202:203], v[146:147], v[146:147], v[202:203]
v_pk_add_f32 v[198:199], v[198:199], v[146:147]
v_pk_fma_f32 v[202:203], v[148:149], v[148:149], v[202:203]
v_pk_add_f32 v[198:199], v[198:199], v[148:149]
v_pk_fma_f32 v[202:203], v[150:151], v[150:151], v[202:203]
v_pk_add_f32 v[198:199], v[198:199], v[150:151]
v_mfma_f32_16x16x32_bf16 v[152:155], a[48:51], v[68:71], 0
v_add_f32_e64 v200, v200, v201
v_cvt_pk_bf16_f32 v184, v104, v105
v_mfma_f32_16x16x32_bf16 v[156:159], a[52:55], v[72:75], 0
v_add_f32 v202, v202, v203
v_add_f32 v196, v196, v197
v_mfma_f32_16x16x32_bf16 v[160:163], a[56:59], v[76:79], 0
buffer_load_dwordx4 v[220:223], v1, s[32:35], s52 offen offset:3072 sc1
v_mfma_f32_16x16x32_bf16 v[164:167], a[72:75], v[92:95], 0
v_add_f32_e64 v198, v198, v199
v_cvt_pk_bf16_f32 v185, v106, v107
v_mfma_f32_16x16x32_bf16 v[168:171], a[76:79], v[96:99], 0
ds_write_b64 v29, v[184:185] offset:36864
v_permlane32_swap_b32_e64 v200, v202
v_mfma_f32_16x16x32_bf16 v[172:175], a[80:83], v[100:103], 0
v_permlane32_swap_b32_e64 v196, v198
v_mfma_f32_16x16x32_bf16 v[152:155], a[60:63], v[92:95], v[152:155]
v_add_f32 v200, v200, v202
v_add_f32 v196, v196, v198
v_mfma_f32_16x16x32_bf16 v[156:159], a[64:67], v[96:99], v[156:159]
buffer_load_dwordx4 v[224:227], v2, s[32:35], s52 offen offset:0 sc1
v_mfma_f32_16x16x32_bf16 v[160:163], a[68:71], v[100:103], v[160:163]
v_cvt_pk_bf16_f32 v186, v108, v109
v_cvt_pk_bf16_f32 v187, v110, v111
v_mfma_f32_16x16x32_bf16 v[164:167], a[48:51], v[80:83], v[164:167]
v_permlane16_swap_b32 v196, v200
v_add_f32 v196, v196, v200
v_mfma_f32_16x16x32_bf16 v[168:171], a[52:55], v[84:87], v[168:171]
ds_write_b32 v31, v196 offset:37888
ds_write_b64 v29, v[186:187] offset:37888
v_mfma_f32_16x16x32_bf16 v[172:175], a[56:59], v[88:91], v[172:175]
v_cvt_pk_bf16_f32 v188, v112, v113
v_mfma_f32_16x16x32_bf16 v[152:155], a[0:3], v[80:83], v[152:155]
buffer_load_dwordx4 v[228:231], v2, s[32:35], s52 offen offset:1024 sc1
v_mfma_f32_16x16x32_bf16 v[156:159], a[4:7], v[84:87], v[156:159]
v_cvt_pk_bf16_f32 v189, v114, v115
v_mfma_f32_16x16x32_bf16 v[160:163], a[8:11], v[88:91], v[160:163]
ds_write_b64 v29, v[188:189] offset:38912
v_cvt_pk_bf16_f32 v190, v116, v117
v_cvt_pk_bf16_f32 v191, v118, v119
v_cvt_pk_bf16_f32 v192, v120, v121
v_cvt_pk_bf16_f32 v193, v122, v123
v_cvt_pk_bf16_f32 v194, v124, v125
v_cvt_pk_bf16_f32 v195, v126, v127
ds_write_b64 v29, v[190:191] offset:37120
ds_write_b64 v29, v[192:193] offset:38144
ds_write_b64 v29, v[194:195] offset:39168
s_waitcnt vmcnt(6) lgkmcnt(5)
s_barrier
v_mfma_f32_16x16x32_bf16 v[152:155], a[12:15], v[32:35], v[152:155]
ds_read_b128 v[176:179], v1 offset:37888
ds_read_b128 v[68:71], v16 offset:28672
v_mfma_f32_16x16x32_bf16 v[156:159], a[16:19], v[36:39], v[156:159]
ds_read_b128 v[72:75], v17 offset:28672
ds_read_b128 v[76:79], v18 offset:28672
v_mfma_f32_16x16x32_bf16 v[160:163], a[20:23], v[40:43], v[160:163]
ds_read_b128 v[92:95], v19 offset:28672
ds_read_b128 v[96:99], v20 offset:28672
v_mfma_f32_16x16x32_bf16 v[152:155], a[24:27], v[56:59], v[152:155]
buffer_load_dwordx4 v[232:235], v2, s[32:35], s52 offen offset:2048 sc1
v_mfma_f32_16x16x32_bf16 v[156:159], a[28:31], v[60:63], v[156:159]
ds_read_b128 v[100:103], v21 offset:28672
ds_read_b128 v[80:83], v16 offset:35840
v_mfma_f32_16x16x32_bf16 v[160:163], a[32:35], v[64:67], v[160:163]
ds_read_b128 v[84:87], v17 offset:35840
ds_read_b128 v[88:91], v18 offset:35840
v_mfma_f32_16x16x32_bf16 v[164:167], a[0:3], v[32:35], v[164:167]
s_waitcnt lgkmcnt(9)
v_add_f32 v176, v176, v177
v_mfma_f32_16x16x32_bf16 v[168:171], a[4:7], v[36:39], v[168:171]
v_add_f32 v178, v178, v179
v_add_f32 v177, v176, v178
v_mfma_f32_16x16x32_bf16 v[172:175], a[8:11], v[40:43], v[172:175]
v_add_f32_e64 v176, v176, v178
v_mfma_f32_16x16x32_bf16 v[164:167], a[36:39], v[56:59], v[164:167]
s_nop 0
v_permlane16_swap_b32 v176, v177
v_mul_f32_e64 v176, s77, v176
v_mfma_f32_16x16x32_bf16 v[168:171], a[40:43], v[60:63], v[168:171]
v_fma_f32 v177, v177, s76, v13
v_fma_f32 v177, -v176, v176, v177
v_mfma_f32_16x16x32_bf16 v[172:175], a[44:47], v[64:67], v[172:175]
buffer_load_dwordx4 v[236:239], v2, s[32:35], s52 offen offset:3072 sc1
v_mfma_f32_16x16x32_bf16 v[164:167], a[12:15], v[44:47], v[164:167]
v_max_f32 v177, v177, v13
v_rsq_f32 v180, v177
v_mfma_f32_16x16x32_bf16 v[168:171], a[16:19], v[48:51], v[168:171]
v_mul_f32_e64 v176, s78, v176
v_mfma_f32_16x16x32_bf16 v[172:175], a[20:23], v[52:55], v[172:175]
v_mov_b32 v182, v180
v_mul_f32 v181, v176, v180
v_mul_f32 v183, v176, v180
v_permlane32_swap_b32 v180, v182
s_nop 0
v_permlane32_swap_b32 v181, v183
v_pk_fma_f32 v[128:129], v[128:129], v[180:181], v[180:181] op_sel:[0,0,1] op_sel_hi:[1,0,1]
v_pk_fma_f32 v[130:131], v[130:131], v[180:181], v[180:181] op_sel:[0,0,1] op_sel_hi:[1,0,1]
v_pk_fma_f32 v[132:133], v[132:133], v[180:181], v[180:181] op_sel:[0,0,1] op_sel_hi:[1,0,1]
v_pk_fma_f32 v[134:135], v[134:135], v[180:181], v[180:181] op_sel:[0,0,1] op_sel_hi:[1,0,1]
v_pk_fma_f32 v[136:137], v[136:137], v[180:181], v[180:181] op_sel:[0,0,1] op_sel_hi:[1,0,1]
v_pk_fma_f32 v[138:139], v[138:139], v[180:181], v[180:181] op_sel:[0,0,1] op_sel_hi:[1,0,1]
v_pk_fma_f32 v[140:141], v[140:141], v[182:183], v[182:183] op_sel:[0,0,1] op_sel_hi:[1,0,1]
v_pk_fma_f32 v[142:143], v[142:143], v[182:183], v[182:183] op_sel:[0,0,1] op_sel_hi:[1,0,1]
v_pk_fma_f32 v[144:145], v[144:145], v[182:183], v[182:183] op_sel:[0,0,1] op_sel_hi:[1,0,1]
v_pk_fma_f32 v[146:147], v[146:147], v[182:183], v[182:183] op_sel:[0,0,1] op_sel_hi:[1,0,1]
v_pk_fma_f32 v[148:149], v[148:149], v[182:183], v[182:183] op_sel:[0,0,1] op_sel_hi:[1,0,1]
v_pk_fma_f32 v[150:151], v[150:151], v[182:183], v[182:183] op_sel:[0,0,1] op_sel_hi:[1,0,1]
v_pk_mul_f32 v[200:201], v[152:153], v[152:153]
v_pk_fma_f32 v[200:201], v[154:155], v[154:155], v[200:201]
v_pk_add_f32 v[196:197], v[152:153], v[154:155]
v_pk_fma_f32 v[200:201], v[156:157], v[156:157], v[200:201]
v_pk_add_f32 v[196:197], v[196:197], v[156:157]
buffer_load_dwordx4 v[240:243], v3, s[32:35], s52 offen offset:0 sc1
v_pk_fma_f32 v[200:201], v[158:159], v[158:159], v[200:201]
v_pk_add_f32 v[196:197], v[196:197], v[158:159]
v_pk_fma_f32 v[200:201], v[160:161], v[160:161], v[200:201]
v_pk_add_f32 v[196:197], v[196:197], v[160:161]
v_pk_fma_f32 v[200:201], v[162:163], v[162:163], v[200:201]
v_pk_add_f32 v[196:197], v[196:197], v[162:163]
v_pk_mul_f32 v[202:203], v[164:165], v[164:165]
v_pk_fma_f32 v[202:203], v[166:167], v[166:167], v[202:203]
v_pk_add_f32 v[198:199], v[164:165], v[166:167]
v_pk_fma_f32 v[202:203], v[168:169], v[168:169], v[202:203]
v_pk_add_f32 v[198:199], v[198:199], v[168:169]
v_pk_fma_f32 v[202:203], v[170:171], v[170:171], v[202:203]
v_pk_add_f32 v[198:199], v[198:199], v[170:171]
v_pk_fma_f32 v[202:203], v[172:173], v[172:173], v[202:203]
v_pk_add_f32 v[198:199], v[198:199], v[172:173]
v_pk_fma_f32 v[202:203], v[174:175], v[174:175], v[202:203]
v_pk_add_f32 v[198:199], v[198:199], v[174:175]
v_mfma_f32_16x16x32_bf16 v[104:107], a[48:51], v[32:35], 0
v_add_f32_e64 v200, v200, v201
v_cvt_pk_bf16_f32 v184, v128, v129
v_mfma_f32_16x16x32_bf16 v[108:111], a[52:55], v[36:39], 0
v_add_f32 v202, v202, v203
v_add_f32 v196, v196, v197
v_mfma_f32_16x16x32_bf16 v[112:115], a[56:59], v[40:43], 0
buffer_load_dwordx4 v[244:247], v3, s[32:35], s52 offen offset:1024 sc1
v_mfma_f32_16x16x32_bf16 v[116:119], a[72:75], v[56:59], 0
v_add_f32_e64 v198, v198, v199
v_cvt_pk_bf16_f32 v185, v130, v131
v_mfma_f32_16x16x32_bf16 v[120:123], a[76:79], v[60:63], 0
ds_write_b64 v30, v[184:185] offset:0
v_permlane32_swap_b32_e64 v200, v202
v_mfma_f32_16x16x32_bf16 v[124:127], a[80:83], v[64:67], 0
v_permlane32_swap_b32_e64 v196, v198
v_mfma_f32_16x16x32_bf16 v[104:107], a[60:63], v[56:59], v[104:107]
v_add_f32 v200, v200, v202
v_add_f32 v196, v196, v198
v_mfma_f32_16x16x32_bf16 v[108:111], a[64:67], v[60:63], v[108:111]
buffer_load_dwordx4 v[248:251], v3, s[32:35], s52 offen offset:2048 sc1
v_mfma_f32_16x16x32_bf16 v[112:115], a[68:71], v[64:67], v[112:115]
v_cvt_pk_bf16_f32 v186, v132, v133
v_cvt_pk_bf16_f32 v187, v134, v135
v_mfma_f32_16x16x32_bf16 v[116:119], a[48:51], v[44:47], v[116:119]
v_permlane16_swap_b32 v196, v200
v_add_f32 v196, v196, v200
v_mfma_f32_16x16x32_bf16 v[120:123], a[52:55], v[48:51], v[120:123]
ds_write_b32 v31, v196 offset:38912
ds_write_b64 v30, v[186:187] offset:1024
v_mfma_f32_16x16x32_bf16 v[124:127], a[56:59], v[52:55], v[124:127]
v_cvt_pk_bf16_f32 v188, v136, v137
v_mfma_f32_16x16x32_bf16 v[104:107], a[0:3], v[44:47], v[104:107]
buffer_load_dwordx4 v[252:255], v3, s[32:35], s52 offen offset:3072 sc1
v_mfma_f32_16x16x32_bf16 v[108:111], a[4:7], v[48:51], v[108:111]
v_cvt_pk_bf16_f32 v189, v138, v139
v_mfma_f32_16x16x32_bf16 v[112:115], a[8:11], v[52:55], v[112:115]
ds_write_b64 v30, v[188:189] offset:2048
v_cvt_pk_bf16_f32 v190, v140, v141
v_cvt_pk_bf16_f32 v191, v142, v143
v_cvt_pk_bf16_f32 v192, v144, v145
v_cvt_pk_bf16_f32 v193, v146, v147
v_cvt_pk_bf16_f32 v194, v148, v149
v_cvt_pk_bf16_f32 v195, v150, v151
ds_write_b64 v30, v[190:191] offset:256
ds_write_b64 v30, v[192:193] offset:1280
ds_write_b64 v30, v[194:195] offset:2304
s_waitcnt lgkmcnt(5)
s_barrier
v_mfma_f32_16x16x32_bf16 v[104:107], a[12:15], v[68:71], v[104:107]
ds_read_b128 v[176:179], v1 offset:38912
ds_read_b128 a[96:99], v4 offset:0
v_mfma_f32_16x16x32_bf16 v[108:111], a[16:19], v[72:75], v[108:111]
buffer_load_dwordx4 a[144:147], v1, s[32:35], s53 offen offset:0 sc1
v_mfma_f32_16x16x32_bf16 v[112:115], a[20:23], v[76:79], v[112:115]
ds_read_b128 a[100:103], v4 offset:1024
ds_read_b128 a[104:107], v4 offset:2048
v_mfma_f32_16x16x32_bf16 v[104:107], a[24:27], v[92:95], v[104:107]
ds_read_b128 a[108:111], v4 offset:3072
ds_read_b128 a[112:115], v4 offset:4096
v_mfma_f32_16x16x32_bf16 v[108:111], a[28:31], v[96:99], v[108:111]
ds_read_b128 a[116:119], v4 offset:5120
ds_read_b128 a[120:123], v4 offset:6144
v_mfma_f32_16x16x32_bf16 v[112:115], a[32:35], v[100:103], v[112:115]
buffer_load_dwordx4 a[148:151], v1, s[32:35], s53 offen offset:1024 sc1
v_mfma_f32_16x16x32_bf16 v[116:119], a[0:3], v[68:71], v[116:119]
s_waitcnt lgkmcnt(7)
s_nop 0
ds_read_b128 a[124:127], v4 offset:7168
v_mfma_f32_16x16x32_bf16 v[120:123], a[4:7], v[72:75], v[120:123]
ds_read_b128 a[128:131], v4 offset:8192
ds_read_b128 a[132:135], v4 offset:9216
v_mfma_f32_16x16x32_bf16 v[124:127], a[8:11], v[76:79], v[124:127]
ds_read_b128 a[136:139], v4 offset:10240
v_add_f32_e64 v176, v176, v177
v_mfma_f32_16x16x32_bf16 v[116:119], a[36:39], v[92:95], v[116:119]
buffer_load_dwordx4 a[152:155], v1, s[32:35], s53 offen offset:2048 sc1
v_mfma_f32_16x16x32_bf16 v[120:123], a[40:43], v[96:99], v[120:123]
ds_read_b128 a[140:143], v4 offset:11264
v_add_f32_e64 v178, v178, v179
v_mfma_f32_16x16x32_bf16 v[124:127], a[44:47], v[100:103], v[124:127]
v_add_f32 v177, v176, v178
v_add_f32 v176, v176, v178
v_mfma_f32_16x16x32_bf16 v[116:119], a[12:15], v[80:83], v[116:119]
v_mfma_f32_16x16x32_bf16 v[120:123], a[16:19], v[84:87], v[120:123]
buffer_load_dwordx4 a[156:159], v1, s[32:35], s53 offen offset:3072 sc1
v_mfma_f32_16x16x32_bf16 v[124:127], a[20:23], v[88:91], v[124:127]
v_permlane16_swap_b32 v176, v177
v_mul_f32 v176, s77, v176
v_fma_f32 v177, v177, s76, v13
v_fma_f32 v177, -v176, v176, v177
v_max_f32 v177, v177, v13
v_rsq_f32 v180, v177
v_mul_f32 v176, s78, v176
v_mov_b32 v182, v180
v_mul_f32 v181, v176, v180
v_mul_f32 v183, v176, v180
v_permlane32_swap_b32 v180, v182
s_nop 0
v_permlane32_swap_b32_e64 v181, v183
v_pk_mul_f32 v[200:201], v[104:105], v[104:105]
v_pk_fma_f32 v[200:201], v[106:107], v[106:107], v[200:201]
buffer_load_dwordx4 a[160:163], v2, s[32:35], s53 offen offset:0 sc1
v_pk_add_f32 v[196:197], v[104:105], v[106:107]
v_pk_fma_f32 v[200:201], v[108:109], v[108:109], v[200:201]
v_pk_add_f32 v[196:197], v[196:197], v[108:109]
v_pk_fma_f32 v[200:201], v[110:111], v[110:111], v[200:201]
v_pk_add_f32 v[196:197], v[196:197], v[110:111]
v_pk_fma_f32 v[200:201], v[112:113], v[112:113], v[200:201]
buffer_load_dwordx4 a[164:167], v2, s[32:35], s53 offen offset:1024 sc1
v_pk_add_f32 v[196:197], v[196:197], v[112:113]
v_pk_fma_f32 v[200:201], v[114:115], v[114:115], v[200:201]
v_pk_add_f32 v[196:197], v[196:197], v[114:115]
v_pk_mul_f32 v[202:203], v[116:117], v[116:117]
v_pk_fma_f32 v[202:203], v[118:119], v[118:119], v[202:203]
buffer_load_dwordx4 a[168:171], v2, s[32:35], s53 offen offset:2048 sc1
v_pk_add_f32 v[198:199], v[116:117], v[118:119]
v_pk_fma_f32 v[202:203], v[120:121], v[120:121], v[202:203]
v_pk_add_f32 v[198:199], v[198:199], v[120:121]
v_pk_fma_f32 v[202:203], v[122:123], v[122:123], v[202:203]
v_pk_add_f32 v[198:199], v[198:199], v[122:123]
v_pk_fma_f32 v[202:203], v[124:125], v[124:125], v[202:203]
buffer_load_dwordx4 a[172:175], v2, s[32:35], s53 offen offset:3072 sc1
v_pk_add_f32 v[198:199], v[198:199], v[124:125]
v_pk_fma_f32 v[202:203], v[126:127], v[126:127], v[202:203]
v_pk_add_f32 v[198:199], v[198:199], v[126:127]
s_waitcnt vmcnt(19) lgkmcnt(11)
v_mfma_f32_32x32x16_bf16 v[32:47], v[208:211], a[96:99], 0
v_add_f32 v200, v200, v201
v_fma_f32 v152, v152, v180, v181
v_add_f32 v202, v202, v203
v_add_f32 v196, v196, v197
v_add_f32_e64 v198, v198, v199
v_fma_f32 v153, v153, v180, v181
s_waitcnt vmcnt(18) lgkmcnt(10)
v_mfma_f32_32x32x16_bf16 v[32:47], v[212:215], a[100:103], v[32:47]
buffer_load_dwordx4 a[176:179], v3, s[32:35], s53 offen offset:0 sc1
v_permlane32_swap_b32 v200, v202
v_fma_f32 v154, v154, v180, v181
v_fma_f32 v155, v155, v180, v181
v_cvt_pk_bf16_f32 v184, v152, v153
s_waitcnt vmcnt(18) lgkmcnt(9)
v_mfma_f32_32x32x16_bf16 v[32:47], v[216:219], a[104:107], v[32:47]
v_permlane32_swap_b32 v196, v198
v_add_f32 v200, v200, v202
v_add_f32 v196, v196, v198
v_cvt_pk_bf16_f32 v185, v154, v155
v_fma_f32 v156, v156, v180, v181
v_fma_f32 v157, v157, v180, v181
s_waitcnt vmcnt(17) lgkmcnt(8)
v_mfma_f32_32x32x16_bf16 v[32:47], v[220:223], a[108:111], v[32:47]
v_permlane16_swap_b32 v196, v200
v_add_f32_e64 v196, v196, v200
v_fma_f32 v158, v158, v180, v181
v_fma_f32 v159, v159, v180, v181
s_waitcnt vmcnt(16) lgkmcnt(7)
s_nop 0
v_mfma_f32_32x32x16_bf16 v[32:47], v[224:227], a[112:115], v[32:47]
ds_write_b32 v31, v196 offset:39936
ds_write_b64 v30, v[184:185] offset:12288
v_cvt_pk_bf16_f32 v186, v156, v157
v_cvt_pk_bf16_f32 v187, v158, v159
v_fma_f32 v160, v160, v180, v181
v_fma_f32 v161, v161, v180, v181
v_fma_f32 v162, v162, v180, v181
s_waitcnt vmcnt(15) lgkmcnt(8)
s_nop 0
v_mfma_f32_32x32x16_bf16 v[32:47], v[228:231], a[116:119], v[32:47]
buffer_load_dwordx4 a[180:183], v3, s[32:35], s53 offen offset:1024 sc1
ds_write_b64 v30, v[186:187] offset:13312
v_fma_f32 v163, v163, v180, v181
v_cvt_pk_bf16_f32 v188, v160, v161
s_waitcnt vmcnt(15) lgkmcnt(8)
s_nop 0
v_mfma_f32_32x32x16_bf16 v[32:47], v[232:235], a[120:123], v[32:47]
v_cvt_pk_bf16_f32 v189, v162, v163
v_fma_f32 v164, v164, v182, v183
v_fma_f32 v165, v165, v182, v183
v_fma_f32 v166, v166, v182, v183
v_fma_f32 v167, v167, v182, v183
s_waitcnt vmcnt(14) lgkmcnt(7)
s_nop 0
v_mfma_f32_32x32x16_bf16 v[32:47], v[236:239], a[124:127], v[32:47]
ds_write_b64 v30, v[188:189] offset:14336
v_cvt_pk_bf16_f32 v190, v164, v165
v_cvt_pk_bf16_f32 v191, v166, v167
v_fma_f32 v168, v168, v182, v183
v_fma_f32 v169, v169, v182, v183
v_fma_f32 v170, v170, v182, v183
s_waitcnt vmcnt(13) lgkmcnt(7)
s_nop 0
v_mfma_f32_32x32x16_bf16 v[32:47], v[240:243], a[128:131], v[32:47]
ds_write_b64 v30, v[190:191] offset:12544
v_fma_f32 v171, v171, v182, v183
v_cvt_pk_bf16_f32 v192, v168, v169
v_cvt_pk_bf16_f32 v193, v170, v171
v_fma_f32 v172, v172, v182, v183
s_waitcnt vmcnt(12) lgkmcnt(7)
s_nop 0
v_mfma_f32_32x32x16_bf16 v[32:47], v[244:247], a[132:135], v[32:47]
buffer_load_dwordx4 a[184:187], v3, s[32:35], s53 offen offset:2048 sc1
ds_write_b64 v30, v[192:193] offset:13568
v_fma_f32 v173, v173, v182, v183
v_fma_f32 v174, v174, v182, v183
v_fma_f32 v175, v175, v182, v183
s_waitcnt vmcnt(12) lgkmcnt(7)
s_nop 0
v_mfma_f32_32x32x16_bf16 v[32:47], v[248:251], a[136:139], v[32:47]
v_cvt_pk_bf16_f32 v194, v172, v173
v_cvt_pk_bf16_f32 v195, v174, v175
s_waitcnt vmcnt(11) lgkmcnt(6)
s_nop 0
v_mfma_f32_32x32x16_bf16 v[32:47], v[252:255], a[140:143], v[32:47]
ds_write_b64 v30, v[194:195] offset:14592
buffer_load_dwordx4 a[188:191], v3, s[32:35], s53 offen offset:3072 sc1
s_waitcnt lgkmcnt(6)
s_barrier
ds_read_b128 v[176:179], v1 offset:39936
s_add_u32 s24, s24, 384
s_addc_u32 s25, s25, 0
s_mov_b32 s26, 19267584
s_nop 3
v_pk_fma_f32 v[64:65], v[32:33], v[32:33], s[68:69]
v_pk_fma_f32 v[66:67], v[34:35], v[34:35], s[68:69]
v_pk_fma_f32 v[68:69], v[36:37], v[36:37], s[68:69]
v_pk_fma_f32 v[70:71], v[38:39], v[38:39], s[68:69]
v_pk_fma_f32 v[72:73], v[40:41], v[40:41], s[68:69]
v_pk_fma_f32 v[74:75], v[42:43], v[42:43], s[68:69]
v_pk_fma_f32 v[76:77], v[44:45], v[44:45], s[68:69]
v_pk_fma_f32 v[78:79], v[46:47], v[46:47], s[68:69]
v_pk_mul_f32 v[64:65], v[32:33], v[64:65] neg_lo:[1,0] neg_hi:[1,0]
v_pk_mul_f32 v[66:67], v[34:35], v[66:67] neg_lo:[1,0] neg_hi:[1,0]
v_pk_mul_f32 v[68:69], v[36:37], v[68:69] neg_lo:[1,0] neg_hi:[1,0]
v_pk_mul_f32 v[70:71], v[38:39], v[70:71] neg_lo:[1,0] neg_hi:[1,0]
v_pk_mul_f32 v[72:73], v[40:41], v[72:73] neg_lo:[1,0] neg_hi:[1,0]
v_pk_mul_f32 v[74:75], v[42:43], v[74:75] neg_lo:[1,0] neg_hi:[1,0]
v_pk_mul_f32 v[76:77], v[44:45], v[76:77] neg_lo:[1,0] neg_hi:[1,0]
v_pk_mul_f32 v[78:79], v[46:47], v[78:79] neg_lo:[1,0] neg_hi:[1,0]
s_waitcnt vmcnt(11)
v_mfma_f32_32x32x16_bf16 v[48:63], a[144:147], a[96:99], 0
ds_read_b128 a[96:99], v4 offset:12288
v_exp_f32 v64, v64
s_waitcnt lgkmcnt(1)
v_add_f32 v176, v176, v177
v_exp_f32 v65, v65
v_add_f32_e64 v178, v178, v179
s_waitcnt vmcnt(10)
v_mfma_f32_32x32x16_bf16 v[48:63], a[148:151], a[100:103], v[48:63]
ds_read_b128 a[100:103], v4 offset:13312
v_exp_f32 v66, v66
v_add_f32 v177, v176, v178
v_exp_f32 v67, v67
v_add_f32_e64 v176, v176, v178
s_waitcnt vmcnt(9)
v_mfma_f32_32x32x16_bf16 v[48:63], a[152:155], a[104:107], v[48:63]
ds_read_b128 a[104:107], v4 offset:14336
v_exp_f32 v68, v68
v_permlane16_swap_b32 v176, v177
v_exp_f32 v69, v69
s_waitcnt vmcnt(8)
v_mfma_f32_32x32x16_bf16 v[48:63], a[156:159], a[108:111], v[48:63]
ds_read_b128 a[108:111], v4 offset:15360
v_exp_f32 v70, v70
v_mul_f32 v176, s77, v176
v_exp_f32_e64 v71, v71
v_fma_f32 v177, v177, s76, v13
s_waitcnt vmcnt(7)
v_mfma_f32_32x32x16_bf16 v[48:63], a[160:163], a[112:115], v[48:63]
ds_read_b128 a[112:115], v4 offset:16384
v_exp_f32 v72, v72
v_fma_f32 v177, -v176, v176, v177
v_exp_f32 v73, v73
s_waitcnt vmcnt(0)
v_mfma_f32_32x32x16_bf16 v[48:63], a[164:167], a[116:119], v[48:63]
ds_read_b128 a[116:119], v4 offset:17408
v_exp_f32 v74, v74
v_max_f32 v177, v177, v13
v_rsq_f32 v180, v177
v_exp_f32 v75, v75
v_mul_f32 v176, s78, v176
v_mov_b32 v182, v180
v_exp_f32 v76, v76
v_mul_f32 v181, v176, v180
v_exp_f32 v77, v77
v_mul_f32 v183, v176, v180
v_exp_f32 v78, v78
v_permlane32_swap_b32 v180, v182
v_exp_f32 v79, v79
v_permlane32_swap_b32 v181, v183
v_pk_add_f32 v[64:65], v[64:65], s[70:71]
v_pk_add_f32 v[66:67], v[66:67], s[70:71]
v_pk_add_f32 v[68:69], v[68:69], s[70:71]
v_pk_add_f32 v[70:71], v[70:71], s[70:71]
v_pk_add_f32 v[72:73], v[72:73], s[70:71]
v_pk_add_f32 v[74:75], v[74:75], s[70:71]
v_pk_add_f32 v[76:77], v[76:77], s[70:71]
v_pk_add_f32 v[78:79], v[78:79], s[70:71]
v_pk_fma_f32 v[104:105], v[104:105], v[180:181], v[180:181] op_sel:[0,0,1] op_sel_hi:[1,0,1]
v_pk_fma_f32 v[106:107], v[106:107], v[180:181], v[180:181] op_sel:[0,0,1] op_sel_hi:[1,0,1]
v_pk_fma_f32 v[108:109], v[108:109], v[180:181], v[180:181] op_sel:[0,0,1] op_sel_hi:[1,0,1]
v_pk_fma_f32 v[110:111], v[110:111], v[180:181], v[180:181] op_sel:[0,0,1] op_sel_hi:[1,0,1]
v_pk_fma_f32 v[112:113], v[112:113], v[180:181], v[180:181] op_sel:[0,0,1] op_sel_hi:[1,0,1]
v_pk_fma_f32 v[114:115], v[114:115], v[180:181], v[180:181] op_sel:[0,0,1] op_sel_hi:[1,0,1]
v_pk_fma_f32 v[116:117], v[116:117], v[182:183], v[182:183] op_sel:[0,0,1] op_sel_hi:[1,0,1]
v_pk_fma_f32 v[118:119], v[118:119], v[182:183], v[182:183] op_sel:[0,0,1] op_sel_hi:[1,0,1]
v_pk_fma_f32 v[120:121], v[120:121], v[182:183], v[182:183] op_sel:[0,0,1] op_sel_hi:[1,0,1]
v_pk_fma_f32 v[122:123], v[122:123], v[182:183], v[182:183] op_sel:[0,0,1] op_sel_hi:[1,0,1]
v_pk_fma_f32 v[124:125], v[124:125], v[182:183], v[182:183] op_sel:[0,0,1] op_sel_hi:[1,0,1]
v_pk_fma_f32 v[126:127], v[126:127], v[182:183], v[182:183] op_sel:[0,0,1] op_sel_hi:[1,0,1]
v_mfma_f32_32x32x16_bf16 v[48:63], a[168:171], a[120:123], v[48:63]
ds_read_b128 a[120:123], v4 offset:18432
v_rcp_f32_e64 v64, v64
v_cvt_pk_bf16_f32 v184, v104, v105
v_rcp_f32_e64 v65, v65
v_cvt_pk_bf16_f32 v185, v106, v107
v_mfma_f32_32x32x16_bf16 v[48:63], a[172:175], a[124:127], v[48:63]
ds_read_b128 a[124:127], v4 offset:19456
ds_write_b64 v30, v[184:185] offset:24576
v_rcp_f32 v66, v66
v_rcp_f32 v67, v67
v_mfma_f32_32x32x16_bf16 v[48:63], a[176:179], a[128:131], v[48:63]
ds_read_b128 a[128:131], v4 offset:20480
v_rcp_f32_e64 v68, v68
v_cvt_pk_bf16_f32 v186, v108, v109
v_rcp_f32_e64 v69, v69
v_cvt_pk_bf16_f32 v187, v110, v111
v_mfma_f32_32x32x16_bf16 v[48:63], a[180:183], a[132:135], v[48:63]
ds_read_b128 a[132:135], v4 offset:21504
ds_write_b64 v30, v[186:187] offset:25600
v_rcp_f32 v70, v70
v_rcp_f32 v71, v71
v_mfma_f32_32x32x16_bf16 v[48:63], a[184:187], a[136:139], v[48:63]
ds_read_b128 a[136:139], v4 offset:22528
v_rcp_f32_e64 v72, v72
v_cvt_pk_bf16_f32 v188, v112, v113
v_rcp_f32 v73, v73
s_waitcnt lgkmcnt(7)
v_mfma_f32_32x32x16_bf16 v[48:63], a[188:191], a[140:143], v[48:63]
ds_read_b128 a[140:143], v4 offset:23552
v_rcp_f32_e64 v74, v74
v_cvt_pk_bf16_f32 v189, v114, v115
ds_write_b64 v30, v[188:189] offset:26624
v_rcp_f32_e64 v75, v75
v_cvt_pk_bf16_f32 v190, v116, v117
v_cvt_pk_bf16_f32 v191, v118, v119
v_rcp_f32_e64 v76, v76
ds_write_b64 v30, v[190:191] offset:24832
v_cvt_pk_bf16_f32 v192, v120, v121
v_rcp_f32_e64 v77, v77
v_cvt_pk_bf16_f32 v193, v122, v123
ds_write_b64 v30, v[192:193] offset:25856
v_rcp_f32_e64 v78, v78
v_cvt_pk_bf16_f32 v194, v124, v125
v_cvt_pk_bf16_f32 v195, v126, v127
v_rcp_f32_e64 v79, v79
ds_write_b64 v30, v[194:195] offset:26880
v_pk_mul_f32 v[64:65], v[32:33], v[64:65]
v_pk_mul_f32 v[66:67], v[34:35], v[66:67]
v_pk_mul_f32 v[68:69], v[36:37], v[68:69]
v_pk_mul_f32 v[70:71], v[38:39], v[70:71]
v_pk_mul_f32 v[72:73], v[40:41], v[72:73]
v_pk_mul_f32 v[74:75], v[42:43], v[74:75]
v_pk_mul_f32 v[76:77], v[44:45], v[76:77]
v_pk_mul_f32 v[78:79], v[46:47], v[78:79]
v_pk_mul_f32 v[16:17], v[64:65], v[64:65]
v_pk_mul_f32 v[18:19], v[66:67], v[66:67]
v_pk_mul_f32 v[20:21], v[68:69], v[68:69]
v_pk_mul_f32 v[22:23], v[70:71], v[70:71]
v_pk_mul_f32 v[24:25], v[72:73], v[72:73]
v_pk_mul_f32 v[26:27], v[74:75], v[74:75]
v_pk_mul_f32 v[28:29], v[76:77], v[76:77]
v_pk_mul_f32 v[30:31], v[78:79], v[78:79]
v_pk_fma_f32 v[80:81], v[48:49], v[48:49], s[68:69]
v_pk_fma_f32 v[82:83], v[50:51], v[50:51], s[68:69]
v_pk_fma_f32 v[84:85], v[52:53], v[52:53], s[68:69]
v_pk_fma_f32 v[86:87], v[54:55], v[54:55], s[68:69]
v_pk_fma_f32 v[88:89], v[56:57], v[56:57], s[68:69]
v_pk_fma_f32 v[90:91], v[58:59], v[58:59], s[68:69]
v_pk_fma_f32 v[92:93], v[60:61], v[60:61], s[68:69]
v_pk_fma_f32 v[94:95], v[62:63], v[62:63], s[68:69]
v_pk_mul_f32 v[80:81], v[48:49], v[80:81] neg_lo:[1,0] neg_hi:[1,0]
v_pk_mul_f32 v[82:83], v[50:51], v[82:83] neg_lo:[1,0] neg_hi:[1,0]
v_pk_mul_f32 v[84:85], v[52:53], v[84:85] neg_lo:[1,0] neg_hi:[1,0]
v_pk_mul_f32 v[86:87], v[54:55], v[86:87] neg_lo:[1,0] neg_hi:[1,0]
v_pk_mul_f32 v[88:89], v[56:57], v[88:89] neg_lo:[1,0] neg_hi:[1,0]
v_pk_mul_f32 v[90:91], v[58:59], v[90:91] neg_lo:[1,0] neg_hi:[1,0]
v_pk_mul_f32 v[92:93], v[60:61], v[92:93] neg_lo:[1,0] neg_hi:[1,0]
v_pk_mul_f32 v[94:95], v[62:63], v[94:95] neg_lo:[1,0] neg_hi:[1,0]
s_waitcnt lgkmcnt(0)
s_barrier
v_mfma_f32_32x32x16_bf16 v[32:47], v[208:211], a[96:99], 0
v_exp_f32_e64 v80, v80
v_cvt_pk_bf16_f32 v64, v64, v65
v_exp_f32_e64 v81, v81
v_cvt_pk_bf16_f32 v65, v66, v67
v_mfma_f32_32x32x16_bf16 v[32:47], v[212:215], a[100:103], v[32:47]
v_exp_f32_e64 v82, v82
v_cvt_pk_bf16_f32 v66, v68, v69
v_exp_f32_e64 v83, v83
v_cvt_pk_bf16_f32 v67, v70, v71
v_mfma_f32_32x32x16_bf16 v[32:47], v[216:219], a[104:107], v[32:47]
ds_write_b128 v5, v[64:67] offset:0
v_exp_f32_e64 v84, v84
v_mfma_f32_32x32x16_bf16 v[32:47], v[220:223], a[108:111], v[32:47]
v_exp_f32 v85, v85
v_exp_f32 v86, v86
v_exp_f32_e64 v87, v87
v_mfma_f32_32x32x16_bf16 v[32:47], v[224:227], a[112:115], v[32:47]
buffer_load_dwordx4 a[0:3], v1, s[32:35], s54 offen offset:0 sc1
v_exp_f32 v88, v88
v_exp_f32 v89, v89
v_mfma_f32_32x32x16_bf16 v[32:47], v[228:231], a[116:119], v[32:47]
buffer_load_dwordx4 a[4:7], v1, s[32:35], s54 offen offset:1024 sc1
v_exp_f32 v90, v90
v_exp_f32 v91, v91
v_exp_f32 v92, v92
v_exp_f32 v93, v93
v_exp_f32 v94, v94
v_exp_f32 v95, v95
v_pk_add_f32 v[80:81], v[80:81], s[70:71]
v_pk_add_f32 v[82:83], v[82:83], s[70:71]
v_pk_add_f32 v[84:85], v[84:85], s[70:71]
v_pk_add_f32 v[86:87], v[86:87], s[70:71]
v_pk_add_f32 v[88:89], v[88:89], s[70:71]
v_pk_add_f32 v[90:91], v[90:91], s[70:71]
v_pk_add_f32 v[92:93], v[92:93], s[70:71]
v_pk_add_f32 v[94:95], v[94:95], s[70:71]
v_mfma_f32_32x32x16_bf16 v[32:47], v[232:235], a[120:123], v[32:47]
v_rcp_f32_e64 v80, v80
v_cvt_pk_bf16_f32 v68, v72, v73
v_rcp_f32_e64 v81, v81
v_cvt_pk_bf16_f32 v69, v74, v75
v_mfma_f32_32x32x16_bf16 v[32:47], v[236:239], a[124:127], v[32:47]
v_rcp_f32_e64 v82, v82
v_cvt_pk_bf16_f32 v70, v76, v77
v_rcp_f32_e64 v83, v83
v_cvt_pk_bf16_f32 v71, v78, v79
v_mfma_f32_32x32x16_bf16 v[32:47], v[240:243], a[128:131], v[32:47]
ds_write_b128 v5, v[68:71] offset:512
v_rcp_f32_e64 v84, v84
v_mfma_f32_32x32x16_bf16 v[32:47], v[244:247], a[132:135], v[32:47]
v_rcp_f32 v85, v85
v_rcp_f32 v86, v86
v_rcp_f32_e64 v87, v87
v_mfma_f32_32x32x16_bf16 v[32:47], v[248:251], a[136:139], v[32:47]
buffer_load_dwordx4 a[8:11], v1, s[32:35], s54 offen offset:2048 sc1
v_rcp_f32 v88, v88
v_rcp_f32 v89, v89
v_mfma_f32_32x32x16_bf16 v[32:47], v[252:255], a[140:143], v[32:47]
buffer_load_dwordx4 a[12:15], v1, s[32:35], s54 offen offset:3072 sc1
v_rcp_f32 v90, v90
v_rcp_f32 v91, v91
v_rcp_f32 v92, v92
v_rcp_f32 v93, v93
v_rcp_f32 v94, v94
v_rcp_f32 v95, v95
v_pk_mul_f32 v[80:81], v[48:49], v[80:81]
v_pk_mul_f32 v[82:83], v[50:51], v[82:83]
v_pk_mul_f32 v[84:85], v[52:53], v[84:85]
v_pk_mul_f32 v[86:87], v[54:55], v[86:87]
v_pk_mul_f32 v[88:89], v[56:57], v[88:89]
v_pk_mul_f32 v[90:91], v[58:59], v[90:91]
v_pk_mul_f32 v[92:93], v[60:61], v[92:93]
v_pk_mul_f32 v[94:95], v[62:63], v[94:95]
v_pk_mul_f32 v[192:193], v[80:81], v[80:81]
v_pk_mul_f32 v[194:195], v[82:83], v[82:83]
v_pk_mul_f32 v[196:197], v[84:85], v[84:85]
v_pk_mul_f32 v[198:199], v[86:87], v[86:87]
v_pk_mul_f32 v[200:201], v[88:89], v[88:89]
v_pk_mul_f32 v[202:203], v[90:91], v[90:91]
v_pk_mul_f32 v[204:205], v[92:93], v[92:93]
v_pk_mul_f32 v[206:207], v[94:95], v[94:95]
v_pk_fma_f32 v[64:65], v[32:33], v[32:33], s[68:69]
v_pk_fma_f32 v[66:67], v[34:35], v[34:35], s[68:69]
v_pk_fma_f32 v[68:69], v[36:37], v[36:37], s[68:69]
v_pk_fma_f32 v[70:71], v[38:39], v[38:39], s[68:69]
v_pk_fma_f32 v[72:73], v[40:41], v[40:41], s[68:69]
v_pk_fma_f32 v[74:75], v[42:43], v[42:43], s[68:69]
v_pk_fma_f32 v[76:77], v[44:45], v[44:45], s[68:69]
v_pk_fma_f32 v[78:79], v[46:47], v[46:47], s[68:69]
v_pk_mul_f32 v[64:65], v[32:33], v[64:65] neg_lo:[1,0] neg_hi:[1,0]
v_pk_mul_f32 v[66:67], v[34:35], v[66:67] neg_lo:[1,0] neg_hi:[1,0]
v_pk_mul_f32 v[68:69], v[36:37], v[68:69] neg_lo:[1,0] neg_hi:[1,0]
v_pk_mul_f32 v[70:71], v[38:39], v[70:71] neg_lo:[1,0] neg_hi:[1,0]
v_pk_mul_f32 v[72:73], v[40:41], v[72:73] neg_lo:[1,0] neg_hi:[1,0]
v_pk_mul_f32 v[74:75], v[42:43], v[74:75] neg_lo:[1,0] neg_hi:[1,0]
v_pk_mul_f32 v[76:77], v[44:45], v[76:77] neg_lo:[1,0] neg_hi:[1,0]
v_pk_mul_f32 v[78:79], v[46:47], v[78:79] neg_lo:[1,0] neg_hi:[1,0]
v_mfma_f32_32x32x16_bf16 v[48:63], a[144:147], a[96:99], 0
ds_read_b128 a[96:99], v4 offset:24576
v_exp_f32_e64 v64, v64
v_cvt_pk_bf16_f32 v96, v80, v81
v_exp_f32_e64 v65, v65
v_mfma_f32_32x32x16_bf16 v[48:63], a[148:151], a[100:103], v[48:63]
ds_read_b128 a[100:103], v4 offset:25600
v_exp_f32_e64 v66, v66
v_cvt_pk_bf16_f32 v97, v82, v83
v_exp_f32_e64 v67, v67
v_mfma_f32_32x32x16_bf16 v[48:63], a[152:155], a[104:107], v[48:63]
ds_read_b128 a[104:107], v4 offset:26624
v_exp_f32_e64 v68, v68
v_cvt_pk_bf16_f32 v98, v84, v85
v_exp_f32_e64 v69, v69
v_mfma_f32_32x32x16_bf16 v[48:63], a[156:159], a[108:111], v[48:63]
ds_read_b128 a[108:111], v4 offset:27648
v_exp_f32_e64 v70, v70
v_cvt_pk_bf16_f32 v99, v86, v87
v_exp_f32_e64 v71, v71
v_mfma_f32_32x32x16_bf16 v[48:63], a[160:163], a[112:115], v[48:63]
ds_read_b128 a[112:115], v4 offset:28672
v_exp_f32 v72, v72
v_exp_f32 v73, v73
v_mfma_f32_32x32x16_bf16 v[48:63], a[164:167], a[116:119], v[48:63]
ds_read_b128 a[116:119], v4 offset:29696
v_exp_f32 v74, v74
v_exp_f32 v75, v75
v_exp_f32 v76, v76
v_exp_f32 v77, v77
v_exp_f32 v78, v78
v_exp_f32 v79, v79
v_pk_add_f32 v[64:65], v[64:65], s[70:71]
v_pk_add_f32 v[66:67], v[66:67], s[70:71]
v_pk_add_f32 v[68:69], v[68:69], s[70:71]
v_pk_add_f32 v[70:71], v[70:71], s[70:71]
v_pk_add_f32 v[72:73], v[72:73], s[70:71]
v_pk_add_f32 v[74:75], v[74:75], s[70:71]
v_pk_add_f32 v[76:77], v[76:77], s[70:71]
v_pk_add_f32 v[78:79], v[78:79], s[70:71]
v_mfma_f32_32x32x16_bf16 v[48:63], a[168:171], a[120:123], v[48:63]
ds_read_b128 a[120:123], v4 offset:30720
v_rcp_f32_e64 v64, v64
v_cvt_pk_bf16_f32 v100, v88, v89
v_rcp_f32_e64 v65, v65
v_mfma_f32_32x32x16_bf16 v[48:63], a[172:175], a[124:127], v[48:63]
ds_read_b128 a[124:127], v4 offset:31744
v_rcp_f32_e64 v66, v66
v_cvt_pk_bf16_f32 v101, v90, v91
v_rcp_f32_e64 v67, v67
v_mfma_f32_32x32x16_bf16 v[48:63], a[176:179], a[128:131], v[48:63]
ds_read_b128 a[128:131], v4 offset:32768
v_rcp_f32_e64 v68, v68
v_cvt_pk_bf16_f32 v102, v92, v93
v_rcp_f32_e64 v69, v69
v_mfma_f32_32x32x16_bf16 v[48:63], a[180:183], a[132:135], v[48:63]
ds_read_b128 a[132:135], v4 offset:33792
v_rcp_f32_e64 v70, v70
v_cvt_pk_bf16_f32 v103, v94, v95
v_rcp_f32_e64 v71, v71
v_mfma_f32_32x32x16_bf16 v[48:63], a[184:187], a[136:139], v[48:63]
ds_read_b128 a[136:139], v4 offset:34816
v_rcp_f32 v72, v72
v_rcp_f32_e64 v73, v73
s_waitcnt lgkmcnt(5)
v_mfma_f32_32x32x16_bf16 v[48:63], a[188:191], a[140:143], v[48:63]
ds_read_b128 a[140:143], v4 offset:35840
v_rcp_f32 v74, v74
v_rcp_f32 v75, v75
v_rcp_f32 v76, v76
v_rcp_f32 v77, v77
v_rcp_f32 v78, v78
v_rcp_f32 v79, v79
v_pk_mul_f32 v[64:65], v[32:33], v[64:65]
v_pk_mul_f32 v[66:67], v[34:35], v[66:67]
v_pk_mul_f32 v[68:69], v[36:37], v[68:69]
v_pk_mul_f32 v[70:71], v[38:39], v[70:71]
v_pk_mul_f32 v[72:73], v[40:41], v[72:73]
v_pk_mul_f32 v[74:75], v[42:43], v[74:75]
v_pk_mul_f32 v[76:77], v[44:45], v[76:77]
v_pk_mul_f32 v[78:79], v[46:47], v[78:79]
v_pk_fma_f32 v[16:17], v[64:65], v[64:65], v[16:17]
v_pk_fma_f32 v[18:19], v[66:67], v[66:67], v[18:19]
v_pk_fma_f32 v[20:21], v[68:69], v[68:69], v[20:21]
v_pk_fma_f32 v[22:23], v[70:71], v[70:71], v[22:23]
v_pk_fma_f32 v[24:25], v[72:73], v[72:73], v[24:25]
v_pk_fma_f32 v[26:27], v[74:75], v[74:75], v[26:27]
v_pk_fma_f32 v[28:29], v[76:77], v[76:77], v[28:29]
v_pk_fma_f32 v[30:31], v[78:79], v[78:79], v[30:31]
v_pk_fma_f32 v[80:81], v[48:49], v[48:49], s[68:69]
v_pk_fma_f32 v[82:83], v[50:51], v[50:51], s[68:69]
v_pk_fma_f32 v[84:85], v[52:53], v[52:53], s[68:69]
v_pk_fma_f32 v[86:87], v[54:55], v[54:55], s[68:69]
v_pk_fma_f32 v[88:89], v[56:57], v[56:57], s[68:69]
v_pk_fma_f32 v[90:91], v[58:59], v[58:59], s[68:69]
v_pk_fma_f32 v[92:93], v[60:61], v[60:61], s[68:69]
v_pk_fma_f32 v[94:95], v[62:63], v[62:63], s[68:69]
v_pk_mul_f32 v[80:81], v[48:49], v[80:81] neg_lo:[1,0] neg_hi:[1,0]
v_pk_mul_f32 v[82:83], v[50:51], v[82:83] neg_lo:[1,0] neg_hi:[1,0]
v_pk_mul_f32 v[84:85], v[52:53], v[84:85] neg_lo:[1,0] neg_hi:[1,0]
v_pk_mul_f32 v[86:87], v[54:55], v[86:87] neg_lo:[1,0] neg_hi:[1,0]
v_pk_mul_f32 v[88:89], v[56:57], v[88:89] neg_lo:[1,0] neg_hi:[1,0]
v_pk_mul_f32 v[90:91], v[58:59], v[90:91] neg_lo:[1,0] neg_hi:[1,0]
v_pk_mul_f32 v[92:93], v[60:61], v[92:93] neg_lo:[1,0] neg_hi:[1,0]
v_pk_mul_f32 v[94:95], v[62:63], v[94:95] neg_lo:[1,0] neg_hi:[1,0]
v_mfma_f32_32x32x16_bf16 v[32:47], v[208:211], a[96:99], 0
v_exp_f32_e64 v80, v80
v_cvt_pk_bf16_f32 v64, v64, v65
v_exp_f32_e64 v81, v81
v_cvt_pk_bf16_f32 v65, v66, v67
v_mfma_f32_32x32x16_bf16 v[32:47], v[212:215], a[100:103], v[32:47]
v_exp_f32_e64 v82, v82
v_cvt_pk_bf16_f32 v66, v68, v69
v_exp_f32_e64 v83, v83
v_cvt_pk_bf16_f32 v67, v70, v71
v_mfma_f32_32x32x16_bf16 v[32:47], v[216:219], a[104:107], v[32:47]
ds_write_b128 v5, v[64:67] offset:2048
v_exp_f32_e64 v84, v84
v_mfma_f32_32x32x16_bf16 v[32:47], v[220:223], a[108:111], v[32:47]
v_exp_f32 v85, v85
v_exp_f32 v86, v86
v_exp_f32_e64 v87, v87
v_mfma_f32_32x32x16_bf16 v[32:47], v[224:227], a[112:115], v[32:47]
buffer_load_dwordx4 a[16:19], v2, s[32:35], s54 offen offset:0 sc1
v_exp_f32 v88, v88
v_exp_f32_e64 v89, v89
s_waitcnt lgkmcnt(1)
v_mfma_f32_32x32x16_bf16 v[32:47], v[228:231], a[116:119], v[32:47]
buffer_load_dwordx4 a[20:23], v2, s[32:35], s54 offen offset:1024 sc1
v_exp_f32 v90, v90
v_exp_f32 v91, v91
v_exp_f32 v92, v92
v_exp_f32 v93, v93
v_exp_f32 v94, v94
v_exp_f32 v95, v95
v_pk_add_f32 v[80:81], v[80:81], s[70:71]
v_pk_add_f32 v[82:83], v[82:83], s[70:71]
v_pk_add_f32 v[84:85], v[84:85], s[70:71]
v_pk_add_f32 v[86:87], v[86:87], s[70:71]
v_pk_add_f32 v[88:89], v[88:89], s[70:71]
v_pk_add_f32 v[90:91], v[90:91], s[70:71]
v_pk_add_f32 v[92:93], v[92:93], s[70:71]
v_pk_add_f32 v[94:95], v[94:95], s[70:71]
v_mfma_f32_32x32x16_bf16 v[32:47], v[232:235], a[120:123], v[32:47]
v_rcp_f32_e64 v80, v80
v_cvt_pk_bf16_f32 v68, v72, v73
v_rcp_f32_e64 v81, v81
v_cvt_pk_bf16_f32 v69, v74, v75
v_mfma_f32_32x32x16_bf16 v[32:47], v[236:239], a[124:127], v[32:47]
v_rcp_f32_e64 v82, v82
v_cvt_pk_bf16_f32 v70, v76, v77
v_rcp_f32_e64 v83, v83
v_cvt_pk_bf16_f32 v71, v78, v79
v_mfma_f32_32x32x16_bf16 v[32:47], v[240:243], a[128:131], v[32:47]
ds_write_b128 v5, v[68:71] offset:2560
v_rcp_f32_e64 v84, v84
v_mfma_f32_32x32x16_bf16 v[32:47], v[244:247], a[132:135], v[32:47]
v_rcp_f32 v85, v85
v_rcp_f32 v86, v86
v_rcp_f32_e64 v87, v87
v_mfma_f32_32x32x16_bf16 v[32:47], v[248:251], a[136:139], v[32:47]
buffer_load_dwordx4 a[24:27], v2, s[32:35], s54 offen offset:2048 sc1
v_rcp_f32 v88, v88
v_rcp_f32 v89, v89
v_mfma_f32_32x32x16_bf16 v[32:47], v[252:255], a[140:143], v[32:47]
buffer_load_dwordx4 a[28:31], v2, s[32:35], s54 offen offset:3072 sc1
v_rcp_f32 v90, v90
v_rcp_f32 v91, v91
v_rcp_f32 v92, v92
v_rcp_f32 v93, v93
v_rcp_f32 v94, v94
v_rcp_f32 v95, v95
v_pk_mul_f32 v[80:81], v[48:49], v[80:81]
v_pk_mul_f32 v[82:83], v[50:51], v[82:83]
v_pk_mul_f32 v[84:85], v[52:53], v[84:85]
v_pk_mul_f32 v[86:87], v[54:55], v[86:87]
v_pk_mul_f32 v[88:89], v[56:57], v[88:89]
v_pk_mul_f32 v[90:91], v[58:59], v[90:91]
v_pk_mul_f32 v[92:93], v[60:61], v[92:93]
v_pk_mul_f32 v[94:95], v[62:63], v[94:95]
v_pk_fma_f32 v[192:193], v[80:81], v[80:81], v[192:193]
v_pk_fma_f32 v[194:195], v[82:83], v[82:83], v[194:195]
v_pk_fma_f32 v[196:197], v[84:85], v[84:85], v[196:197]
v_pk_fma_f32 v[198:199], v[86:87], v[86:87], v[198:199]
v_pk_fma_f32 v[200:201], v[88:89], v[88:89], v[200:201]
v_pk_fma_f32 v[202:203], v[90:91], v[90:91], v[202:203]
v_pk_fma_f32 v[204:205], v[92:93], v[92:93], v[204:205]
v_pk_fma_f32 v[206:207], v[94:95], v[94:95], v[206:207]
v_pk_fma_f32 v[64:65], v[32:33], v[32:33], s[68:69]
v_pk_fma_f32 v[66:67], v[34:35], v[34:35], s[68:69]
v_pk_fma_f32 v[68:69], v[36:37], v[36:37], s[68:69]
v_pk_fma_f32 v[70:71], v[38:39], v[38:39], s[68:69]
v_pk_fma_f32 v[72:73], v[40:41], v[40:41], s[68:69]
v_pk_fma_f32 v[74:75], v[42:43], v[42:43], s[68:69]
v_pk_fma_f32 v[76:77], v[44:45], v[44:45], s[68:69]
v_pk_fma_f32 v[78:79], v[46:47], v[46:47], s[68:69]
v_pk_mul_f32 v[64:65], v[32:33], v[64:65] neg_lo:[1,0] neg_hi:[1,0]
v_pk_mul_f32 v[66:67], v[34:35], v[66:67] neg_lo:[1,0] neg_hi:[1,0]
v_pk_mul_f32 v[68:69], v[36:37], v[68:69] neg_lo:[1,0] neg_hi:[1,0]
v_pk_mul_f32 v[70:71], v[38:39], v[70:71] neg_lo:[1,0] neg_hi:[1,0]
v_pk_mul_f32 v[72:73], v[40:41], v[72:73] neg_lo:[1,0] neg_hi:[1,0]
v_pk_mul_f32 v[74:75], v[42:43], v[74:75] neg_lo:[1,0] neg_hi:[1,0]
v_pk_mul_f32 v[76:77], v[44:45], v[76:77] neg_lo:[1,0] neg_hi:[1,0]
v_pk_mul_f32 v[78:79], v[46:47], v[78:79] neg_lo:[1,0] neg_hi:[1,0]
v_mfma_f32_32x32x16_bf16 v[48:63], a[144:147], a[96:99], 0
ds_read_b128 a[96:99], v4 offset:36864
v_exp_f32_e64 v64, v64
v_cvt_pk_bf16_f32 v104, v80, v81
v_exp_f32_e64 v65, v65
v_mfma_f32_32x32x16_bf16 v[48:63], a[148:151], a[100:103], v[48:63]
ds_read_b128 a[100:103], v4 offset:37888
v_exp_f32_e64 v66, v66
v_cvt_pk_bf16_f32 v105, v82, v83
v_exp_f32_e64 v67, v67
v_mfma_f32_32x32x16_bf16 v[48:63], a[152:155], a[104:107], v[48:63]
ds_read_b128 a[104:107], v4 offset:38912
v_exp_f32_e64 v68, v68
v_cvt_pk_bf16_f32 v106, v84, v85
v_exp_f32_e64 v69, v69
v_mfma_f32_32x32x16_bf16 v[48:63], a[156:159], a[108:111], v[48:63]
ds_read_b128 a[108:111], v4 offset:39936
v_exp_f32_e64 v70, v70
v_cvt_pk_bf16_f32 v107, v86, v87
v_exp_f32_e64 v71, v71
v_mfma_f32_32x32x16_bf16 v[48:63], a[160:163], a[112:115], v[48:63]
ds_read_b128 a[112:115], v4 offset:40960
v_exp_f32 v72, v72
v_exp_f32 v73, v73
v_mfma_f32_32x32x16_bf16 v[48:63], a[164:167], a[116:119], v[48:63]
ds_read_b128 a[116:119], v4 offset:41984
v_exp_f32 v74, v74
v_exp_f32 v75, v75
v_exp_f32 v76, v76
v_exp_f32 v77, v77
v_exp_f32 v78, v78
v_exp_f32 v79, v79
v_pk_add_f32 v[64:65], v[64:65], s[70:71]
v_pk_add_f32 v[66:67], v[66:67], s[70:71]
v_pk_add_f32 v[68:69], v[68:69], s[70:71]
v_pk_add_f32 v[70:71], v[70:71], s[70:71]
v_pk_add_f32 v[72:73], v[72:73], s[70:71]
v_pk_add_f32 v[74:75], v[74:75], s[70:71]
v_pk_add_f32 v[76:77], v[76:77], s[70:71]
v_pk_add_f32 v[78:79], v[78:79], s[70:71]
v_mfma_f32_32x32x16_bf16 v[48:63], a[168:171], a[120:123], v[48:63]
ds_read_b128 a[120:123], v4 offset:43008
v_rcp_f32_e64 v64, v64
v_cvt_pk_bf16_f32 v108, v88, v89
v_rcp_f32_e64 v65, v65
v_mfma_f32_32x32x16_bf16 v[48:63], a[172:175], a[124:127], v[48:63]
ds_read_b128 a[124:127], v4 offset:44032
v_rcp_f32_e64 v66, v66
v_cvt_pk_bf16_f32 v109, v90, v91
v_rcp_f32_e64 v67, v67
v_mfma_f32_32x32x16_bf16 v[48:63], a[176:179], a[128:131], v[48:63]
ds_read_b128 a[128:131], v4 offset:45056
v_rcp_f32_e64 v68, v68
v_cvt_pk_bf16_f32 v110, v92, v93
v_rcp_f32_e64 v69, v69
v_mfma_f32_32x32x16_bf16 v[48:63], a[180:183], a[132:135], v[48:63]
ds_read_b128 a[132:135], v4 offset:46080
v_rcp_f32_e64 v70, v70
v_cvt_pk_bf16_f32 v111, v94, v95
v_rcp_f32_e64 v71, v71
v_mfma_f32_32x32x16_bf16 v[48:63], a[184:187], a[136:139], v[48:63]
ds_read_b128 a[136:139], v4 offset:47104
v_rcp_f32 v72, v72
v_rcp_f32_e64 v73, v73
s_waitcnt lgkmcnt(5)
v_mfma_f32_32x32x16_bf16 v[48:63], a[188:191], a[140:143], v[48:63]
ds_read_b128 a[140:143], v4 offset:48128
v_rcp_f32 v74, v74
v_rcp_f32 v75, v75
v_rcp_f32 v76, v76
v_rcp_f32 v77, v77
v_rcp_f32 v78, v78
v_rcp_f32 v79, v79
v_pk_mul_f32 v[64:65], v[32:33], v[64:65]
v_pk_mul_f32 v[66:67], v[34:35], v[66:67]
v_pk_mul_f32 v[68:69], v[36:37], v[68:69]
v_pk_mul_f32 v[70:71], v[38:39], v[70:71]
v_pk_mul_f32 v[72:73], v[40:41], v[72:73]
v_pk_mul_f32 v[74:75], v[42:43], v[74:75]
v_pk_mul_f32 v[76:77], v[44:45], v[76:77]
v_pk_mul_f32 v[78:79], v[46:47], v[78:79]
v_pk_fma_f32 v[16:17], v[64:65], v[64:65], v[16:17]
v_pk_fma_f32 v[18:19], v[66:67], v[66:67], v[18:19]
v_pk_fma_f32 v[20:21], v[68:69], v[68:69], v[20:21]
v_pk_fma_f32 v[22:23], v[70:71], v[70:71], v[22:23]
v_pk_fma_f32 v[24:25], v[72:73], v[72:73], v[24:25]
v_pk_fma_f32 v[26:27], v[74:75], v[74:75], v[26:27]
v_pk_fma_f32 v[28:29], v[76:77], v[76:77], v[28:29]
v_pk_fma_f32 v[30:31], v[78:79], v[78:79], v[30:31]
v_pk_fma_f32 v[80:81], v[48:49], v[48:49], s[68:69]
v_pk_fma_f32 v[82:83], v[50:51], v[50:51], s[68:69]
v_pk_fma_f32 v[84:85], v[52:53], v[52:53], s[68:69]
v_pk_fma_f32 v[86:87], v[54:55], v[54:55], s[68:69]
v_pk_fma_f32 v[88:89], v[56:57], v[56:57], s[68:69]
v_pk_fma_f32 v[90:91], v[58:59], v[58:59], s[68:69]
v_pk_fma_f32 v[92:93], v[60:61], v[60:61], s[68:69]
v_pk_fma_f32 v[94:95], v[62:63], v[62:63], s[68:69]
v_pk_mul_f32 v[80:81], v[48:49], v[80:81] neg_lo:[1,0] neg_hi:[1,0]
v_pk_mul_f32 v[82:83], v[50:51], v[82:83] neg_lo:[1,0] neg_hi:[1,0]
v_pk_mul_f32 v[84:85], v[52:53], v[84:85] neg_lo:[1,0] neg_hi:[1,0]
v_pk_mul_f32 v[86:87], v[54:55], v[86:87] neg_lo:[1,0] neg_hi:[1,0]
v_pk_mul_f32 v[88:89], v[56:57], v[88:89] neg_lo:[1,0] neg_hi:[1,0]
v_pk_mul_f32 v[90:91], v[58:59], v[90:91] neg_lo:[1,0] neg_hi:[1,0]
v_pk_mul_f32 v[92:93], v[60:61], v[92:93] neg_lo:[1,0] neg_hi:[1,0]
v_pk_mul_f32 v[94:95], v[62:63], v[94:95] neg_lo:[1,0] neg_hi:[1,0]
v_mfma_f32_32x32x16_bf16 v[32:47], v[208:211], a[96:99], 0
v_exp_f32_e64 v80, v80
v_cvt_pk_bf16_f32 v64, v64, v65
v_exp_f32_e64 v81, v81
v_cvt_pk_bf16_f32 v65, v66, v67
v_mfma_f32_32x32x16_bf16 v[32:47], v[212:215], a[100:103], v[32:47]
v_exp_f32_e64 v82, v82
v_cvt_pk_bf16_f32 v66, v68, v69
v_exp_f32_e64 v83, v83
v_cvt_pk_bf16_f32 v67, v70, v71
v_mfma_f32_32x32x16_bf16 v[32:47], v[216:219], a[104:107], v[32:47]
ds_write_b128 v5, v[64:67] offset:4096
v_exp_f32_e64 v84, v84
v_mfma_f32_32x32x16_bf16 v[32:47], v[220:223], a[108:111], v[32:47]
v_exp_f32 v85, v85
v_exp_f32 v86, v86
v_exp_f32_e64 v87, v87
v_mfma_f32_32x32x16_bf16 v[32:47], v[224:227], a[112:115], v[32:47]
buffer_load_dwordx4 a[32:35], v3, s[32:35], s54 offen offset:0 sc1
v_exp_f32 v88, v88
v_exp_f32_e64 v89, v89
s_waitcnt lgkmcnt(1)
v_mfma_f32_32x32x16_bf16 v[32:47], v[228:231], a[116:119], v[32:47]
buffer_load_dwordx4 a[36:39], v3, s[32:35], s54 offen offset:1024 sc1
v_exp_f32 v90, v90
v_exp_f32 v91, v91
v_exp_f32 v92, v92
v_exp_f32 v93, v93
v_exp_f32 v94, v94
v_exp_f32 v95, v95
v_pk_add_f32 v[80:81], v[80:81], s[70:71]
v_pk_add_f32 v[82:83], v[82:83], s[70:71]
v_pk_add_f32 v[84:85], v[84:85], s[70:71]
v_pk_add_f32 v[86:87], v[86:87], s[70:71]
v_pk_add_f32 v[88:89], v[88:89], s[70:71]
v_pk_add_f32 v[90:91], v[90:91], s[70:71]
v_pk_add_f32 v[92:93], v[92:93], s[70:71]
v_pk_add_f32 v[94:95], v[94:95], s[70:71]
v_mfma_f32_32x32x16_bf16 v[32:47], v[232:235], a[120:123], v[32:47]
v_rcp_f32_e64 v80, v80
v_cvt_pk_bf16_f32 v68, v72, v73
v_rcp_f32_e64 v81, v81
v_cvt_pk_bf16_f32 v69, v74, v75
v_mfma_f32_32x32x16_bf16 v[32:47], v[236:239], a[124:127], v[32:47]
v_rcp_f32_e64 v82, v82
v_cvt_pk_bf16_f32 v70, v76, v77
v_rcp_f32_e64 v83, v83
v_cvt_pk_bf16_f32 v71, v78, v79
v_mfma_f32_32x32x16_bf16 v[32:47], v[240:243], a[128:131], v[32:47]
ds_write_b128 v5, v[68:71] offset:4608
v_rcp_f32_e64 v84, v84
v_mfma_f32_32x32x16_bf16 v[32:47], v[244:247], a[132:135], v[32:47]
v_rcp_f32 v85, v85
v_rcp_f32 v86, v86
v_rcp_f32_e64 v87, v87
v_mfma_f32_32x32x16_bf16 v[32:47], v[248:251], a[136:139], v[32:47]
buffer_load_dwordx4 a[40:43], v3, s[32:35], s54 offen offset:2048 sc1
v_rcp_f32 v88, v88
v_rcp_f32 v89, v89
v_mfma_f32_32x32x16_bf16 v[32:47], v[252:255], a[140:143], v[32:47]
buffer_load_dwordx4 a[44:47], v3, s[32:35], s54 offen offset:3072 sc1
v_rcp_f32 v90, v90
v_rcp_f32 v91, v91
v_rcp_f32 v92, v92
v_rcp_f32 v93, v93
v_rcp_f32 v94, v94
v_rcp_f32 v95, v95
v_pk_mul_f32 v[80:81], v[48:49], v[80:81]
v_pk_mul_f32 v[82:83], v[50:51], v[82:83]
v_pk_mul_f32 v[84:85], v[52:53], v[84:85]
v_pk_mul_f32 v[86:87], v[54:55], v[86:87]
v_pk_mul_f32 v[88:89], v[56:57], v[88:89]
v_pk_mul_f32 v[90:91], v[58:59], v[90:91]
v_pk_mul_f32 v[92:93], v[60:61], v[92:93]
v_pk_mul_f32 v[94:95], v[62:63], v[94:95]
v_pk_fma_f32 v[192:193], v[80:81], v[80:81], v[192:193]
v_pk_fma_f32 v[194:195], v[82:83], v[82:83], v[194:195]
v_pk_fma_f32 v[196:197], v[84:85], v[84:85], v[196:197]
v_pk_fma_f32 v[198:199], v[86:87], v[86:87], v[198:199]
v_pk_fma_f32 v[200:201], v[88:89], v[88:89], v[200:201]
v_pk_fma_f32 v[202:203], v[90:91], v[90:91], v[202:203]
v_pk_fma_f32 v[204:205], v[92:93], v[92:93], v[204:205]
v_pk_fma_f32 v[206:207], v[94:95], v[94:95], v[206:207]
v_pk_fma_f32 v[64:65], v[32:33], v[32:33], s[68:69]
v_pk_fma_f32 v[66:67], v[34:35], v[34:35], s[68:69]
v_pk_fma_f32 v[68:69], v[36:37], v[36:37], s[68:69]
v_pk_fma_f32 v[70:71], v[38:39], v[38:39], s[68:69]
v_pk_fma_f32 v[72:73], v[40:41], v[40:41], s[68:69]
v_pk_fma_f32 v[74:75], v[42:43], v[42:43], s[68:69]
v_pk_fma_f32 v[76:77], v[44:45], v[44:45], s[68:69]
v_pk_fma_f32 v[78:79], v[46:47], v[46:47], s[68:69]
v_pk_mul_f32 v[64:65], v[32:33], v[64:65] neg_lo:[1,0] neg_hi:[1,0]
v_pk_mul_f32 v[66:67], v[34:35], v[66:67] neg_lo:[1,0] neg_hi:[1,0]
v_pk_mul_f32 v[68:69], v[36:37], v[68:69] neg_lo:[1,0] neg_hi:[1,0]
v_pk_mul_f32 v[70:71], v[38:39], v[70:71] neg_lo:[1,0] neg_hi:[1,0]
v_pk_mul_f32 v[72:73], v[40:41], v[72:73] neg_lo:[1,0] neg_hi:[1,0]
v_pk_mul_f32 v[74:75], v[42:43], v[74:75] neg_lo:[1,0] neg_hi:[1,0]
v_pk_mul_f32 v[76:77], v[44:45], v[76:77] neg_lo:[1,0] neg_hi:[1,0]
v_pk_mul_f32 v[78:79], v[46:47], v[78:79] neg_lo:[1,0] neg_hi:[1,0]
v_mfma_f32_32x32x16_bf16 v[48:63], a[144:147], a[96:99], 0
ds_read_b128 a[96:99], v1 offset:0
v_exp_f32_e64 v64, v64
v_cvt_pk_bf16_f32 v112, v80, v81
v_exp_f32_e64 v65, v65
v_mfma_f32_32x32x16_bf16 v[48:63], a[148:151], a[100:103], v[48:63]
ds_read_b128 a[100:103], v1 offset:1024
v_exp_f32_e64 v66, v66
v_cvt_pk_bf16_f32 v113, v82, v83
v_exp_f32_e64 v67, v67
v_mfma_f32_32x32x16_bf16 v[48:63], a[152:155], a[104:107], v[48:63]
ds_read_b128 a[104:107], v1 offset:2048
v_exp_f32_e64 v68, v68
v_cvt_pk_bf16_f32 v114, v84, v85
v_exp_f32_e64 v69, v69
v_mfma_f32_32x32x16_bf16 v[48:63], a[156:159], a[108:111], v[48:63]
ds_read_b128 a[108:111], v1 offset:3072
v_exp_f32_e64 v70, v70
v_cvt_pk_bf16_f32 v115, v86, v87
v_exp_f32_e64 v71, v71
v_mfma_f32_32x32x16_bf16 v[48:63], a[160:163], a[112:115], v[48:63]
ds_read_b128 a[112:115], v1 offset:4096
v_exp_f32 v72, v72
v_exp_f32 v73, v73
v_mfma_f32_32x32x16_bf16 v[48:63], a[164:167], a[116:119], v[48:63]
ds_read_b128 a[116:119], v1 offset:5120
v_exp_f32 v74, v74
v_exp_f32 v75, v75
v_exp_f32 v76, v76
v_exp_f32 v77, v77
v_exp_f32 v78, v78
v_exp_f32 v79, v79
v_pk_add_f32 v[64:65], v[64:65], s[70:71]
v_pk_add_f32 v[66:67], v[66:67], s[70:71]
v_pk_add_f32 v[68:69], v[68:69], s[70:71]
v_pk_add_f32 v[70:71], v[70:71], s[70:71]
v_pk_add_f32 v[72:73], v[72:73], s[70:71]
v_pk_add_f32 v[74:75], v[74:75], s[70:71]
v_pk_add_f32 v[76:77], v[76:77], s[70:71]
v_pk_add_f32 v[78:79], v[78:79], s[70:71]
v_mfma_f32_32x32x16_bf16 v[48:63], a[168:171], a[120:123], v[48:63]
ds_read_b128 a[120:123], v1 offset:6144
v_rcp_f32_e64 v64, v64
v_cvt_pk_bf16_f32 v116, v88, v89
v_rcp_f32_e64 v65, v65
v_mfma_f32_32x32x16_bf16 v[48:63], a[172:175], a[124:127], v[48:63]
ds_read_b128 a[124:127], v1 offset:7168
v_rcp_f32_e64 v66, v66
v_cvt_pk_bf16_f32 v117, v90, v91
v_rcp_f32_e64 v67, v67
v_mfma_f32_32x32x16_bf16 v[48:63], a[176:179], a[128:131], v[48:63]
ds_read_b128 a[128:131], v1 offset:8192
v_rcp_f32_e64 v68, v68
v_cvt_pk_bf16_f32 v118, v92, v93
v_rcp_f32_e64 v69, v69
v_mfma_f32_32x32x16_bf16 v[48:63], a[180:183], a[132:135], v[48:63]
ds_read_b128 a[132:135], v1 offset:9216
v_rcp_f32_e64 v70, v70
v_cvt_pk_bf16_f32 v119, v94, v95
v_rcp_f32_e64 v71, v71
v_mfma_f32_32x32x16_bf16 v[48:63], a[184:187], a[136:139], v[48:63]
ds_read_b128 a[136:139], v1 offset:10240
v_rcp_f32 v72, v72
v_rcp_f32_e64 v73, v73
s_waitcnt lgkmcnt(5)
v_mfma_f32_32x32x16_bf16 v[48:63], a[188:191], a[140:143], v[48:63]
ds_read_b128 a[140:143], v1 offset:11264
v_rcp_f32 v74, v74
v_rcp_f32 v75, v75
v_rcp_f32 v76, v76
v_rcp_f32 v77, v77
v_rcp_f32 v78, v78
v_rcp_f32 v79, v79
v_pk_mul_f32 v[64:65], v[32:33], v[64:65]
v_pk_mul_f32 v[66:67], v[34:35], v[66:67]
v_pk_mul_f32 v[68:69], v[36:37], v[68:69]
v_pk_mul_f32 v[70:71], v[38:39], v[70:71]
v_pk_mul_f32 v[72:73], v[40:41], v[72:73]
v_pk_mul_f32 v[74:75], v[42:43], v[74:75]
v_pk_mul_f32 v[76:77], v[44:45], v[76:77]
v_pk_mul_f32 v[78:79], v[46:47], v[78:79]
v_pk_fma_f32 v[16:17], v[64:65], v[64:65], v[16:17]
v_pk_fma_f32 v[18:19], v[66:67], v[66:67], v[18:19]
v_pk_fma_f32 v[20:21], v[68:69], v[68:69], v[20:21]
v_pk_fma_f32 v[22:23], v[70:71], v[70:71], v[22:23]
v_pk_fma_f32 v[24:25], v[72:73], v[72:73], v[24:25]
v_pk_fma_f32 v[26:27], v[74:75], v[74:75], v[26:27]
v_pk_fma_f32 v[28:29], v[76:77], v[76:77], v[28:29]
v_pk_fma_f32 v[30:31], v[78:79], v[78:79], v[30:31]
v_pk_fma_f32 v[80:81], v[48:49], v[48:49], s[68:69]
v_pk_fma_f32 v[82:83], v[50:51], v[50:51], s[68:69]
v_pk_fma_f32 v[84:85], v[52:53], v[52:53], s[68:69]
v_pk_fma_f32 v[86:87], v[54:55], v[54:55], s[68:69]
v_pk_fma_f32 v[88:89], v[56:57], v[56:57], s[68:69]
v_pk_fma_f32 v[90:91], v[58:59], v[58:59], s[68:69]
v_pk_fma_f32 v[92:93], v[60:61], v[60:61], s[68:69]
v_pk_fma_f32 v[94:95], v[62:63], v[62:63], s[68:69]
v_pk_mul_f32 v[80:81], v[48:49], v[80:81] neg_lo:[1,0] neg_hi:[1,0]
v_pk_mul_f32 v[82:83], v[50:51], v[82:83] neg_lo:[1,0] neg_hi:[1,0]
v_pk_mul_f32 v[84:85], v[52:53], v[84:85] neg_lo:[1,0] neg_hi:[1,0]
v_pk_mul_f32 v[86:87], v[54:55], v[86:87] neg_lo:[1,0] neg_hi:[1,0]
v_pk_mul_f32 v[88:89], v[56:57], v[88:89] neg_lo:[1,0] neg_hi:[1,0]
v_pk_mul_f32 v[90:91], v[58:59], v[90:91] neg_lo:[1,0] neg_hi:[1,0]
v_pk_mul_f32 v[92:93], v[60:61], v[92:93] neg_lo:[1,0] neg_hi:[1,0]
v_pk_mul_f32 v[94:95], v[62:63], v[94:95] neg_lo:[1,0] neg_hi:[1,0]
v_mfma_f32_32x32x16_bf16 v[32:47], v[208:211], a[96:99], 0
v_exp_f32_e64 v80, v80
v_cvt_pk_bf16_f32 v64, v64, v65
v_exp_f32_e64 v81, v81
v_cvt_pk_bf16_f32 v65, v66, v67
v_mfma_f32_32x32x16_bf16 v[32:47], v[212:215], a[100:103], v[32:47]
v_exp_f32_e64 v82, v82
v_cvt_pk_bf16_f32 v66, v68, v69
v_exp_f32_e64 v83, v83
v_cvt_pk_bf16_f32 v67, v70, v71
v_mfma_f32_32x32x16_bf16 v[32:47], v[216:219], a[104:107], v[32:47]
ds_write_b128 v5, v[64:67] offset:6144
v_exp_f32_e64 v84, v84
v_mfma_f32_32x32x16_bf16 v[32:47], v[220:223], a[108:111], v[32:47]
v_exp_f32 v85, v85
v_exp_f32 v86, v86
v_exp_f32_e64 v87, v87
v_mfma_f32_32x32x16_bf16 v[32:47], v[224:227], a[112:115], v[32:47]
buffer_load_dwordx4 a[48:51], v1, s[32:35], s55 offen offset:0 sc1
v_exp_f32 v88, v88
v_exp_f32_e64 v89, v89
s_waitcnt lgkmcnt(1)
v_mfma_f32_32x32x16_bf16 v[32:47], v[228:231], a[116:119], v[32:47]
buffer_load_dwordx4 a[52:55], v1, s[32:35], s55 offen offset:1024 sc1
v_exp_f32 v90, v90
v_exp_f32 v91, v91
v_exp_f32 v92, v92
v_exp_f32 v93, v93
v_exp_f32 v94, v94
v_exp_f32 v95, v95
v_pk_add_f32 v[80:81], v[80:81], s[70:71]
v_pk_add_f32 v[82:83], v[82:83], s[70:71]
v_pk_add_f32 v[84:85], v[84:85], s[70:71]
v_pk_add_f32 v[86:87], v[86:87], s[70:71]
v_pk_add_f32 v[88:89], v[88:89], s[70:71]
v_pk_add_f32 v[90:91], v[90:91], s[70:71]
v_pk_add_f32 v[92:93], v[92:93], s[70:71]
v_pk_add_f32 v[94:95], v[94:95], s[70:71]
v_mfma_f32_32x32x16_bf16 v[32:47], v[232:235], a[120:123], v[32:47]
v_rcp_f32_e64 v80, v80
v_cvt_pk_bf16_f32 v68, v72, v73
v_rcp_f32_e64 v81, v81
v_cvt_pk_bf16_f32 v69, v74, v75
v_mfma_f32_32x32x16_bf16 v[32:47], v[236:239], a[124:127], v[32:47]
v_rcp_f32_e64 v82, v82
v_cvt_pk_bf16_f32 v70, v76, v77
v_rcp_f32_e64 v83, v83
v_cvt_pk_bf16_f32 v71, v78, v79
v_mfma_f32_32x32x16_bf16 v[32:47], v[240:243], a[128:131], v[32:47]
ds_write_b128 v5, v[68:71] offset:6656
v_rcp_f32_e64 v84, v84
v_mfma_f32_32x32x16_bf16 v[32:47], v[244:247], a[132:135], v[32:47]
v_rcp_f32 v85, v85
v_rcp_f32 v86, v86
v_rcp_f32_e64 v87, v87
v_mfma_f32_32x32x16_bf16 v[32:47], v[248:251], a[136:139], v[32:47]
buffer_load_dwordx4 a[56:59], v1, s[32:35], s55 offen offset:2048 sc1
v_rcp_f32 v88, v88
v_rcp_f32 v89, v89
v_mfma_f32_32x32x16_bf16 v[32:47], v[252:255], a[140:143], v[32:47]
buffer_load_dwordx4 a[60:63], v1, s[32:35], s55 offen offset:3072 sc1
v_rcp_f32 v90, v90
v_rcp_f32 v91, v91
v_rcp_f32 v92, v92
v_rcp_f32 v93, v93
v_rcp_f32 v94, v94
v_rcp_f32 v95, v95
v_pk_mul_f32 v[80:81], v[48:49], v[80:81]
v_pk_mul_f32 v[82:83], v[50:51], v[82:83]
v_pk_mul_f32 v[84:85], v[52:53], v[84:85]
v_pk_mul_f32 v[86:87], v[54:55], v[86:87]
v_pk_mul_f32 v[88:89], v[56:57], v[88:89]
v_pk_mul_f32 v[90:91], v[58:59], v[90:91]
v_pk_mul_f32 v[92:93], v[60:61], v[92:93]
v_pk_mul_f32 v[94:95], v[62:63], v[94:95]
v_pk_fma_f32 v[192:193], v[80:81], v[80:81], v[192:193]
v_pk_fma_f32 v[194:195], v[82:83], v[82:83], v[194:195]
v_pk_fma_f32 v[196:197], v[84:85], v[84:85], v[196:197]
v_pk_fma_f32 v[198:199], v[86:87], v[86:87], v[198:199]
v_pk_fma_f32 v[200:201], v[88:89], v[88:89], v[200:201]
v_pk_fma_f32 v[202:203], v[90:91], v[90:91], v[202:203]
v_pk_fma_f32 v[204:205], v[92:93], v[92:93], v[204:205]
v_pk_fma_f32 v[206:207], v[94:95], v[94:95], v[206:207]
v_pk_fma_f32 v[64:65], v[32:33], v[32:33], s[68:69]
v_pk_fma_f32 v[66:67], v[34:35], v[34:35], s[68:69]
v_pk_fma_f32 v[68:69], v[36:37], v[36:37], s[68:69]
v_pk_fma_f32 v[70:71], v[38:39], v[38:39], s[68:69]
v_pk_fma_f32 v[72:73], v[40:41], v[40:41], s[68:69]
v_pk_fma_f32 v[74:75], v[42:43], v[42:43], s[68:69]
v_pk_fma_f32 v[76:77], v[44:45], v[44:45], s[68:69]
v_pk_fma_f32 v[78:79], v[46:47], v[46:47], s[68:69]
v_pk_mul_f32 v[64:65], v[32:33], v[64:65] neg_lo:[1,0] neg_hi:[1,0]
v_pk_mul_f32 v[66:67], v[34:35], v[66:67] neg_lo:[1,0] neg_hi:[1,0]
v_pk_mul_f32 v[68:69], v[36:37], v[68:69] neg_lo:[1,0] neg_hi:[1,0]
v_pk_mul_f32 v[70:71], v[38:39], v[70:71] neg_lo:[1,0] neg_hi:[1,0]
v_pk_mul_f32 v[72:73], v[40:41], v[72:73] neg_lo:[1,0] neg_hi:[1,0]
v_pk_mul_f32 v[74:75], v[42:43], v[74:75] neg_lo:[1,0] neg_hi:[1,0]
v_pk_mul_f32 v[76:77], v[44:45], v[76:77] neg_lo:[1,0] neg_hi:[1,0]
v_pk_mul_f32 v[78:79], v[46:47], v[78:79] neg_lo:[1,0] neg_hi:[1,0]
v_mfma_f32_32x32x16_bf16 v[48:63], a[144:147], a[96:99], 0
ds_read_b128 a[96:99], v1 offset:12288
v_exp_f32_e64 v64, v64
v_cvt_pk_bf16_f32 v120, v80, v81
v_exp_f32_e64 v65, v65
v_mfma_f32_32x32x16_bf16 v[48:63], a[148:151], a[100:103], v[48:63]
ds_read_b128 a[100:103], v1 offset:13312
v_exp_f32_e64 v66, v66
v_cvt_pk_bf16_f32 v121, v82, v83
v_exp_f32_e64 v67, v67
v_mfma_f32_32x32x16_bf16 v[48:63], a[152:155], a[104:107], v[48:63]
ds_read_b128 a[104:107], v1 offset:14336
v_exp_f32_e64 v68, v68
v_cvt_pk_bf16_f32 v122, v84, v85
v_exp_f32_e64 v69, v69
v_mfma_f32_32x32x16_bf16 v[48:63], a[156:159], a[108:111], v[48:63]
ds_read_b128 a[108:111], v1 offset:15360
v_exp_f32_e64 v70, v70
v_cvt_pk_bf16_f32 v123, v86, v87
v_exp_f32_e64 v71, v71
v_mfma_f32_32x32x16_bf16 v[48:63], a[160:163], a[112:115], v[48:63]
ds_read_b128 a[112:115], v1 offset:16384
v_exp_f32 v72, v72
v_exp_f32 v73, v73
v_mfma_f32_32x32x16_bf16 v[48:63], a[164:167], a[116:119], v[48:63]
ds_read_b128 a[116:119], v1 offset:17408
v_exp_f32 v74, v74
v_exp_f32 v75, v75
v_exp_f32 v76, v76
v_exp_f32 v77, v77
v_exp_f32 v78, v78
v_exp_f32 v79, v79
v_pk_add_f32 v[64:65], v[64:65], s[70:71]
v_pk_add_f32 v[66:67], v[66:67], s[70:71]
v_pk_add_f32 v[68:69], v[68:69], s[70:71]
v_pk_add_f32 v[70:71], v[70:71], s[70:71]
v_pk_add_f32 v[72:73], v[72:73], s[70:71]
v_pk_add_f32 v[74:75], v[74:75], s[70:71]
v_pk_add_f32 v[76:77], v[76:77], s[70:71]
v_pk_add_f32 v[78:79], v[78:79], s[70:71]
v_mfma_f32_32x32x16_bf16 v[48:63], a[168:171], a[120:123], v[48:63]
ds_read_b128 a[120:123], v1 offset:18432
v_rcp_f32_e64 v64, v64
v_cvt_pk_bf16_f32 v124, v88, v89
v_rcp_f32_e64 v65, v65
v_mfma_f32_32x32x16_bf16 v[48:63], a[172:175], a[124:127], v[48:63]
ds_read_b128 a[124:127], v1 offset:19456
v_rcp_f32_e64 v66, v66
v_cvt_pk_bf16_f32 v125, v90, v91
v_rcp_f32_e64 v67, v67
v_mfma_f32_32x32x16_bf16 v[48:63], a[176:179], a[128:131], v[48:63]
ds_read_b128 a[128:131], v1 offset:20480
v_rcp_f32_e64 v68, v68
v_cvt_pk_bf16_f32 v126, v92, v93
v_rcp_f32_e64 v69, v69
v_mfma_f32_32x32x16_bf16 v[48:63], a[180:183], a[132:135], v[48:63]
ds_read_b128 a[132:135], v1 offset:21504
v_rcp_f32_e64 v70, v70
v_cvt_pk_bf16_f32 v127, v94, v95
v_rcp_f32_e64 v71, v71
v_mfma_f32_32x32x16_bf16 v[48:63], a[184:187], a[136:139], v[48:63]
ds_read_b128 a[136:139], v1 offset:22528
v_rcp_f32 v72, v72
v_rcp_f32_e64 v73, v73
s_waitcnt lgkmcnt(5)
v_mfma_f32_32x32x16_bf16 v[48:63], a[188:191], a[140:143], v[48:63]
ds_read_b128 a[140:143], v1 offset:23552
v_rcp_f32 v74, v74
v_rcp_f32 v75, v75
v_rcp_f32 v76, v76
v_rcp_f32 v77, v77
v_rcp_f32 v78, v78
v_rcp_f32 v79, v79
v_pk_mul_f32 v[64:65], v[32:33], v[64:65]
v_pk_mul_f32 v[66:67], v[34:35], v[66:67]
v_pk_mul_f32 v[68:69], v[36:37], v[68:69]
v_pk_mul_f32 v[70:71], v[38:39], v[70:71]
v_pk_mul_f32 v[72:73], v[40:41], v[72:73]
v_pk_mul_f32 v[74:75], v[42:43], v[74:75]
v_pk_mul_f32 v[76:77], v[44:45], v[76:77]
v_pk_mul_f32 v[78:79], v[46:47], v[78:79]
v_pk_fma_f32 v[16:17], v[64:65], v[64:65], v[16:17]
v_pk_fma_f32 v[18:19], v[66:67], v[66:67], v[18:19]
v_pk_fma_f32 v[20:21], v[68:69], v[68:69], v[20:21]
v_pk_fma_f32 v[22:23], v[70:71], v[70:71], v[22:23]
v_pk_fma_f32 v[24:25], v[72:73], v[72:73], v[24:25]
v_pk_fma_f32 v[26:27], v[74:75], v[74:75], v[26:27]
v_pk_fma_f32 v[28:29], v[76:77], v[76:77], v[28:29]
v_pk_fma_f32 v[30:31], v[78:79], v[78:79], v[30:31]
v_pk_fma_f32 v[80:81], v[48:49], v[48:49], s[68:69]
v_pk_fma_f32 v[82:83], v[50:51], v[50:51], s[68:69]
v_pk_fma_f32 v[84:85], v[52:53], v[52:53], s[68:69]
v_pk_fma_f32 v[86:87], v[54:55], v[54:55], s[68:69]
v_pk_fma_f32 v[88:89], v[56:57], v[56:57], s[68:69]
v_pk_fma_f32 v[90:91], v[58:59], v[58:59], s[68:69]
v_pk_fma_f32 v[92:93], v[60:61], v[60:61], s[68:69]
v_pk_fma_f32 v[94:95], v[62:63], v[62:63], s[68:69]
v_pk_mul_f32 v[80:81], v[48:49], v[80:81] neg_lo:[1,0] neg_hi:[1,0]
v_pk_mul_f32 v[82:83], v[50:51], v[82:83] neg_lo:[1,0] neg_hi:[1,0]
v_pk_mul_f32 v[84:85], v[52:53], v[84:85] neg_lo:[1,0] neg_hi:[1,0]
v_pk_mul_f32 v[86:87], v[54:55], v[86:87] neg_lo:[1,0] neg_hi:[1,0]
v_pk_mul_f32 v[88:89], v[56:57], v[88:89] neg_lo:[1,0] neg_hi:[1,0]
v_pk_mul_f32 v[90:91], v[58:59], v[90:91] neg_lo:[1,0] neg_hi:[1,0]
v_pk_mul_f32 v[92:93], v[60:61], v[92:93] neg_lo:[1,0] neg_hi:[1,0]
v_pk_mul_f32 v[94:95], v[62:63], v[94:95] neg_lo:[1,0] neg_hi:[1,0]
v_mfma_f32_32x32x16_bf16 v[32:47], v[208:211], a[96:99], 0
v_exp_f32_e64 v80, v80
v_cvt_pk_bf16_f32 v64, v64, v65
v_exp_f32_e64 v81, v81
v_cvt_pk_bf16_f32 v65, v66, v67
v_mfma_f32_32x32x16_bf16 v[32:47], v[212:215], a[100:103], v[32:47]
v_exp_f32_e64 v82, v82
v_cvt_pk_bf16_f32 v66, v68, v69
v_exp_f32_e64 v83, v83
v_cvt_pk_bf16_f32 v67, v70, v71
v_mfma_f32_32x32x16_bf16 v[32:47], v[216:219], a[104:107], v[32:47]
ds_write_b128 v5, v[64:67] offset:8192
v_exp_f32_e64 v84, v84
v_mfma_f32_32x32x16_bf16 v[32:47], v[220:223], a[108:111], v[32:47]
v_exp_f32 v85, v85
v_exp_f32 v86, v86
v_exp_f32_e64 v87, v87
v_mfma_f32_32x32x16_bf16 v[32:47], v[224:227], a[112:115], v[32:47]
buffer_load_dwordx4 a[64:67], v2, s[32:35], s55 offen offset:0 sc1
v_exp_f32 v88, v88
v_exp_f32_e64 v89, v89
s_waitcnt lgkmcnt(1)
v_mfma_f32_32x32x16_bf16 v[32:47], v[228:231], a[116:119], v[32:47]
buffer_load_dwordx4 a[68:71], v2, s[32:35], s55 offen offset:1024 sc1
v_exp_f32 v90, v90
v_exp_f32 v91, v91
v_exp_f32 v92, v92
v_exp_f32 v93, v93
v_exp_f32 v94, v94
v_exp_f32 v95, v95
v_pk_add_f32 v[80:81], v[80:81], s[70:71]
v_pk_add_f32 v[82:83], v[82:83], s[70:71]
v_pk_add_f32 v[84:85], v[84:85], s[70:71]
v_pk_add_f32 v[86:87], v[86:87], s[70:71]
v_pk_add_f32 v[88:89], v[88:89], s[70:71]
v_pk_add_f32 v[90:91], v[90:91], s[70:71]
v_pk_add_f32 v[92:93], v[92:93], s[70:71]
v_pk_add_f32 v[94:95], v[94:95], s[70:71]
v_mfma_f32_32x32x16_bf16 v[32:47], v[232:235], a[120:123], v[32:47]
v_rcp_f32_e64 v80, v80
v_cvt_pk_bf16_f32 v68, v72, v73
v_rcp_f32_e64 v81, v81
v_cvt_pk_bf16_f32 v69, v74, v75
v_mfma_f32_32x32x16_bf16 v[32:47], v[236:239], a[124:127], v[32:47]
v_rcp_f32_e64 v82, v82
v_cvt_pk_bf16_f32 v70, v76, v77
v_rcp_f32_e64 v83, v83
v_cvt_pk_bf16_f32 v71, v78, v79
v_mfma_f32_32x32x16_bf16 v[32:47], v[240:243], a[128:131], v[32:47]
ds_write_b128 v5, v[68:71] offset:8704
v_rcp_f32_e64 v84, v84
v_mfma_f32_32x32x16_bf16 v[32:47], v[244:247], a[132:135], v[32:47]
v_rcp_f32 v85, v85
v_rcp_f32 v86, v86
v_rcp_f32_e64 v87, v87
v_mfma_f32_32x32x16_bf16 v[32:47], v[248:251], a[136:139], v[32:47]
buffer_load_dwordx4 a[72:75], v2, s[32:35], s55 offen offset:2048 sc1
v_rcp_f32 v88, v88
v_rcp_f32 v89, v89
v_mfma_f32_32x32x16_bf16 v[32:47], v[252:255], a[140:143], v[32:47]
buffer_load_dwordx4 a[76:79], v2, s[32:35], s55 offen offset:3072 sc1
v_rcp_f32 v90, v90
v_rcp_f32 v91, v91
v_rcp_f32 v92, v92
v_rcp_f32 v93, v93
v_rcp_f32 v94, v94
v_rcp_f32 v95, v95
v_pk_mul_f32 v[80:81], v[48:49], v[80:81]
v_pk_mul_f32 v[82:83], v[50:51], v[82:83]
v_pk_mul_f32 v[84:85], v[52:53], v[84:85]
v_pk_mul_f32 v[86:87], v[54:55], v[86:87]
v_pk_mul_f32 v[88:89], v[56:57], v[88:89]
v_pk_mul_f32 v[90:91], v[58:59], v[90:91]
v_pk_mul_f32 v[92:93], v[60:61], v[92:93]
v_pk_mul_f32 v[94:95], v[62:63], v[94:95]
v_pk_fma_f32 v[192:193], v[80:81], v[80:81], v[192:193]
v_pk_fma_f32 v[194:195], v[82:83], v[82:83], v[194:195]
v_pk_fma_f32 v[196:197], v[84:85], v[84:85], v[196:197]
v_pk_fma_f32 v[198:199], v[86:87], v[86:87], v[198:199]
v_pk_fma_f32 v[200:201], v[88:89], v[88:89], v[200:201]
v_pk_fma_f32 v[202:203], v[90:91], v[90:91], v[202:203]
v_pk_fma_f32 v[204:205], v[92:93], v[92:93], v[204:205]
v_pk_fma_f32 v[206:207], v[94:95], v[94:95], v[206:207]
v_pk_fma_f32 v[64:65], v[32:33], v[32:33], s[68:69]
v_pk_fma_f32 v[66:67], v[34:35], v[34:35], s[68:69]
v_pk_fma_f32 v[68:69], v[36:37], v[36:37], s[68:69]
v_pk_fma_f32 v[70:71], v[38:39], v[38:39], s[68:69]
v_pk_fma_f32 v[72:73], v[40:41], v[40:41], s[68:69]
v_pk_fma_f32 v[74:75], v[42:43], v[42:43], s[68:69]
v_pk_fma_f32 v[76:77], v[44:45], v[44:45], s[68:69]
v_pk_fma_f32 v[78:79], v[46:47], v[46:47], s[68:69]
v_pk_mul_f32 v[64:65], v[32:33], v[64:65] neg_lo:[1,0] neg_hi:[1,0]
v_pk_mul_f32 v[66:67], v[34:35], v[66:67] neg_lo:[1,0] neg_hi:[1,0]
v_pk_mul_f32 v[68:69], v[36:37], v[68:69] neg_lo:[1,0] neg_hi:[1,0]
v_pk_mul_f32 v[70:71], v[38:39], v[70:71] neg_lo:[1,0] neg_hi:[1,0]
v_pk_mul_f32 v[72:73], v[40:41], v[72:73] neg_lo:[1,0] neg_hi:[1,0]
v_pk_mul_f32 v[74:75], v[42:43], v[74:75] neg_lo:[1,0] neg_hi:[1,0]
v_pk_mul_f32 v[76:77], v[44:45], v[76:77] neg_lo:[1,0] neg_hi:[1,0]
v_pk_mul_f32 v[78:79], v[46:47], v[78:79] neg_lo:[1,0] neg_hi:[1,0]
v_mfma_f32_32x32x16_bf16 v[48:63], a[144:147], a[96:99], 0
ds_read_b128 a[96:99], v1 offset:24576
v_exp_f32_e64 v64, v64
v_cvt_pk_bf16_f32 v128, v80, v81
v_exp_f32_e64 v65, v65
v_mfma_f32_32x32x16_bf16 v[48:63], a[148:151], a[100:103], v[48:63]
ds_read_b128 a[100:103], v1 offset:25600
v_exp_f32_e64 v66, v66
v_cvt_pk_bf16_f32 v129, v82, v83
v_exp_f32_e64 v67, v67
v_mfma_f32_32x32x16_bf16 v[48:63], a[152:155], a[104:107], v[48:63]
ds_read_b128 a[104:107], v1 offset:26624
v_exp_f32_e64 v68, v68
v_cvt_pk_bf16_f32 v130, v84, v85
v_exp_f32_e64 v69, v69
v_mfma_f32_32x32x16_bf16 v[48:63], a[156:159], a[108:111], v[48:63]
ds_read_b128 a[108:111], v1 offset:27648
v_exp_f32_e64 v70, v70
v_cvt_pk_bf16_f32 v131, v86, v87
v_exp_f32_e64 v71, v71
v_mfma_f32_32x32x16_bf16 v[48:63], a[160:163], a[112:115], v[48:63]
ds_read_b128 a[112:115], v1 offset:28672
v_exp_f32 v72, v72
v_exp_f32 v73, v73
v_mfma_f32_32x32x16_bf16 v[48:63], a[164:167], a[116:119], v[48:63]
ds_read_b128 a[116:119], v1 offset:29696
v_exp_f32 v74, v74
v_exp_f32 v75, v75
v_exp_f32 v76, v76
v_exp_f32 v77, v77
v_exp_f32 v78, v78
v_exp_f32 v79, v79
v_pk_add_f32 v[64:65], v[64:65], s[70:71]
v_pk_add_f32 v[66:67], v[66:67], s[70:71]
v_pk_add_f32 v[68:69], v[68:69], s[70:71]
v_pk_add_f32 v[70:71], v[70:71], s[70:71]
v_pk_add_f32 v[72:73], v[72:73], s[70:71]
v_pk_add_f32 v[74:75], v[74:75], s[70:71]
v_pk_add_f32 v[76:77], v[76:77], s[70:71]
v_pk_add_f32 v[78:79], v[78:79], s[70:71]
v_mfma_f32_32x32x16_bf16 v[48:63], a[168:171], a[120:123], v[48:63]
ds_read_b128 a[120:123], v1 offset:30720
v_rcp_f32_e64 v64, v64
v_cvt_pk_bf16_f32 v132, v88, v89
v_rcp_f32_e64 v65, v65
v_mfma_f32_32x32x16_bf16 v[48:63], a[172:175], a[124:127], v[48:63]
ds_read_b128 a[124:127], v1 offset:31744
v_rcp_f32_e64 v66, v66
v_cvt_pk_bf16_f32 v133, v90, v91
v_rcp_f32_e64 v67, v67
v_mfma_f32_32x32x16_bf16 v[48:63], a[176:179], a[128:131], v[48:63]
ds_read_b128 a[128:131], v1 offset:32768
v_rcp_f32_e64 v68, v68
v_cvt_pk_bf16_f32 v134, v92, v93
v_rcp_f32_e64 v69, v69
v_mfma_f32_32x32x16_bf16 v[48:63], a[180:183], a[132:135], v[48:63]
ds_read_b128 a[132:135], v1 offset:33792
v_rcp_f32_e64 v70, v70
v_cvt_pk_bf16_f32 v135, v94, v95
v_rcp_f32_e64 v71, v71
v_mfma_f32_32x32x16_bf16 v[48:63], a[184:187], a[136:139], v[48:63]
ds_read_b128 a[136:139], v1 offset:34816
v_rcp_f32 v72, v72
v_rcp_f32_e64 v73, v73
s_waitcnt lgkmcnt(5)
v_mfma_f32_32x32x16_bf16 v[48:63], a[188:191], a[140:143], v[48:63]
ds_read_b128 a[140:143], v1 offset:35840
v_rcp_f32 v74, v74
v_rcp_f32 v75, v75
v_rcp_f32 v76, v76
v_rcp_f32 v77, v77
v_rcp_f32 v78, v78
v_rcp_f32 v79, v79
v_pk_mul_f32 v[64:65], v[32:33], v[64:65]
v_pk_mul_f32 v[66:67], v[34:35], v[66:67]
v_pk_mul_f32 v[68:69], v[36:37], v[68:69]
v_pk_mul_f32 v[70:71], v[38:39], v[70:71]
v_pk_mul_f32 v[72:73], v[40:41], v[72:73]
v_pk_mul_f32 v[74:75], v[42:43], v[74:75]
v_pk_mul_f32 v[76:77], v[44:45], v[76:77]
v_pk_mul_f32 v[78:79], v[46:47], v[78:79]
v_pk_fma_f32 v[16:17], v[64:65], v[64:65], v[16:17]
v_pk_fma_f32 v[18:19], v[66:67], v[66:67], v[18:19]
v_pk_fma_f32 v[20:21], v[68:69], v[68:69], v[20:21]
v_pk_fma_f32 v[22:23], v[70:71], v[70:71], v[22:23]
v_pk_fma_f32 v[24:25], v[72:73], v[72:73], v[24:25]
v_pk_fma_f32 v[26:27], v[74:75], v[74:75], v[26:27]
v_pk_fma_f32 v[28:29], v[76:77], v[76:77], v[28:29]
v_pk_fma_f32 v[30:31], v[78:79], v[78:79], v[30:31]
v_pk_fma_f32 v[80:81], v[48:49], v[48:49], s[68:69]
v_pk_fma_f32 v[82:83], v[50:51], v[50:51], s[68:69]
v_pk_fma_f32 v[84:85], v[52:53], v[52:53], s[68:69]
v_pk_fma_f32 v[86:87], v[54:55], v[54:55], s[68:69]
v_pk_fma_f32 v[88:89], v[56:57], v[56:57], s[68:69]
v_pk_fma_f32 v[90:91], v[58:59], v[58:59], s[68:69]
v_pk_fma_f32 v[92:93], v[60:61], v[60:61], s[68:69]
v_pk_fma_f32 v[94:95], v[62:63], v[62:63], s[68:69]
v_pk_mul_f32 v[80:81], v[48:49], v[80:81] neg_lo:[1,0] neg_hi:[1,0]
v_pk_mul_f32 v[82:83], v[50:51], v[82:83] neg_lo:[1,0] neg_hi:[1,0]
v_pk_mul_f32 v[84:85], v[52:53], v[84:85] neg_lo:[1,0] neg_hi:[1,0]
v_pk_mul_f32 v[86:87], v[54:55], v[86:87] neg_lo:[1,0] neg_hi:[1,0]
v_pk_mul_f32 v[88:89], v[56:57], v[88:89] neg_lo:[1,0] neg_hi:[1,0]
v_pk_mul_f32 v[90:91], v[58:59], v[90:91] neg_lo:[1,0] neg_hi:[1,0]
v_pk_mul_f32 v[92:93], v[60:61], v[92:93] neg_lo:[1,0] neg_hi:[1,0]
v_pk_mul_f32 v[94:95], v[62:63], v[94:95] neg_lo:[1,0] neg_hi:[1,0]
v_mfma_f32_32x32x16_bf16 v[32:47], v[208:211], a[96:99], 0
v_exp_f32_e64 v80, v80
v_cvt_pk_bf16_f32 v64, v64, v65
v_exp_f32_e64 v81, v81
v_cvt_pk_bf16_f32 v65, v66, v67
v_mfma_f32_32x32x16_bf16 v[32:47], v[212:215], a[100:103], v[32:47]
v_exp_f32_e64 v82, v82
v_cvt_pk_bf16_f32 v66, v68, v69
v_exp_f32_e64 v83, v83
v_cvt_pk_bf16_f32 v67, v70, v71
v_mfma_f32_32x32x16_bf16 v[32:47], v[216:219], a[104:107], v[32:47]
ds_write_b128 v5, v[64:67] offset:10240
v_exp_f32_e64 v84, v84
v_mfma_f32_32x32x16_bf16 v[32:47], v[220:223], a[108:111], v[32:47]
v_exp_f32 v85, v85
v_exp_f32 v86, v86
v_exp_f32_e64 v87, v87
v_mfma_f32_32x32x16_bf16 v[32:47], v[224:227], a[112:115], v[32:47]
buffer_load_dwordx4 a[80:83], v3, s[32:35], s55 offen offset:0 sc1
v_exp_f32 v88, v88
v_exp_f32_e64 v89, v89
s_waitcnt lgkmcnt(1)
v_mfma_f32_32x32x16_bf16 v[32:47], v[228:231], a[116:119], v[32:47]
buffer_load_dwordx4 a[84:87], v3, s[32:35], s55 offen offset:1024 sc1
v_exp_f32 v90, v90
v_exp_f32 v91, v91
v_exp_f32 v92, v92
v_exp_f32 v93, v93
v_exp_f32 v94, v94
v_exp_f32 v95, v95
v_pk_add_f32 v[80:81], v[80:81], s[70:71]
v_pk_add_f32 v[82:83], v[82:83], s[70:71]
v_pk_add_f32 v[84:85], v[84:85], s[70:71]
v_pk_add_f32 v[86:87], v[86:87], s[70:71]
v_pk_add_f32 v[88:89], v[88:89], s[70:71]
v_pk_add_f32 v[90:91], v[90:91], s[70:71]
v_pk_add_f32 v[92:93], v[92:93], s[70:71]
v_pk_add_f32 v[94:95], v[94:95], s[70:71]
v_mfma_f32_32x32x16_bf16 v[32:47], v[232:235], a[120:123], v[32:47]
v_rcp_f32_e64 v80, v80
v_cvt_pk_bf16_f32 v68, v72, v73
v_rcp_f32_e64 v81, v81
v_cvt_pk_bf16_f32 v69, v74, v75
v_mfma_f32_32x32x16_bf16 v[32:47], v[236:239], a[124:127], v[32:47]
v_rcp_f32_e64 v82, v82
v_cvt_pk_bf16_f32 v70, v76, v77
v_rcp_f32_e64 v83, v83
v_cvt_pk_bf16_f32 v71, v78, v79
v_mfma_f32_32x32x16_bf16 v[32:47], v[240:243], a[128:131], v[32:47]
ds_write_b128 v5, v[68:71] offset:10752
v_rcp_f32_e64 v84, v84
v_mfma_f32_32x32x16_bf16 v[32:47], v[244:247], a[132:135], v[32:47]
v_rcp_f32 v85, v85
v_rcp_f32 v86, v86
v_rcp_f32_e64 v87, v87
v_mfma_f32_32x32x16_bf16 v[32:47], v[248:251], a[136:139], v[32:47]
buffer_load_dwordx4 a[88:91], v3, s[32:35], s55 offen offset:2048 sc1
v_rcp_f32 v88, v88
v_rcp_f32 v89, v89
v_mfma_f32_32x32x16_bf16 v[32:47], v[252:255], a[140:143], v[32:47]
buffer_load_dwordx4 a[92:95], v3, s[32:35], s55 offen offset:3072 sc1
v_rcp_f32 v90, v90
v_rcp_f32 v91, v91
v_rcp_f32 v92, v92
v_rcp_f32 v93, v93
v_rcp_f32 v94, v94
v_rcp_f32 v95, v95
v_pk_mul_f32 v[80:81], v[48:49], v[80:81]
v_pk_mul_f32 v[82:83], v[50:51], v[82:83]
v_pk_mul_f32 v[84:85], v[52:53], v[84:85]
v_pk_mul_f32 v[86:87], v[54:55], v[86:87]
v_pk_mul_f32 v[88:89], v[56:57], v[88:89]
v_pk_mul_f32 v[90:91], v[58:59], v[90:91]
v_pk_mul_f32 v[92:93], v[60:61], v[92:93]
v_pk_mul_f32 v[94:95], v[62:63], v[94:95]
v_pk_fma_f32 v[192:193], v[80:81], v[80:81], v[192:193]
v_pk_fma_f32 v[194:195], v[82:83], v[82:83], v[194:195]
v_pk_fma_f32 v[196:197], v[84:85], v[84:85], v[196:197]
v_pk_fma_f32 v[198:199], v[86:87], v[86:87], v[198:199]
v_pk_fma_f32 v[200:201], v[88:89], v[88:89], v[200:201]
v_pk_fma_f32 v[202:203], v[90:91], v[90:91], v[202:203]
v_pk_fma_f32 v[204:205], v[92:93], v[92:93], v[204:205]
v_pk_fma_f32 v[206:207], v[94:95], v[94:95], v[206:207]
v_pk_fma_f32 v[64:65], v[32:33], v[32:33], s[68:69]
v_pk_fma_f32 v[66:67], v[34:35], v[34:35], s[68:69]
v_pk_fma_f32 v[68:69], v[36:37], v[36:37], s[68:69]
v_pk_fma_f32 v[70:71], v[38:39], v[38:39], s[68:69]
v_pk_fma_f32 v[72:73], v[40:41], v[40:41], s[68:69]
v_pk_fma_f32 v[74:75], v[42:43], v[42:43], s[68:69]
v_pk_fma_f32 v[76:77], v[44:45], v[44:45], s[68:69]
v_pk_fma_f32 v[78:79], v[46:47], v[46:47], s[68:69]
v_pk_mul_f32 v[64:65], v[32:33], v[64:65] neg_lo:[1,0] neg_hi:[1,0]
v_pk_mul_f32 v[66:67], v[34:35], v[66:67] neg_lo:[1,0] neg_hi:[1,0]
v_pk_mul_f32 v[68:69], v[36:37], v[68:69] neg_lo:[1,0] neg_hi:[1,0]
v_pk_mul_f32 v[70:71], v[38:39], v[70:71] neg_lo:[1,0] neg_hi:[1,0]
v_pk_mul_f32 v[72:73], v[40:41], v[72:73] neg_lo:[1,0] neg_hi:[1,0]
v_pk_mul_f32 v[74:75], v[42:43], v[74:75] neg_lo:[1,0] neg_hi:[1,0]
v_pk_mul_f32 v[76:77], v[44:45], v[76:77] neg_lo:[1,0] neg_hi:[1,0]
v_pk_mul_f32 v[78:79], v[46:47], v[78:79] neg_lo:[1,0] neg_hi:[1,0]
v_mfma_f32_32x32x16_bf16 v[48:63], a[144:147], a[96:99], 0
ds_read_b128 a[96:99], v4 offset:0
v_exp_f32_e64 v64, v64
v_cvt_pk_bf16_f32 v136, v80, v81
v_exp_f32_e64 v65, v65
v_mfma_f32_32x32x16_bf16 v[48:63], a[148:151], a[100:103], v[48:63]
ds_read_b128 a[100:103], v4 offset:1024
v_exp_f32_e64 v66, v66
v_cvt_pk_bf16_f32 v137, v82, v83
v_exp_f32_e64 v67, v67
v_mfma_f32_32x32x16_bf16 v[48:63], a[152:155], a[104:107], v[48:63]
ds_read_b128 a[104:107], v4 offset:2048
v_exp_f32_e64 v68, v68
v_cvt_pk_bf16_f32 v138, v84, v85
v_exp_f32_e64 v69, v69
v_mfma_f32_32x32x16_bf16 v[48:63], a[156:159], a[108:111], v[48:63]
ds_read_b128 a[108:111], v4 offset:3072
v_exp_f32_e64 v70, v70
v_cvt_pk_bf16_f32 v139, v86, v87
v_exp_f32_e64 v71, v71
v_mfma_f32_32x32x16_bf16 v[48:63], a[160:163], a[112:115], v[48:63]
ds_read_b128 a[112:115], v4 offset:4096
v_exp_f32 v72, v72
v_exp_f32 v73, v73
v_mfma_f32_32x32x16_bf16 v[48:63], a[164:167], a[116:119], v[48:63]
ds_read_b128 a[116:119], v4 offset:5120
v_exp_f32 v74, v74
v_exp_f32 v75, v75
v_exp_f32 v76, v76
v_exp_f32 v77, v77
v_exp_f32 v78, v78
v_exp_f32 v79, v79
v_pk_add_f32 v[64:65], v[64:65], s[70:71]
v_pk_add_f32 v[66:67], v[66:67], s[70:71]
v_pk_add_f32 v[68:69], v[68:69], s[70:71]
v_pk_add_f32 v[70:71], v[70:71], s[70:71]
v_pk_add_f32 v[72:73], v[72:73], s[70:71]
v_pk_add_f32 v[74:75], v[74:75], s[70:71]
v_pk_add_f32 v[76:77], v[76:77], s[70:71]
v_pk_add_f32 v[78:79], v[78:79], s[70:71]
v_mfma_f32_32x32x16_bf16 v[48:63], a[168:171], a[120:123], v[48:63]
ds_read_b128 a[120:123], v4 offset:6144
v_rcp_f32_e64 v64, v64
v_cvt_pk_bf16_f32 v140, v88, v89
v_rcp_f32_e64 v65, v65
v_mfma_f32_32x32x16_bf16 v[48:63], a[172:175], a[124:127], v[48:63]
ds_read_b128 a[124:127], v4 offset:7168
v_rcp_f32_e64 v66, v66
v_cvt_pk_bf16_f32 v141, v90, v91
v_rcp_f32_e64 v67, v67
v_mfma_f32_32x32x16_bf16 v[48:63], a[176:179], a[128:131], v[48:63]
ds_read_b128 a[128:131], v4 offset:8192
v_rcp_f32_e64 v68, v68
v_cvt_pk_bf16_f32 v142, v92, v93
v_rcp_f32_e64 v69, v69
v_mfma_f32_32x32x16_bf16 v[48:63], a[180:183], a[132:135], v[48:63]
ds_read_b128 a[132:135], v4 offset:9216
v_rcp_f32_e64 v70, v70
v_cvt_pk_bf16_f32 v143, v94, v95
v_rcp_f32_e64 v71, v71
v_mfma_f32_32x32x16_bf16 v[48:63], a[184:187], a[136:139], v[48:63]
ds_read_b128 a[136:139], v4 offset:10240
v_rcp_f32 v72, v72
v_rcp_f32_e64 v73, v73
s_waitcnt vmcnt(18) lgkmcnt(5)
v_mfma_f32_32x32x16_bf16 v[48:63], a[188:191], a[140:143], v[48:63]
ds_read_b128 a[140:143], v4 offset:11264
v_rcp_f32 v74, v74
v_rcp_f32 v75, v75
v_rcp_f32 v76, v76
v_rcp_f32 v77, v77
v_rcp_f32 v78, v78
v_rcp_f32 v79, v79
v_pk_mul_f32 v[64:65], v[32:33], v[64:65]
v_pk_mul_f32 v[66:67], v[34:35], v[66:67]
v_pk_mul_f32 v[68:69], v[36:37], v[68:69]
v_pk_mul_f32 v[70:71], v[38:39], v[70:71]
v_pk_mul_f32 v[72:73], v[40:41], v[72:73]
v_pk_mul_f32 v[74:75], v[42:43], v[74:75]
v_pk_mul_f32 v[76:77], v[44:45], v[76:77]
v_pk_mul_f32 v[78:79], v[46:47], v[78:79]
v_pk_fma_f32 v[16:17], v[64:65], v[64:65], v[16:17]
v_pk_fma_f32 v[18:19], v[66:67], v[66:67], v[18:19]
v_pk_fma_f32 v[20:21], v[68:69], v[68:69], v[20:21]
v_pk_fma_f32 v[22:23], v[70:71], v[70:71], v[22:23]
v_pk_fma_f32 v[24:25], v[72:73], v[72:73], v[24:25]
v_pk_fma_f32 v[26:27], v[74:75], v[74:75], v[26:27]
v_pk_fma_f32 v[28:29], v[76:77], v[76:77], v[28:29]
v_pk_fma_f32 v[30:31], v[78:79], v[78:79], v[30:31]
v_pk_fma_f32 v[80:81], v[48:49], v[48:49], s[68:69]
v_pk_fma_f32 v[82:83], v[50:51], v[50:51], s[68:69]
v_pk_fma_f32 v[84:85], v[52:53], v[52:53], s[68:69]
v_pk_fma_f32 v[86:87], v[54:55], v[54:55], s[68:69]
v_pk_fma_f32 v[88:89], v[56:57], v[56:57], s[68:69]
v_pk_fma_f32 v[90:91], v[58:59], v[58:59], s[68:69]
v_pk_fma_f32 v[92:93], v[60:61], v[60:61], s[68:69]
v_pk_fma_f32 v[94:95], v[62:63], v[62:63], s[68:69]
v_pk_mul_f32 v[80:81], v[48:49], v[80:81] neg_lo:[1,0] neg_hi:[1,0]
v_pk_mul_f32 v[82:83], v[50:51], v[82:83] neg_lo:[1,0] neg_hi:[1,0]
v_pk_mul_f32 v[84:85], v[52:53], v[84:85] neg_lo:[1,0] neg_hi:[1,0]
v_pk_mul_f32 v[86:87], v[54:55], v[86:87] neg_lo:[1,0] neg_hi:[1,0]
v_pk_mul_f32 v[88:89], v[56:57], v[88:89] neg_lo:[1,0] neg_hi:[1,0]
v_pk_mul_f32 v[90:91], v[58:59], v[90:91] neg_lo:[1,0] neg_hi:[1,0]
v_pk_mul_f32 v[92:93], v[60:61], v[92:93] neg_lo:[1,0] neg_hi:[1,0]
v_pk_mul_f32 v[94:95], v[62:63], v[94:95] neg_lo:[1,0] neg_hi:[1,0]
v_mfma_f32_32x32x16_bf16 v[32:47], a[0:3], a[96:99], 0
v_exp_f32_e64 v80, v80
v_cvt_pk_bf16_f32 v64, v64, v65
v_cvt_pk_bf16_f32 v65, v66, v67
v_exp_f32_e64 v81, v81
v_cvt_pk_bf16_f32 v66, v68, v69
v_mfma_f32_32x32x16_bf16 v[32:47], a[4:7], a[100:103], v[32:47]
v_exp_f32_e64 v82, v82
v_cvt_pk_bf16_f32 v67, v70, v71
v_mfma_f32_32x32x16_bf16 v[32:47], a[8:11], a[104:107], v[32:47]
ds_write_b128 v5, v[64:67] offset:12288
v_exp_f32_e64 v83, v83
v_add_f32_dpp v16, v16, v16 row_ror:8 row_mask:0xf bank_mask:0x3
v_add_f32_dpp v17, v17, v17 row_ror:8 row_mask:0xf bank_mask:0x3
v_exp_f32_e64 v84, v84
v_add_f32_dpp v18, v18, v18 row_ror:8 row_mask:0xf bank_mask:0x3
v_mfma_f32_32x32x16_bf16 v[32:47], a[12:15], a[108:111], v[32:47]
v_exp_f32_e64 v85, v85
v_add_f32_dpp v19, v19, v19 row_ror:8 row_mask:0xf bank_mask:0x3
v_add_f32_dpp v24, v24, v24 row_ror:8 row_mask:0xf bank_mask:0x3
v_exp_f32_e64 v86, v86
v_add_f32_dpp v25, v25, v25 row_ror:8 row_mask:0xf bank_mask:0x3
v_mfma_f32_32x32x16_bf16 v[32:47], a[16:19], a[112:115], v[32:47]
v_exp_f32_e64 v87, v87
v_add_f32_dpp v26, v26, v26 row_ror:8 row_mask:0xf bank_mask:0x3
v_exp_f32_e64 v88, v88
v_add_f32_dpp v27, v27, v27 row_ror:8 row_mask:0xf bank_mask:0x3
s_waitcnt vmcnt(12) lgkmcnt(1)
v_mfma_f32_32x32x16_bf16 v[32:47], a[20:23], a[116:119], v[32:47]
v_exp_f32 v89, v89
v_add_f32_dpp v16, v20, v20 row_ror:8 row_mask:0xf bank_mask:0xc
v_add_f32_dpp v17, v21, v21 row_ror:8 row_mask:0xf bank_mask:0xc
v_exp_f32_e64 v90, v90
v_add_f32_dpp v18, v22, v22 row_ror:8 row_mask:0xf bank_mask:0xc
v_exp_f32_e64 v91, v91
v_add_f32_dpp v19, v23, v23 row_ror:8 row_mask:0xf bank_mask:0xc
v_exp_f32_e64 v92, v92
v_add_f32_dpp v24, v28, v28 row_ror:8 row_mask:0xf bank_mask:0xc
v_exp_f32_e64 v93, v93
v_add_f32_dpp v25, v29, v29 row_ror:8 row_mask:0xf bank_mask:0xc
v_exp_f32_e64 v94, v94
v_add_f32_dpp v26, v30, v30 row_ror:8 row_mask:0xf bank_mask:0xc
v_exp_f32_e64 v95, v95
v_add_f32_dpp v27, v31, v31 row_ror:8 row_mask:0xf bank_mask:0xc
v_pk_add_f32 v[80:81], v[80:81], s[70:71]
v_pk_add_f32 v[82:83], v[82:83], s[70:71]
v_pk_add_f32 v[84:85], v[84:85], s[70:71]
v_pk_add_f32 v[86:87], v[86:87], s[70:71]
v_pk_add_f32 v[88:89], v[88:89], s[70:71]
v_pk_add_f32 v[90:91], v[90:91], s[70:71]
v_pk_add_f32 v[92:93], v[92:93], s[70:71]
v_pk_add_f32 v[94:95], v[94:95], s[70:71]
v_mfma_f32_32x32x16_bf16 v[32:47], a[24:27], a[120:123], v[32:47]
v_rcp_f32_e64 v80, v80
v_cvt_pk_bf16_f32 v68, v72, v73
v_cvt_pk_bf16_f32 v69, v74, v75
v_rcp_f32_e64 v81, v81
v_cvt_pk_bf16_f32 v70, v76, v77
v_mfma_f32_32x32x16_bf16 v[32:47], a[28:31], a[124:127], v[32:47]
v_rcp_f32_e64 v82, v82
v_cvt_pk_bf16_f32 v71, v78, v79
v_mfma_f32_32x32x16_bf16 v[32:47], a[32:35], a[128:131], v[32:47]
ds_write_b128 v5, v[68:71] offset:12800
v_rcp_f32_e64 v83, v83
v_add_f32_dpp v16, v16, v16 row_shl:4 row_mask:0xf bank_mask:0x5
v_add_f32_dpp v17, v17, v17 row_shl:4 row_mask:0xf bank_mask:0x5
v_rcp_f32_e64 v84, v84
v_add_f32_dpp v24, v24, v24 row_shl:4 row_mask:0xf bank_mask:0x5
v_mfma_f32_32x32x16_bf16 v[32:47], a[36:39], a[132:135], v[32:47]
v_rcp_f32_e64 v85, v85
v_add_f32_dpp v25, v25, v25 row_shl:4 row_mask:0xf bank_mask:0x5
v_add_f32_dpp v16, v18, v18 row_shr:4 row_mask:0xf bank_mask:0xa
v_rcp_f32_e64 v86, v86
v_add_f32_dpp v17, v19, v19 row_shr:4 row_mask:0xf bank_mask:0xa
v_mfma_f32_32x32x16_bf16 v[32:47], a[40:43], a[136:139], v[32:47]
v_rcp_f32_e64 v87, v87
v_add_f32_dpp v24, v26, v26 row_shr:4 row_mask:0xf bank_mask:0xa
v_rcp_f32_e64 v88, v88
v_add_f32_dpp v25, v27, v27 row_shr:4 row_mask:0xf bank_mask:0xa
s_waitcnt vmcnt(6)
v_mfma_f32_32x32x16_bf16 v[32:47], a[44:47], a[140:143], v[32:47]
v_rcp_f32 v89, v89
v_permlane16_swap_b32 v16, v24
v_permlane16_swap_b32 v17, v25
v_rcp_f32 v90, v90
v_add_f32 v16, v16, v24
v_add_f32 v17, v17, v25
v_rcp_f32 v91, v91
v_add_f32_dpp v16, v16, v16 quad_perm:[1,0,3,2] row_mask:0xf bank_mask:0xf
v_rcp_f32_e64 v92, v92
v_add_f32_dpp v17, v17, v17 quad_perm:[1,0,3,2] row_mask:0xf bank_mask:0xf
v_rcp_f32_e64 v93, v93
v_cndmask_b32_e64 v16, v16, v17, s[72:73]
v_rcp_f32 v94, v94
s_nop 0
v_add_f32_dpp v13, v16, v16 quad_perm:[2,3,0,1] row_mask:0xf bank_mask:0xf
v_rcp_f32_e64 v95, v95
buffer_atomic_add_f32 v13, v7, s[32:35], s66 offen offset:0 sc1
v_pk_mul_f32 v[80:81], v[48:49], v[80:81]
v_pk_mul_f32 v[82:83], v[50:51], v[82:83]
v_pk_mul_f32 v[84:85], v[52:53], v[84:85]
v_pk_mul_f32 v[86:87], v[54:55], v[86:87]
v_pk_mul_f32 v[88:89], v[56:57], v[88:89]
v_pk_mul_f32 v[90:91], v[58:59], v[90:91]
v_pk_mul_f32 v[92:93], v[60:61], v[92:93]
v_pk_mul_f32 v[94:95], v[62:63], v[94:95]
v_pk_fma_f32 v[192:193], v[80:81], v[80:81], v[192:193]
v_pk_fma_f32 v[194:195], v[82:83], v[82:83], v[194:195]
v_pk_fma_f32 v[196:197], v[84:85], v[84:85], v[196:197]
v_pk_fma_f32 v[198:199], v[86:87], v[86:87], v[198:199]
v_pk_fma_f32 v[200:201], v[88:89], v[88:89], v[200:201]
v_pk_fma_f32 v[202:203], v[90:91], v[90:91], v[202:203]
v_pk_fma_f32 v[204:205], v[92:93], v[92:93], v[204:205]
v_pk_fma_f32 v[206:207], v[94:95], v[94:95], v[206:207]
v_pk_fma_f32 v[64:65], v[32:33], v[32:33], s[68:69]
v_pk_fma_f32 v[66:67], v[34:35], v[34:35], s[68:69]
v_pk_fma_f32 v[68:69], v[36:37], v[36:37], s[68:69]
v_pk_fma_f32 v[70:71], v[38:39], v[38:39], s[68:69]
v_pk_fma_f32 v[72:73], v[40:41], v[40:41], s[68:69]
v_pk_fma_f32 v[74:75], v[42:43], v[42:43], s[68:69]
v_pk_fma_f32 v[76:77], v[44:45], v[44:45], s[68:69]
v_pk_fma_f32 v[78:79], v[46:47], v[46:47], s[68:69]
v_pk_mul_f32 v[64:65], v[32:33], v[64:65] neg_lo:[1,0] neg_hi:[1,0]
v_pk_mul_f32 v[66:67], v[34:35], v[66:67] neg_lo:[1,0] neg_hi:[1,0]
v_pk_mul_f32 v[68:69], v[36:37], v[68:69] neg_lo:[1,0] neg_hi:[1,0]
v_pk_mul_f32 v[70:71], v[38:39], v[70:71] neg_lo:[1,0] neg_hi:[1,0]
v_pk_mul_f32 v[72:73], v[40:41], v[72:73] neg_lo:[1,0] neg_hi:[1,0]
v_pk_mul_f32 v[74:75], v[42:43], v[74:75] neg_lo:[1,0] neg_hi:[1,0]
v_pk_mul_f32 v[76:77], v[44:45], v[76:77] neg_lo:[1,0] neg_hi:[1,0]
v_pk_mul_f32 v[78:79], v[46:47], v[78:79] neg_lo:[1,0] neg_hi:[1,0]
v_mfma_f32_32x32x16_bf16 v[48:63], a[48:51], a[96:99], 0
ds_read_b128 a[96:99], v4 offset:12288
v_exp_f32_e64 v64, v64
v_cvt_pk_bf16_f32 v144, v80, v81
v_exp_f32_e64 v65, v65
v_cvt_pk_bf16_f32 v145, v82, v83
v_mfma_f32_32x32x16_bf16 v[48:63], a[52:55], a[100:103], v[48:63]
ds_read_b128 a[100:103], v4 offset:13312
v_exp_f32_e64 v66, v66
v_cvt_pk_bf16_f32 v146, v84, v85
v_exp_f32_e64 v67, v67
v_cvt_pk_bf16_f32 v147, v86, v87
v_mfma_f32_32x32x16_bf16 v[48:63], a[56:59], a[104:107], v[48:63]
ds_read_b128 a[104:107], v4 offset:14336
v_exp_f32_e64 v68, v68
v_add_f32_dpp v192, v192, v192 row_ror:8 row_mask:0xf bank_mask:0x3
v_exp_f32_e64 v69, v69
v_add_f32_dpp v193, v193, v193 row_ror:8 row_mask:0xf bank_mask:0x3
v_mfma_f32_32x32x16_bf16 v[48:63], a[60:63], a[108:111], v[48:63]
ds_read_b128 a[108:111], v4 offset:15360
v_exp_f32_e64 v70, v70
v_add_f32_dpp v194, v194, v194 row_ror:8 row_mask:0xf bank_mask:0x3
v_exp_f32_e64 v71, v71
v_add_f32_dpp v195, v195, v195 row_ror:8 row_mask:0xf bank_mask:0x3
v_mfma_f32_32x32x16_bf16 v[48:63], a[64:67], a[112:115], v[48:63]
ds_read_b128 a[112:115], v4 offset:16384
v_exp_f32_e64 v72, v72
v_add_f32_dpp v200, v200, v200 row_ror:8 row_mask:0xf bank_mask:0x3
v_exp_f32 v73, v73
s_waitcnt vmcnt(1)
v_mfma_f32_32x32x16_bf16 v[48:63], a[68:71], a[116:119], v[48:63]
ds_read_b128 a[116:119], v4 offset:17408
v_exp_f32_e64 v74, v74
v_add_f32_dpp v201, v201, v201 row_ror:8 row_mask:0xf bank_mask:0x3
v_add_f32_dpp v202, v202, v202 row_ror:8 row_mask:0xf bank_mask:0x3
v_exp_f32_e64 v75, v75
v_add_f32_dpp v203, v203, v203 row_ror:8 row_mask:0xf bank_mask:0x3
v_add_f32_dpp v192, v196, v196 row_ror:8 row_mask:0xf bank_mask:0xc
v_exp_f32_e64 v76, v76
v_add_f32_dpp v193, v197, v197 row_ror:8 row_mask:0xf bank_mask:0xc
v_add_f32_dpp v194, v198, v198 row_ror:8 row_mask:0xf bank_mask:0xc
v_exp_f32_e64 v77, v77
v_add_f32_dpp v195, v199, v199 row_ror:8 row_mask:0xf bank_mask:0xc
v_add_f32_dpp v200, v204, v204 row_ror:8 row_mask:0xf bank_mask:0xc
v_exp_f32_e64 v78, v78
v_add_f32_dpp v201, v205, v205 row_ror:8 row_mask:0xf bank_mask:0xc
v_add_f32_dpp v202, v206, v206 row_ror:8 row_mask:0xf bank_mask:0xc
v_exp_f32_e64 v79, v79
v_add_f32_dpp v203, v207, v207 row_ror:8 row_mask:0xf bank_mask:0xc
v_pk_add_f32 v[64:65], v[64:65], s[70:71]
v_pk_add_f32 v[66:67], v[66:67], s[70:71]
v_pk_add_f32 v[68:69], v[68:69], s[70:71]
v_pk_add_f32 v[70:71], v[70:71], s[70:71]
v_pk_add_f32 v[72:73], v[72:73], s[70:71]
v_pk_add_f32 v[74:75], v[74:75], s[70:71]
v_pk_add_f32 v[76:77], v[76:77], s[70:71]
v_pk_add_f32 v[78:79], v[78:79], s[70:71]
v_mfma_f32_32x32x16_bf16 v[48:63], a[72:75], a[120:123], v[48:63]
ds_read_b128 a[120:123], v4 offset:18432
v_rcp_f32_e64 v64, v64
v_cvt_pk_bf16_f32 v148, v88, v89
v_rcp_f32_e64 v65, v65
v_cvt_pk_bf16_f32 v149, v90, v91
v_mfma_f32_32x32x16_bf16 v[48:63], a[76:79], a[124:127], v[48:63]
ds_read_b128 a[124:127], v4 offset:19456
v_rcp_f32_e64 v66, v66
v_cvt_pk_bf16_f32 v150, v92, v93
v_rcp_f32_e64 v67, v67
v_cvt_pk_bf16_f32 v151, v94, v95
v_mfma_f32_32x32x16_bf16 v[48:63], a[80:83], a[128:131], v[48:63]
ds_read_b128 a[128:131], v4 offset:20480
v_rcp_f32_e64 v68, v68
v_add_f32_dpp v192, v192, v192 row_shl:4 row_mask:0xf bank_mask:0x5
v_rcp_f32_e64 v69, v69
v_add_f32_dpp v193, v193, v193 row_shl:4 row_mask:0xf bank_mask:0x5
v_mfma_f32_32x32x16_bf16 v[48:63], a[84:87], a[132:135], v[48:63]
ds_read_b128 a[132:135], v4 offset:21504
v_rcp_f32_e64 v70, v70
v_add_f32_dpp v200, v200, v200 row_shl:4 row_mask:0xf bank_mask:0x5
v_rcp_f32_e64 v71, v71
v_add_f32_dpp v201, v201, v201 row_shl:4 row_mask:0xf bank_mask:0x5
v_mfma_f32_32x32x16_bf16 v[48:63], a[88:91], a[136:139], v[48:63]
ds_read_b128 a[136:139], v4 offset:22528
v_rcp_f32_e64 v72, v72
v_add_f32_dpp v192, v194, v194 row_shr:4 row_mask:0xf bank_mask:0xa
v_rcp_f32 v73, v73
s_waitcnt lgkmcnt(5)
v_mfma_f32_32x32x16_bf16 v[48:63], a[92:95], a[140:143], v[48:63]
ds_read_b128 a[140:143], v4 offset:23552
v_rcp_f32_e64 v74, v74
v_add_f32_dpp v193, v195, v195 row_shr:4 row_mask:0xf bank_mask:0xa
v_add_f32_dpp v200, v202, v202 row_shr:4 row_mask:0xf bank_mask:0xa
v_rcp_f32_e64 v75, v75
v_add_f32_dpp v201, v203, v203 row_shr:4 row_mask:0xf bank_mask:0xa
v_permlane16_swap_b32 v192, v200
v_rcp_f32 v76, v76
v_permlane16_swap_b32 v193, v201
v_add_f32 v192, v192, v200
v_rcp_f32 v77, v77
v_add_f32 v193, v193, v201
v_add_f32_dpp v192, v192, v192 quad_perm:[1,0,3,2] row_mask:0xf bank_mask:0xf
v_rcp_f32_e64 v78, v78
v_add_f32_dpp v193, v193, v193 quad_perm:[1,0,3,2] row_mask:0xf bank_mask:0xf
v_cndmask_b32_e64 v192, v192, v193, s[72:73]
v_rcp_f32 v79, v79
s_nop 0
v_add_f32_dpp v13, v192, v192 quad_perm:[2,3,0,1] row_mask:0xf bank_mask:0xf
buffer_atomic_add_f32 v13, v7, s[32:35], s66 offen offset:128 sc1
v_pk_mul_f32 v[64:65], v[32:33], v[64:65]
v_pk_mul_f32 v[66:67], v[34:35], v[66:67]
v_pk_mul_f32 v[68:69], v[36:37], v[68:69]
v_pk_mul_f32 v[70:71], v[38:39], v[70:71]
v_pk_mul_f32 v[72:73], v[40:41], v[72:73]
v_pk_mul_f32 v[74:75], v[42:43], v[74:75]
v_pk_mul_f32 v[76:77], v[44:45], v[76:77]
v_pk_mul_f32 v[78:79], v[46:47], v[78:79]
v_pk_mul_f32 v[16:17], v[64:65], v[64:65]
v_pk_mul_f32 v[18:19], v[66:67], v[66:67]
v_pk_mul_f32 v[20:21], v[68:69], v[68:69]
v_pk_mul_f32 v[22:23], v[70:71], v[70:71]
v_pk_mul_f32 v[24:25], v[72:73], v[72:73]
v_pk_mul_f32 v[26:27], v[74:75], v[74:75]
v_pk_mul_f32 v[28:29], v[76:77], v[76:77]
v_pk_mul_f32 v[30:31], v[78:79], v[78:79]
v_pk_fma_f32 v[80:81], v[48:49], v[48:49], s[68:69]
v_pk_fma_f32 v[82:83], v[50:51], v[50:51], s[68:69]
v_pk_fma_f32 v[84:85], v[52:53], v[52:53], s[68:69]
v_pk_fma_f32 v[86:87], v[54:55], v[54:55], s[68:69]
v_pk_fma_f32 v[88:89], v[56:57], v[56:57], s[68:69]
v_pk_fma_f32 v[90:91], v[58:59], v[58:59], s[68:69]
v_pk_fma_f32 v[92:93], v[60:61], v[60:61], s[68:69]
v_pk_fma_f32 v[94:95], v[62:63], v[62:63], s[68:69]
v_pk_mul_f32 v[80:81], v[48:49], v[80:81] neg_lo:[1,0] neg_hi:[1,0]
v_pk_mul_f32 v[82:83], v[50:51], v[82:83] neg_lo:[1,0] neg_hi:[1,0]
v_pk_mul_f32 v[84:85], v[52:53], v[84:85] neg_lo:[1,0] neg_hi:[1,0]
v_pk_mul_f32 v[86:87], v[54:55], v[86:87] neg_lo:[1,0] neg_hi:[1,0]
v_pk_mul_f32 v[88:89], v[56:57], v[88:89] neg_lo:[1,0] neg_hi:[1,0]
v_pk_mul_f32 v[90:91], v[58:59], v[90:91] neg_lo:[1,0] neg_hi:[1,0]
v_pk_mul_f32 v[92:93], v[60:61], v[92:93] neg_lo:[1,0] neg_hi:[1,0]
v_pk_mul_f32 v[94:95], v[62:63], v[94:95] neg_lo:[1,0] neg_hi:[1,0]
v_mfma_f32_32x32x16_bf16 v[32:47], a[0:3], a[96:99], 0
v_exp_f32_e64 v80, v80
v_cvt_pk_bf16_f32 v64, v64, v65
v_exp_f32_e64 v81, v81
v_cvt_pk_bf16_f32 v65, v66, v67
v_mfma_f32_32x32x16_bf16 v[32:47], a[4:7], a[100:103], v[32:47]
v_exp_f32_e64 v82, v82
v_cvt_pk_bf16_f32 v66, v68, v69
v_exp_f32_e64 v83, v83
v_cvt_pk_bf16_f32 v67, v70, v71
v_mfma_f32_32x32x16_bf16 v[32:47], a[8:11], a[104:107], v[32:47]
v_exp_f32_e64 v84, v84
v_accvgpr_write_b32 a192, v64
v_exp_f32_e64 v85, v85
v_accvgpr_write_b32 a193, v65
v_mfma_f32_32x32x16_bf16 v[32:47], a[12:15], a[108:111], v[32:47]
v_exp_f32_e64 v86, v86
v_accvgpr_write_b32 a194, v66
v_exp_f32_e64 v87, v87
v_accvgpr_write_b32 a195, v67
v_mfma_f32_32x32x16_bf16 v[32:47], a[16:19], a[112:115], v[32:47]
buffer_load_dwordx4 a[144:147], v1, s[32:35], s56 offen offset:0 sc1
v_exp_f32 v88, v88
v_exp_f32_e64 v89, v89
s_waitcnt lgkmcnt(0)
v_mfma_f32_32x32x16_bf16 v[32:47], a[20:23], a[116:119], v[32:47]
buffer_load_dwordx4 a[148:151], v1, s[32:35], s56 offen offset:1024 sc1
v_exp_f32 v90, v90
v_exp_f32 v91, v91
v_exp_f32 v92, v92
v_exp_f32 v93, v93
v_exp_f32 v94, v94
v_exp_f32 v95, v95
v_pk_add_f32 v[80:81], v[80:81], s[70:71]
v_pk_add_f32 v[82:83], v[82:83], s[70:71]
v_pk_add_f32 v[84:85], v[84:85], s[70:71]
v_pk_add_f32 v[86:87], v[86:87], s[70:71]
v_pk_add_f32 v[88:89], v[88:89], s[70:71]
v_pk_add_f32 v[90:91], v[90:91], s[70:71]
v_pk_add_f32 v[92:93], v[92:93], s[70:71]
v_pk_add_f32 v[94:95], v[94:95], s[70:71]
v_mfma_f32_32x32x16_bf16 v[32:47], a[24:27], a[120:123], v[32:47]
v_rcp_f32_e64 v80, v80
v_cvt_pk_bf16_f32 v68, v72, v73
v_rcp_f32_e64 v81, v81
v_cvt_pk_bf16_f32 v69, v74, v75
v_mfma_f32_32x32x16_bf16 v[32:47], a[28:31], a[124:127], v[32:47]
v_rcp_f32_e64 v82, v82
v_cvt_pk_bf16_f32 v70, v76, v77
v_rcp_f32_e64 v83, v83
v_cvt_pk_bf16_f32 v71, v78, v79
v_mfma_f32_32x32x16_bf16 v[32:47], a[32:35], a[128:131], v[32:47]
v_rcp_f32_e64 v84, v84
v_accvgpr_write_b32 a196, v68
v_rcp_f32_e64 v85, v85
v_accvgpr_write_b32 a197, v69
v_mfma_f32_32x32x16_bf16 v[32:47], a[36:39], a[132:135], v[32:47]
v_rcp_f32_e64 v86, v86
v_accvgpr_write_b32 a198, v70
v_rcp_f32_e64 v87, v87
v_accvgpr_write_b32 a199, v71
v_mfma_f32_32x32x16_bf16 v[32:47], a[40:43], a[136:139], v[32:47]
buffer_load_dwordx4 a[152:155], v1, s[32:35], s56 offen offset:2048 sc1
v_rcp_f32 v88, v88
v_rcp_f32 v89, v89
v_mfma_f32_32x32x16_bf16 v[32:47], a[44:47], a[140:143], v[32:47]
v_rcp_f32 v90, v90
v_rcp_f32 v91, v91
v_rcp_f32 v92, v92
v_rcp_f32 v93, v93
v_rcp_f32 v94, v94
v_rcp_f32 v95, v95
v_pk_mul_f32 v[80:81], v[48:49], v[80:81]
v_pk_mul_f32 v[82:83], v[50:51], v[82:83]
v_pk_mul_f32 v[84:85], v[52:53], v[84:85]
v_pk_mul_f32 v[86:87], v[54:55], v[86:87]
v_pk_mul_f32 v[88:89], v[56:57], v[88:89]
v_pk_mul_f32 v[90:91], v[58:59], v[90:91]
v_pk_mul_f32 v[92:93], v[60:61], v[92:93]
v_pk_mul_f32 v[94:95], v[62:63], v[94:95]
v_pk_mul_f32 v[240:241], v[80:81], v[80:81]
v_pk_mul_f32 v[242:243], v[82:83], v[82:83]
v_pk_mul_f32 v[244:245], v[84:85], v[84:85]
v_pk_mul_f32 v[246:247], v[86:87], v[86:87]
v_pk_mul_f32 v[248:249], v[88:89], v[88:89]
v_pk_mul_f32 v[250:251], v[90:91], v[90:91]
v_pk_mul_f32 v[252:253], v[92:93], v[92:93]
v_pk_mul_f32 v[254:255], v[94:95], v[94:95]
v_pk_fma_f32 v[64:65], v[32:33], v[32:33], s[68:69]
v_pk_fma_f32 v[66:67], v[34:35], v[34:35], s[68:69]
v_pk_fma_f32 v[68:69], v[36:37], v[36:37], s[68:69]
v_pk_fma_f32 v[70:71], v[38:39], v[38:39], s[68:69]
v_pk_fma_f32 v[72:73], v[40:41], v[40:41], s[68:69]
v_pk_fma_f32 v[74:75], v[42:43], v[42:43], s[68:69]
v_pk_fma_f32 v[76:77], v[44:45], v[44:45], s[68:69]
v_pk_fma_f32 v[78:79], v[46:47], v[46:47], s[68:69]
v_pk_mul_f32 v[64:65], v[32:33], v[64:65] neg_lo:[1,0] neg_hi:[1,0]
v_pk_mul_f32 v[66:67], v[34:35], v[66:67] neg_lo:[1,0] neg_hi:[1,0]
v_pk_mul_f32 v[68:69], v[36:37], v[68:69] neg_lo:[1,0] neg_hi:[1,0]
v_pk_mul_f32 v[70:71], v[38:39], v[70:71] neg_lo:[1,0] neg_hi:[1,0]
v_pk_mul_f32 v[72:73], v[40:41], v[72:73] neg_lo:[1,0] neg_hi:[1,0]
v_pk_mul_f32 v[74:75], v[42:43], v[74:75] neg_lo:[1,0] neg_hi:[1,0]
v_pk_mul_f32 v[76:77], v[44:45], v[76:77] neg_lo:[1,0] neg_hi:[1,0]
v_pk_mul_f32 v[78:79], v[46:47], v[78:79] neg_lo:[1,0] neg_hi:[1,0]
v_mfma_f32_32x32x16_bf16 v[48:63], a[48:51], a[96:99], 0
ds_read_b128 a[96:99], v4 offset:24576
v_exp_f32_e64 v64, v64
v_cvt_pk_bf16_f32 v152, v80, v81
v_exp_f32_e64 v65, v65
v_mfma_f32_32x32x16_bf16 v[48:63], a[52:55], a[100:103], v[48:63]
ds_read_b128 a[100:103], v4 offset:25600
v_exp_f32_e64 v66, v66
v_cvt_pk_bf16_f32 v153, v82, v83
v_exp_f32_e64 v67, v67
v_mfma_f32_32x32x16_bf16 v[48:63], a[56:59], a[104:107], v[48:63]
ds_read_b128 a[104:107], v4 offset:26624
v_exp_f32_e64 v68, v68
v_cvt_pk_bf16_f32 v154, v84, v85
v_exp_f32_e64 v69, v69
v_mfma_f32_32x32x16_bf16 v[48:63], a[60:63], a[108:111], v[48:63]
ds_read_b128 a[108:111], v4 offset:27648
v_exp_f32_e64 v70, v70
v_cvt_pk_bf16_f32 v155, v86, v87
v_exp_f32_e64 v71, v71
v_mfma_f32_32x32x16_bf16 v[48:63], a[64:67], a[112:115], v[48:63]
ds_read_b128 a[112:115], v4 offset:28672
v_exp_f32 v72, v72
v_exp_f32 v73, v73
v_mfma_f32_32x32x16_bf16 v[48:63], a[68:71], a[116:119], v[48:63]
ds_read_b128 a[116:119], v4 offset:29696
v_exp_f32 v74, v74
v_exp_f32 v75, v75
v_exp_f32 v76, v76
v_exp_f32 v77, v77
v_exp_f32 v78, v78
v_exp_f32 v79, v79
v_pk_add_f32 v[64:65], v[64:65], s[70:71]
v_pk_add_f32 v[66:67], v[66:67], s[70:71]
v_pk_add_f32 v[68:69], v[68:69], s[70:71]
v_pk_add_f32 v[70:71], v[70:71], s[70:71]
v_pk_add_f32 v[72:73], v[72:73], s[70:71]
v_pk_add_f32 v[74:75], v[74:75], s[70:71]
v_pk_add_f32 v[76:77], v[76:77], s[70:71]
v_pk_add_f32 v[78:79], v[78:79], s[70:71]
v_mfma_f32_32x32x16_bf16 v[48:63], a[72:75], a[120:123], v[48:63]
ds_read_b128 a[120:123], v4 offset:30720
v_rcp_f32_e64 v64, v64
v_cvt_pk_bf16_f32 v156, v88, v89
v_rcp_f32_e64 v65, v65
v_mfma_f32_32x32x16_bf16 v[48:63], a[76:79], a[124:127], v[48:63]
ds_read_b128 a[124:127], v4 offset:31744
v_rcp_f32_e64 v66, v66
v_cvt_pk_bf16_f32 v157, v90, v91
v_rcp_f32_e64 v67, v67
v_mfma_f32_32x32x16_bf16 v[48:63], a[80:83], a[128:131], v[48:63]
ds_read_b128 a[128:131], v4 offset:32768
v_rcp_f32_e64 v68, v68
v_cvt_pk_bf16_f32 v158, v92, v93
v_rcp_f32_e64 v69, v69
v_mfma_f32_32x32x16_bf16 v[48:63], a[84:87], a[132:135], v[48:63]
ds_read_b128 a[132:135], v4 offset:33792
v_rcp_f32_e64 v70, v70
v_cvt_pk_bf16_f32 v159, v94, v95
v_rcp_f32_e64 v71, v71
v_mfma_f32_32x32x16_bf16 v[48:63], a[88:91], a[136:139], v[48:63]
ds_read_b128 a[136:139], v4 offset:34816
v_rcp_f32 v72, v72
v_rcp_f32_e64 v73, v73
s_waitcnt lgkmcnt(5)
v_mfma_f32_32x32x16_bf16 v[48:63], a[92:95], a[140:143], v[48:63]
ds_read_b128 a[140:143], v4 offset:35840
v_rcp_f32 v74, v74
v_rcp_f32 v75, v75
v_rcp_f32 v76, v76
v_rcp_f32 v77, v77
v_rcp_f32 v78, v78
v_rcp_f32 v79, v79
v_pk_mul_f32 v[64:65], v[32:33], v[64:65]
v_pk_mul_f32 v[66:67], v[34:35], v[66:67]
v_pk_mul_f32 v[68:69], v[36:37], v[68:69]
v_pk_mul_f32 v[70:71], v[38:39], v[70:71]
v_pk_mul_f32 v[72:73], v[40:41], v[72:73]
v_pk_mul_f32 v[74:75], v[42:43], v[74:75]
v_pk_mul_f32 v[76:77], v[44:45], v[76:77]
v_pk_mul_f32 v[78:79], v[46:47], v[78:79]
v_pk_fma_f32 v[16:17], v[64:65], v[64:65], v[16:17]
v_pk_fma_f32 v[18:19], v[66:67], v[66:67], v[18:19]
v_pk_fma_f32 v[20:21], v[68:69], v[68:69], v[20:21]
v_pk_fma_f32 v[22:23], v[70:71], v[70:71], v[22:23]
v_pk_fma_f32 v[24:25], v[72:73], v[72:73], v[24:25]
v_pk_fma_f32 v[26:27], v[74:75], v[74:75], v[26:27]
v_pk_fma_f32 v[28:29], v[76:77], v[76:77], v[28:29]
v_pk_fma_f32 v[30:31], v[78:79], v[78:79], v[30:31]
v_pk_fma_f32 v[80:81], v[48:49], v[48:49], s[68:69]
v_pk_fma_f32 v[82:83], v[50:51], v[50:51], s[68:69]
v_pk_fma_f32 v[84:85], v[52:53], v[52:53], s[68:69]
v_pk_fma_f32 v[86:87], v[54:55], v[54:55], s[68:69]
v_pk_fma_f32 v[88:89], v[56:57], v[56:57], s[68:69]
v_pk_fma_f32 v[90:91], v[58:59], v[58:59], s[68:69]
v_pk_fma_f32 v[92:93], v[60:61], v[60:61], s[68:69]
v_pk_fma_f32 v[94:95], v[62:63], v[62:63], s[68:69]
v_pk_mul_f32 v[80:81], v[48:49], v[80:81] neg_lo:[1,0] neg_hi:[1,0]
v_pk_mul_f32 v[82:83], v[50:51], v[82:83] neg_lo:[1,0] neg_hi:[1,0]
v_pk_mul_f32 v[84:85], v[52:53], v[84:85] neg_lo:[1,0] neg_hi:[1,0]
v_pk_mul_f32 v[86:87], v[54:55], v[86:87] neg_lo:[1,0] neg_hi:[1,0]
v_pk_mul_f32 v[88:89], v[56:57], v[88:89] neg_lo:[1,0] neg_hi:[1,0]
v_pk_mul_f32 v[90:91], v[58:59], v[90:91] neg_lo:[1,0] neg_hi:[1,0]
v_pk_mul_f32 v[92:93], v[60:61], v[92:93] neg_lo:[1,0] neg_hi:[1,0]
v_pk_mul_f32 v[94:95], v[62:63], v[94:95] neg_lo:[1,0] neg_hi:[1,0]
v_mfma_f32_32x32x16_bf16 v[32:47], a[0:3], a[96:99], 0
v_exp_f32_e64 v80, v80
v_cvt_pk_bf16_f32 v64, v64, v65
v_exp_f32_e64 v81, v81
v_cvt_pk_bf16_f32 v65, v66, v67
v_mfma_f32_32x32x16_bf16 v[32:47], a[4:7], a[100:103], v[32:47]
v_exp_f32_e64 v82, v82
v_cvt_pk_bf16_f32 v66, v68, v69
v_exp_f32_e64 v83, v83
v_cvt_pk_bf16_f32 v67, v70, v71
v_mfma_f32_32x32x16_bf16 v[32:47], a[8:11], a[104:107], v[32:47]
v_exp_f32_e64 v84, v84
v_accvgpr_write_b32 a200, v64
v_exp_f32_e64 v85, v85
v_accvgpr_write_b32 a201, v65
v_mfma_f32_32x32x16_bf16 v[32:47], a[12:15], a[108:111], v[32:47]
v_exp_f32_e64 v86, v86
v_accvgpr_write_b32 a202, v66
v_exp_f32_e64 v87, v87
v_accvgpr_write_b32 a203, v67
v_mfma_f32_32x32x16_bf16 v[32:47], a[16:19], a[112:115], v[32:47]
buffer_load_dwordx4 a[156:159], v1, s[32:35], s56 offen offset:3072 sc1
v_exp_f32 v88, v88
v_exp_f32_e64 v89, v89
s_waitcnt lgkmcnt(0)
v_mfma_f32_32x32x16_bf16 v[32:47], a[20:23], a[116:119], v[32:47]
buffer_load_dwordx4 a[160:163], v2, s[32:35], s56 offen offset:0 sc1
v_exp_f32 v90, v90
v_exp_f32 v91, v91
v_exp_f32 v92, v92
v_exp_f32 v93, v93
v_exp_f32 v94, v94
v_exp_f32 v95, v95
v_pk_add_f32 v[80:81], v[80:81], s[70:71]
v_pk_add_f32 v[82:83], v[82:83], s[70:71]
v_pk_add_f32 v[84:85], v[84:85], s[70:71]
v_pk_add_f32 v[86:87], v[86:87], s[70:71]
v_pk_add_f32 v[88:89], v[88:89], s[70:71]
v_pk_add_f32 v[90:91], v[90:91], s[70:71]
v_pk_add_f32 v[92:93], v[92:93], s[70:71]
v_pk_add_f32 v[94:95], v[94:95], s[70:71]
v_mfma_f32_32x32x16_bf16 v[32:47], a[24:27], a[120:123], v[32:47]
v_rcp_f32_e64 v80, v80
v_cvt_pk_bf16_f32 v68, v72, v73
v_rcp_f32_e64 v81, v81
v_cvt_pk_bf16_f32 v69, v74, v75
v_mfma_f32_32x32x16_bf16 v[32:47], a[28:31], a[124:127], v[32:47]
v_rcp_f32_e64 v82, v82
v_cvt_pk_bf16_f32 v70, v76, v77
v_rcp_f32_e64 v83, v83
v_cvt_pk_bf16_f32 v71, v78, v79
v_mfma_f32_32x32x16_bf16 v[32:47], a[32:35], a[128:131], v[32:47]
v_rcp_f32_e64 v84, v84
v_accvgpr_write_b32 a204, v68
v_rcp_f32_e64 v85, v85
v_accvgpr_write_b32 a205, v69
v_mfma_f32_32x32x16_bf16 v[32:47], a[36:39], a[132:135], v[32:47]
v_rcp_f32_e64 v86, v86
v_accvgpr_write_b32 a206, v70
v_rcp_f32_e64 v87, v87
v_accvgpr_write_b32 a207, v71
v_mfma_f32_32x32x16_bf16 v[32:47], a[40:43], a[136:139], v[32:47]
buffer_load_dwordx4 a[164:167], v2, s[32:35], s56 offen offset:1024 sc1
v_rcp_f32 v88, v88
v_rcp_f32 v89, v89
v_mfma_f32_32x32x16_bf16 v[32:47], a[44:47], a[140:143], v[32:47]
v_rcp_f32 v90, v90
v_rcp_f32 v91, v91
v_rcp_f32 v92, v92
v_rcp_f32 v93, v93
v_rcp_f32 v94, v94
v_rcp_f32 v95, v95
v_pk_mul_f32 v[80:81], v[48:49], v[80:81]
v_pk_mul_f32 v[82:83], v[50:51], v[82:83]
v_pk_mul_f32 v[84:85], v[52:53], v[84:85]
v_pk_mul_f32 v[86:87], v[54:55], v[86:87]
v_pk_mul_f32 v[88:89], v[56:57], v[88:89]
v_pk_mul_f32 v[90:91], v[58:59], v[90:91]
v_pk_mul_f32 v[92:93], v[60:61], v[92:93]
v_pk_mul_f32 v[94:95], v[62:63], v[94:95]
v_pk_fma_f32 v[240:241], v[80:81], v[80:81], v[240:241]
v_pk_fma_f32 v[242:243], v[82:83], v[82:83], v[242:243]
v_pk_fma_f32 v[244:245], v[84:85], v[84:85], v[244:245]
v_pk_fma_f32 v[246:247], v[86:87], v[86:87], v[246:247]
v_pk_fma_f32 v[248:249], v[88:89], v[88:89], v[248:249]
v_pk_fma_f32 v[250:251], v[90:91], v[90:91], v[250:251]
v_pk_fma_f32 v[252:253], v[92:93], v[92:93], v[252:253]
v_pk_fma_f32 v[254:255], v[94:95], v[94:95], v[254:255]
v_pk_fma_f32 v[64:65], v[32:33], v[32:33], s[68:69]
v_pk_fma_f32 v[66:67], v[34:35], v[34:35], s[68:69]
v_pk_fma_f32 v[68:69], v[36:37], v[36:37], s[68:69]
v_pk_fma_f32 v[70:71], v[38:39], v[38:39], s[68:69]
v_pk_fma_f32 v[72:73], v[40:41], v[40:41], s[68:69]
v_pk_fma_f32 v[74:75], v[42:43], v[42:43], s[68:69]
v_pk_fma_f32 v[76:77], v[44:45], v[44:45], s[68:69]
v_pk_fma_f32 v[78:79], v[46:47], v[46:47], s[68:69]
v_pk_mul_f32 v[64:65], v[32:33], v[64:65] neg_lo:[1,0] neg_hi:[1,0]
v_pk_mul_f32 v[66:67], v[34:35], v[66:67] neg_lo:[1,0] neg_hi:[1,0]
v_pk_mul_f32 v[68:69], v[36:37], v[68:69] neg_lo:[1,0] neg_hi:[1,0]
v_pk_mul_f32 v[70:71], v[38:39], v[70:71] neg_lo:[1,0] neg_hi:[1,0]
v_pk_mul_f32 v[72:73], v[40:41], v[72:73] neg_lo:[1,0] neg_hi:[1,0]
v_pk_mul_f32 v[74:75], v[42:43], v[74:75] neg_lo:[1,0] neg_hi:[1,0]
v_pk_mul_f32 v[76:77], v[44:45], v[76:77] neg_lo:[1,0] neg_hi:[1,0]
v_pk_mul_f32 v[78:79], v[46:47], v[78:79] neg_lo:[1,0] neg_hi:[1,0]
v_mfma_f32_32x32x16_bf16 v[48:63], a[48:51], a[96:99], 0
ds_read_b128 a[96:99], v4 offset:36864
v_exp_f32_e64 v64, v64
v_cvt_pk_bf16_f32 v160, v80, v81
v_exp_f32_e64 v65, v65
v_mfma_f32_32x32x16_bf16 v[48:63], a[52:55], a[100:103], v[48:63]
ds_read_b128 a[100:103], v4 offset:37888
v_exp_f32_e64 v66, v66
v_cvt_pk_bf16_f32 v161, v82, v83
v_exp_f32_e64 v67, v67
v_mfma_f32_32x32x16_bf16 v[48:63], a[56:59], a[104:107], v[48:63]
ds_read_b128 a[104:107], v4 offset:38912
v_exp_f32_e64 v68, v68
v_cvt_pk_bf16_f32 v162, v84, v85
v_exp_f32_e64 v69, v69
v_mfma_f32_32x32x16_bf16 v[48:63], a[60:63], a[108:111], v[48:63]
ds_read_b128 a[108:111], v4 offset:39936
v_exp_f32_e64 v70, v70
v_cvt_pk_bf16_f32 v163, v86, v87
v_exp_f32_e64 v71, v71
v_mfma_f32_32x32x16_bf16 v[48:63], a[64:67], a[112:115], v[48:63]
ds_read_b128 a[112:115], v4 offset:40960
v_exp_f32 v72, v72
v_exp_f32 v73, v73
v_mfma_f32_32x32x16_bf16 v[48:63], a[68:71], a[116:119], v[48:63]
ds_read_b128 a[116:119], v4 offset:41984
v_exp_f32 v74, v74
v_exp_f32 v75, v75
v_exp_f32 v76, v76
v_exp_f32 v77, v77
v_exp_f32 v78, v78
v_exp_f32 v79, v79
v_pk_add_f32 v[64:65], v[64:65], s[70:71]
v_pk_add_f32 v[66:67], v[66:67], s[70:71]
v_pk_add_f32 v[68:69], v[68:69], s[70:71]
v_pk_add_f32 v[70:71], v[70:71], s[70:71]
v_pk_add_f32 v[72:73], v[72:73], s[70:71]
v_pk_add_f32 v[74:75], v[74:75], s[70:71]
v_pk_add_f32 v[76:77], v[76:77], s[70:71]
v_pk_add_f32 v[78:79], v[78:79], s[70:71]
v_mfma_f32_32x32x16_bf16 v[48:63], a[72:75], a[120:123], v[48:63]
ds_read_b128 a[120:123], v4 offset:43008
v_rcp_f32_e64 v64, v64
v_cvt_pk_bf16_f32 v164, v88, v89
v_rcp_f32_e64 v65, v65
v_mfma_f32_32x32x16_bf16 v[48:63], a[76:79], a[124:127], v[48:63]
ds_read_b128 a[124:127], v4 offset:44032
v_rcp_f32_e64 v66, v66
v_cvt_pk_bf16_f32 v165, v90, v91
v_rcp_f32_e64 v67, v67
v_mfma_f32_32x32x16_bf16 v[48:63], a[80:83], a[128:131], v[48:63]
ds_read_b128 a[128:131], v4 offset:45056
v_rcp_f32_e64 v68, v68
v_cvt_pk_bf16_f32 v166, v92, v93
v_rcp_f32_e64 v69, v69
v_mfma_f32_32x32x16_bf16 v[48:63], a[84:87], a[132:135], v[48:63]
ds_read_b128 a[132:135], v4 offset:46080
v_rcp_f32_e64 v70, v70
v_cvt_pk_bf16_f32 v167, v94, v95
v_rcp_f32_e64 v71, v71
v_mfma_f32_32x32x16_bf16 v[48:63], a[88:91], a[136:139], v[48:63]
ds_read_b128 a[136:139], v4 offset:47104
v_rcp_f32 v72, v72
v_rcp_f32_e64 v73, v73
s_waitcnt lgkmcnt(5)
v_mfma_f32_32x32x16_bf16 v[48:63], a[92:95], a[140:143], v[48:63]
ds_read_b128 a[140:143], v4 offset:48128
v_rcp_f32 v74, v74
v_rcp_f32 v75, v75
v_rcp_f32 v76, v76
v_rcp_f32 v77, v77
v_rcp_f32 v78, v78
v_rcp_f32 v79, v79
v_pk_mul_f32 v[64:65], v[32:33], v[64:65]
v_pk_mul_f32 v[66:67], v[34:35], v[66:67]
v_pk_mul_f32 v[68:69], v[36:37], v[68:69]
v_pk_mul_f32 v[70:71], v[38:39], v[70:71]
v_pk_mul_f32 v[72:73], v[40:41], v[72:73]
v_pk_mul_f32 v[74:75], v[42:43], v[74:75]
v_pk_mul_f32 v[76:77], v[44:45], v[76:77]
v_pk_mul_f32 v[78:79], v[46:47], v[78:79]
v_pk_fma_f32 v[16:17], v[64:65], v[64:65], v[16:17]
v_pk_fma_f32 v[18:19], v[66:67], v[66:67], v[18:19]
v_pk_fma_f32 v[20:21], v[68:69], v[68:69], v[20:21]
v_pk_fma_f32 v[22:23], v[70:71], v[70:71], v[22:23]
v_pk_fma_f32 v[24:25], v[72:73], v[72:73], v[24:25]
v_pk_fma_f32 v[26:27], v[74:75], v[74:75], v[26:27]
v_pk_fma_f32 v[28:29], v[76:77], v[76:77], v[28:29]
v_pk_fma_f32 v[30:31], v[78:79], v[78:79], v[30:31]
v_pk_fma_f32 v[80:81], v[48:49], v[48:49], s[68:69]
v_pk_fma_f32 v[82:83], v[50:51], v[50:51], s[68:69]
v_pk_fma_f32 v[84:85], v[52:53], v[52:53], s[68:69]
v_pk_fma_f32 v[86:87], v[54:55], v[54:55], s[68:69]
v_pk_fma_f32 v[88:89], v[56:57], v[56:57], s[68:69]
v_pk_fma_f32 v[90:91], v[58:59], v[58:59], s[68:69]
v_pk_fma_f32 v[92:93], v[60:61], v[60:61], s[68:69]
v_pk_fma_f32 v[94:95], v[62:63], v[62:63], s[68:69]
v_pk_mul_f32 v[80:81], v[48:49], v[80:81] neg_lo:[1,0] neg_hi:[1,0]
v_pk_mul_f32 v[82:83], v[50:51], v[82:83] neg_lo:[1,0] neg_hi:[1,0]
v_pk_mul_f32 v[84:85], v[52:53], v[84:85] neg_lo:[1,0] neg_hi:[1,0]
v_pk_mul_f32 v[86:87], v[54:55], v[86:87] neg_lo:[1,0] neg_hi:[1,0]
v_pk_mul_f32 v[88:89], v[56:57], v[88:89] neg_lo:[1,0] neg_hi:[1,0]
v_pk_mul_f32 v[90:91], v[58:59], v[90:91] neg_lo:[1,0] neg_hi:[1,0]
v_pk_mul_f32 v[92:93], v[60:61], v[92:93] neg_lo:[1,0] neg_hi:[1,0]
v_pk_mul_f32 v[94:95], v[62:63], v[94:95] neg_lo:[1,0] neg_hi:[1,0]
v_mfma_f32_32x32x16_bf16 v[32:47], a[0:3], a[96:99], 0
v_exp_f32_e64 v80, v80
v_cvt_pk_bf16_f32 v64, v64, v65
v_exp_f32_e64 v81, v81
v_cvt_pk_bf16_f32 v65, v66, v67
v_mfma_f32_32x32x16_bf16 v[32:47], a[4:7], a[100:103], v[32:47]
v_exp_f32_e64 v82, v82
v_cvt_pk_bf16_f32 v66, v68, v69
v_exp_f32_e64 v83, v83
v_cvt_pk_bf16_f32 v67, v70, v71
v_mfma_f32_32x32x16_bf16 v[32:47], a[8:11], a[104:107], v[32:47]
v_exp_f32_e64 v84, v84
v_accvgpr_write_b32 a208, v64
v_exp_f32_e64 v85, v85
v_accvgpr_write_b32 a209, v65
v_mfma_f32_32x32x16_bf16 v[32:47], a[12:15], a[108:111], v[32:47]
v_exp_f32_e64 v86, v86
v_accvgpr_write_b32 a210, v66
v_exp_f32_e64 v87, v87
v_accvgpr_write_b32 a211, v67
v_mfma_f32_32x32x16_bf16 v[32:47], a[16:19], a[112:115], v[32:47]
buffer_load_dwordx4 a[168:171], v2, s[32:35], s56 offen offset:2048 sc1
v_exp_f32 v88, v88
v_exp_f32_e64 v89, v89
s_waitcnt lgkmcnt(0)
v_mfma_f32_32x32x16_bf16 v[32:47], a[20:23], a[116:119], v[32:47]
buffer_load_dwordx4 a[172:175], v2, s[32:35], s56 offen offset:3072 sc1
v_exp_f32 v90, v90
v_exp_f32 v91, v91
v_exp_f32 v92, v92
v_exp_f32 v93, v93
v_exp_f32 v94, v94
v_exp_f32 v95, v95
v_pk_add_f32 v[80:81], v[80:81], s[70:71]
v_pk_add_f32 v[82:83], v[82:83], s[70:71]
v_pk_add_f32 v[84:85], v[84:85], s[70:71]
v_pk_add_f32 v[86:87], v[86:87], s[70:71]
v_pk_add_f32 v[88:89], v[88:89], s[70:71]
v_pk_add_f32 v[90:91], v[90:91], s[70:71]
v_pk_add_f32 v[92:93], v[92:93], s[70:71]
v_pk_add_f32 v[94:95], v[94:95], s[70:71]
v_mfma_f32_32x32x16_bf16 v[32:47], a[24:27], a[120:123], v[32:47]
v_rcp_f32_e64 v80, v80
v_cvt_pk_bf16_f32 v68, v72, v73
v_rcp_f32_e64 v81, v81
v_cvt_pk_bf16_f32 v69, v74, v75
v_mfma_f32_32x32x16_bf16 v[32:47], a[28:31], a[124:127], v[32:47]
v_rcp_f32_e64 v82, v82
v_cvt_pk_bf16_f32 v70, v76, v77
v_rcp_f32_e64 v83, v83
v_cvt_pk_bf16_f32 v71, v78, v79
v_mfma_f32_32x32x16_bf16 v[32:47], a[32:35], a[128:131], v[32:47]
v_rcp_f32_e64 v84, v84
v_accvgpr_write_b32 a212, v68
v_rcp_f32_e64 v85, v85
v_accvgpr_write_b32 a213, v69
v_mfma_f32_32x32x16_bf16 v[32:47], a[36:39], a[132:135], v[32:47]
v_rcp_f32_e64 v86, v86
v_accvgpr_write_b32 a214, v70
v_rcp_f32_e64 v87, v87
v_accvgpr_write_b32 a215, v71
v_mfma_f32_32x32x16_bf16 v[32:47], a[40:43], a[136:139], v[32:47]
buffer_load_dwordx4 a[176:179], v3, s[32:35], s56 offen offset:0 sc1
v_rcp_f32 v88, v88
v_rcp_f32 v89, v89
v_mfma_f32_32x32x16_bf16 v[32:47], a[44:47], a[140:143], v[32:47]
v_rcp_f32 v90, v90
v_rcp_f32 v91, v91
v_rcp_f32 v92, v92
v_rcp_f32 v93, v93
v_rcp_f32 v94, v94
v_rcp_f32 v95, v95
v_pk_mul_f32 v[80:81], v[48:49], v[80:81]
v_pk_mul_f32 v[82:83], v[50:51], v[82:83]
v_pk_mul_f32 v[84:85], v[52:53], v[84:85]
v_pk_mul_f32 v[86:87], v[54:55], v[86:87]
v_pk_mul_f32 v[88:89], v[56:57], v[88:89]
v_pk_mul_f32 v[90:91], v[58:59], v[90:91]
v_pk_mul_f32 v[92:93], v[60:61], v[92:93]
v_pk_mul_f32 v[94:95], v[62:63], v[94:95]
v_pk_fma_f32 v[240:241], v[80:81], v[80:81], v[240:241]
v_pk_fma_f32 v[242:243], v[82:83], v[82:83], v[242:243]
v_pk_fma_f32 v[244:245], v[84:85], v[84:85], v[244:245]
v_pk_fma_f32 v[246:247], v[86:87], v[86:87], v[246:247]
v_pk_fma_f32 v[248:249], v[88:89], v[88:89], v[248:249]
v_pk_fma_f32 v[250:251], v[90:91], v[90:91], v[250:251]
v_pk_fma_f32 v[252:253], v[92:93], v[92:93], v[252:253]
v_pk_fma_f32 v[254:255], v[94:95], v[94:95], v[254:255]
v_pk_fma_f32 v[64:65], v[32:33], v[32:33], s[68:69]
v_pk_fma_f32 v[66:67], v[34:35], v[34:35], s[68:69]
v_pk_fma_f32 v[68:69], v[36:37], v[36:37], s[68:69]
v_pk_fma_f32 v[70:71], v[38:39], v[38:39], s[68:69]
v_pk_fma_f32 v[72:73], v[40:41], v[40:41], s[68:69]
v_pk_fma_f32 v[74:75], v[42:43], v[42:43], s[68:69]
v_pk_fma_f32 v[76:77], v[44:45], v[44:45], s[68:69]
v_pk_fma_f32 v[78:79], v[46:47], v[46:47], s[68:69]
v_pk_mul_f32 v[64:65], v[32:33], v[64:65] neg_lo:[1,0] neg_hi:[1,0]
v_pk_mul_f32 v[66:67], v[34:35], v[66:67] neg_lo:[1,0] neg_hi:[1,0]
v_pk_mul_f32 v[68:69], v[36:37], v[68:69] neg_lo:[1,0] neg_hi:[1,0]
v_pk_mul_f32 v[70:71], v[38:39], v[70:71] neg_lo:[1,0] neg_hi:[1,0]
v_pk_mul_f32 v[72:73], v[40:41], v[72:73] neg_lo:[1,0] neg_hi:[1,0]
v_pk_mul_f32 v[74:75], v[42:43], v[74:75] neg_lo:[1,0] neg_hi:[1,0]
v_pk_mul_f32 v[76:77], v[44:45], v[76:77] neg_lo:[1,0] neg_hi:[1,0]
v_pk_mul_f32 v[78:79], v[46:47], v[78:79] neg_lo:[1,0] neg_hi:[1,0]
v_mfma_f32_32x32x16_bf16 v[48:63], a[48:51], a[96:99], 0
ds_read_b128 a[96:99], v1 offset:0
v_exp_f32_e64 v64, v64
v_cvt_pk_bf16_f32 v168, v80, v81
v_exp_f32_e64 v65, v65
v_mfma_f32_32x32x16_bf16 v[48:63], a[52:55], a[100:103], v[48:63]
ds_read_b128 a[100:103], v1 offset:1024
v_exp_f32_e64 v66, v66
v_cvt_pk_bf16_f32 v169, v82, v83
v_exp_f32_e64 v67, v67
v_mfma_f32_32x32x16_bf16 v[48:63], a[56:59], a[104:107], v[48:63]
ds_read_b128 a[104:107], v1 offset:2048
v_exp_f32_e64 v68, v68
v_cvt_pk_bf16_f32 v170, v84, v85
v_exp_f32_e64 v69, v69
v_mfma_f32_32x32x16_bf16 v[48:63], a[60:63], a[108:111], v[48:63]
ds_read_b128 a[108:111], v1 offset:3072
v_exp_f32_e64 v70, v70
v_cvt_pk_bf16_f32 v171, v86, v87
v_exp_f32_e64 v71, v71
v_mfma_f32_32x32x16_bf16 v[48:63], a[64:67], a[112:115], v[48:63]
ds_read_b128 a[112:115], v1 offset:4096
v_exp_f32 v72, v72
v_exp_f32 v73, v73
v_mfma_f32_32x32x16_bf16 v[48:63], a[68:71], a[116:119], v[48:63]
ds_read_b128 a[116:119], v1 offset:5120
v_exp_f32 v74, v74
v_exp_f32 v75, v75
v_exp_f32 v76, v76
v_exp_f32 v77, v77
v_exp_f32 v78, v78
v_exp_f32 v79, v79
v_pk_add_f32 v[64:65], v[64:65], s[70:71]
v_pk_add_f32 v[66:67], v[66:67], s[70:71]
v_pk_add_f32 v[68:69], v[68:69], s[70:71]
v_pk_add_f32 v[70:71], v[70:71], s[70:71]
v_pk_add_f32 v[72:73], v[72:73], s[70:71]
v_pk_add_f32 v[74:75], v[74:75], s[70:71]
v_pk_add_f32 v[76:77], v[76:77], s[70:71]
v_pk_add_f32 v[78:79], v[78:79], s[70:71]
v_mfma_f32_32x32x16_bf16 v[48:63], a[72:75], a[120:123], v[48:63]
ds_read_b128 a[120:123], v1 offset:6144
v_rcp_f32_e64 v64, v64
v_cvt_pk_bf16_f32 v172, v88, v89
v_rcp_f32_e64 v65, v65
v_mfma_f32_32x32x16_bf16 v[48:63], a[76:79], a[124:127], v[48:63]
ds_read_b128 a[124:127], v1 offset:7168
v_rcp_f32_e64 v66, v66
v_cvt_pk_bf16_f32 v173, v90, v91
v_rcp_f32_e64 v67, v67
v_mfma_f32_32x32x16_bf16 v[48:63], a[80:83], a[128:131], v[48:63]
ds_read_b128 a[128:131], v1 offset:8192
v_rcp_f32_e64 v68, v68
v_cvt_pk_bf16_f32 v174, v92, v93
v_rcp_f32_e64 v69, v69
v_mfma_f32_32x32x16_bf16 v[48:63], a[84:87], a[132:135], v[48:63]
ds_read_b128 a[132:135], v1 offset:9216
v_rcp_f32_e64 v70, v70
v_cvt_pk_bf16_f32 v175, v94, v95
v_rcp_f32_e64 v71, v71
v_mfma_f32_32x32x16_bf16 v[48:63], a[88:91], a[136:139], v[48:63]
ds_read_b128 a[136:139], v1 offset:10240
v_rcp_f32 v72, v72
v_rcp_f32_e64 v73, v73
s_waitcnt lgkmcnt(5)
v_mfma_f32_32x32x16_bf16 v[48:63], a[92:95], a[140:143], v[48:63]
ds_read_b128 a[140:143], v1 offset:11264
v_rcp_f32 v74, v74
v_rcp_f32 v75, v75
v_rcp_f32 v76, v76
v_rcp_f32 v77, v77
v_rcp_f32 v78, v78
v_rcp_f32 v79, v79
v_pk_mul_f32 v[64:65], v[32:33], v[64:65]
v_pk_mul_f32 v[66:67], v[34:35], v[66:67]
v_pk_mul_f32 v[68:69], v[36:37], v[68:69]
v_pk_mul_f32 v[70:71], v[38:39], v[70:71]
v_pk_mul_f32 v[72:73], v[40:41], v[72:73]
v_pk_mul_f32 v[74:75], v[42:43], v[74:75]
v_pk_mul_f32 v[76:77], v[44:45], v[76:77]
v_pk_mul_f32 v[78:79], v[46:47], v[78:79]
v_pk_fma_f32 v[16:17], v[64:65], v[64:65], v[16:17]
v_pk_fma_f32 v[18:19], v[66:67], v[66:67], v[18:19]
v_pk_fma_f32 v[20:21], v[68:69], v[68:69], v[20:21]
v_pk_fma_f32 v[22:23], v[70:71], v[70:71], v[22:23]
v_pk_fma_f32 v[24:25], v[72:73], v[72:73], v[24:25]
v_pk_fma_f32 v[26:27], v[74:75], v[74:75], v[26:27]
v_pk_fma_f32 v[28:29], v[76:77], v[76:77], v[28:29]
v_pk_fma_f32 v[30:31], v[78:79], v[78:79], v[30:31]
v_pk_fma_f32 v[80:81], v[48:49], v[48:49], s[68:69]
v_pk_fma_f32 v[82:83], v[50:51], v[50:51], s[68:69]
v_pk_fma_f32 v[84:85], v[52:53], v[52:53], s[68:69]
v_pk_fma_f32 v[86:87], v[54:55], v[54:55], s[68:69]
v_pk_fma_f32 v[88:89], v[56:57], v[56:57], s[68:69]
v_pk_fma_f32 v[90:91], v[58:59], v[58:59], s[68:69]
v_pk_fma_f32 v[92:93], v[60:61], v[60:61], s[68:69]
v_pk_fma_f32 v[94:95], v[62:63], v[62:63], s[68:69]
v_pk_mul_f32 v[80:81], v[48:49], v[80:81] neg_lo:[1,0] neg_hi:[1,0]
v_pk_mul_f32 v[82:83], v[50:51], v[82:83] neg_lo:[1,0] neg_hi:[1,0]
v_pk_mul_f32 v[84:85], v[52:53], v[84:85] neg_lo:[1,0] neg_hi:[1,0]
v_pk_mul_f32 v[86:87], v[54:55], v[86:87] neg_lo:[1,0] neg_hi:[1,0]
v_pk_mul_f32 v[88:89], v[56:57], v[88:89] neg_lo:[1,0] neg_hi:[1,0]
v_pk_mul_f32 v[90:91], v[58:59], v[90:91] neg_lo:[1,0] neg_hi:[1,0]
v_pk_mul_f32 v[92:93], v[60:61], v[92:93] neg_lo:[1,0] neg_hi:[1,0]
v_pk_mul_f32 v[94:95], v[62:63], v[94:95] neg_lo:[1,0] neg_hi:[1,0]
v_mfma_f32_32x32x16_bf16 v[32:47], a[0:3], a[96:99], 0
v_exp_f32_e64 v80, v80
v_cvt_pk_bf16_f32 v64, v64, v65
v_exp_f32_e64 v81, v81
v_cvt_pk_bf16_f32 v65, v66, v67
v_mfma_f32_32x32x16_bf16 v[32:47], a[4:7], a[100:103], v[32:47]
v_exp_f32_e64 v82, v82
v_cvt_pk_bf16_f32 v66, v68, v69
v_exp_f32_e64 v83, v83
v_cvt_pk_bf16_f32 v67, v70, v71
v_mfma_f32_32x32x16_bf16 v[32:47], a[8:11], a[104:107], v[32:47]
v_exp_f32_e64 v84, v84
v_accvgpr_write_b32 a216, v64
v_exp_f32_e64 v85, v85
v_accvgpr_write_b32 a217, v65
v_mfma_f32_32x32x16_bf16 v[32:47], a[12:15], a[108:111], v[32:47]
v_exp_f32_e64 v86, v86
v_accvgpr_write_b32 a218, v66
v_exp_f32_e64 v87, v87
v_accvgpr_write_b32 a219, v67
v_mfma_f32_32x32x16_bf16 v[32:47], a[16:19], a[112:115], v[32:47]
buffer_load_dwordx4 a[180:183], v3, s[32:35], s56 offen offset:1024 sc1
v_exp_f32 v88, v88
v_exp_f32_e64 v89, v89
s_waitcnt lgkmcnt(0)
v_mfma_f32_32x32x16_bf16 v[32:47], a[20:23], a[116:119], v[32:47]
buffer_load_dwordx4 a[184:187], v3, s[32:35], s56 offen offset:2048 sc1
v_exp_f32 v90, v90
v_exp_f32 v91, v91
v_exp_f32 v92, v92
v_exp_f32 v93, v93
v_exp_f32 v94, v94
v_exp_f32 v95, v95
v_pk_add_f32 v[80:81], v[80:81], s[70:71]
v_pk_add_f32 v[82:83], v[82:83], s[70:71]
v_pk_add_f32 v[84:85], v[84:85], s[70:71]
v_pk_add_f32 v[86:87], v[86:87], s[70:71]
v_pk_add_f32 v[88:89], v[88:89], s[70:71]
v_pk_add_f32 v[90:91], v[90:91], s[70:71]
v_pk_add_f32 v[92:93], v[92:93], s[70:71]
v_pk_add_f32 v[94:95], v[94:95], s[70:71]
v_mfma_f32_32x32x16_bf16 v[32:47], a[24:27], a[120:123], v[32:47]
v_rcp_f32_e64 v80, v80
v_cvt_pk_bf16_f32 v68, v72, v73
v_rcp_f32_e64 v81, v81
v_cvt_pk_bf16_f32 v69, v74, v75
v_mfma_f32_32x32x16_bf16 v[32:47], a[28:31], a[124:127], v[32:47]
v_rcp_f32_e64 v82, v82
v_cvt_pk_bf16_f32 v70, v76, v77
v_rcp_f32_e64 v83, v83
v_cvt_pk_bf16_f32 v71, v78, v79
v_mfma_f32_32x32x16_bf16 v[32:47], a[32:35], a[128:131], v[32:47]
v_rcp_f32_e64 v84, v84
v_accvgpr_write_b32 a220, v68
v_rcp_f32_e64 v85, v85
v_accvgpr_write_b32 a221, v69
v_mfma_f32_32x32x16_bf16 v[32:47], a[36:39], a[132:135], v[32:47]
v_rcp_f32_e64 v86, v86
v_accvgpr_write_b32 a222, v70
v_rcp_f32_e64 v87, v87
v_accvgpr_write_b32 a223, v71
v_mfma_f32_32x32x16_bf16 v[32:47], a[40:43], a[136:139], v[32:47]
buffer_load_dwordx4 a[188:191], v3, s[32:35], s56 offen offset:3072 sc1
v_rcp_f32 v88, v88
v_rcp_f32 v89, v89
v_mfma_f32_32x32x16_bf16 v[32:47], a[44:47], a[140:143], v[32:47]
v_rcp_f32 v90, v90
v_rcp_f32 v91, v91
v_rcp_f32 v92, v92
v_rcp_f32 v93, v93
v_rcp_f32 v94, v94
v_rcp_f32 v95, v95
v_pk_mul_f32 v[80:81], v[48:49], v[80:81]
v_pk_mul_f32 v[82:83], v[50:51], v[82:83]
v_pk_mul_f32 v[84:85], v[52:53], v[84:85]
v_pk_mul_f32 v[86:87], v[54:55], v[86:87]
v_pk_mul_f32 v[88:89], v[56:57], v[88:89]
v_pk_mul_f32 v[90:91], v[58:59], v[90:91]
v_pk_mul_f32 v[92:93], v[60:61], v[92:93]
v_pk_mul_f32 v[94:95], v[62:63], v[94:95]
v_pk_fma_f32 v[240:241], v[80:81], v[80:81], v[240:241]
v_pk_fma_f32 v[242:243], v[82:83], v[82:83], v[242:243]
v_pk_fma_f32 v[244:245], v[84:85], v[84:85], v[244:245]
v_pk_fma_f32 v[246:247], v[86:87], v[86:87], v[246:247]
v_pk_fma_f32 v[248:249], v[88:89], v[88:89], v[248:249]
v_pk_fma_f32 v[250:251], v[90:91], v[90:91], v[250:251]
v_pk_fma_f32 v[252:253], v[92:93], v[92:93], v[252:253]
v_pk_fma_f32 v[254:255], v[94:95], v[94:95], v[254:255]
v_pk_fma_f32 v[64:65], v[32:33], v[32:33], s[68:69]
v_pk_fma_f32 v[66:67], v[34:35], v[34:35], s[68:69]
v_pk_fma_f32 v[68:69], v[36:37], v[36:37], s[68:69]
v_pk_fma_f32 v[70:71], v[38:39], v[38:39], s[68:69]
v_pk_fma_f32 v[72:73], v[40:41], v[40:41], s[68:69]
v_pk_fma_f32 v[74:75], v[42:43], v[42:43], s[68:69]
v_pk_fma_f32 v[76:77], v[44:45], v[44:45], s[68:69]
v_pk_fma_f32 v[78:79], v[46:47], v[46:47], s[68:69]
v_pk_mul_f32 v[64:65], v[32:33], v[64:65] neg_lo:[1,0] neg_hi:[1,0]
v_pk_mul_f32 v[66:67], v[34:35], v[66:67] neg_lo:[1,0] neg_hi:[1,0]
v_pk_mul_f32 v[68:69], v[36:37], v[68:69] neg_lo:[1,0] neg_hi:[1,0]
v_pk_mul_f32 v[70:71], v[38:39], v[70:71] neg_lo:[1,0] neg_hi:[1,0]
v_pk_mul_f32 v[72:73], v[40:41], v[72:73] neg_lo:[1,0] neg_hi:[1,0]
v_pk_mul_f32 v[74:75], v[42:43], v[74:75] neg_lo:[1,0] neg_hi:[1,0]
v_pk_mul_f32 v[76:77], v[44:45], v[76:77] neg_lo:[1,0] neg_hi:[1,0]
v_pk_mul_f32 v[78:79], v[46:47], v[78:79] neg_lo:[1,0] neg_hi:[1,0]
v_mfma_f32_32x32x16_bf16 v[48:63], a[48:51], a[96:99], 0
ds_read_b128 a[96:99], v1 offset:12288
v_exp_f32_e64 v64, v64
v_cvt_pk_bf16_f32 v176, v80, v81
v_exp_f32_e64 v65, v65
v_mfma_f32_32x32x16_bf16 v[48:63], a[52:55], a[100:103], v[48:63]
ds_read_b128 a[100:103], v1 offset:13312
v_exp_f32_e64 v66, v66
v_cvt_pk_bf16_f32 v177, v82, v83
v_exp_f32_e64 v67, v67
v_mfma_f32_32x32x16_bf16 v[48:63], a[56:59], a[104:107], v[48:63]
ds_read_b128 a[104:107], v1 offset:14336
v_exp_f32_e64 v68, v68
v_cvt_pk_bf16_f32 v178, v84, v85
v_exp_f32_e64 v69, v69
v_mfma_f32_32x32x16_bf16 v[48:63], a[60:63], a[108:111], v[48:63]
ds_read_b128 a[108:111], v1 offset:15360
v_exp_f32_e64 v70, v70
v_cvt_pk_bf16_f32 v179, v86, v87
v_exp_f32_e64 v71, v71
v_mfma_f32_32x32x16_bf16 v[48:63], a[64:67], a[112:115], v[48:63]
ds_read_b128 a[112:115], v1 offset:16384
v_exp_f32 v72, v72
v_exp_f32 v73, v73
v_mfma_f32_32x32x16_bf16 v[48:63], a[68:71], a[116:119], v[48:63]
ds_read_b128 a[116:119], v1 offset:17408
v_exp_f32 v74, v74
v_exp_f32 v75, v75
v_exp_f32 v76, v76
v_exp_f32 v77, v77
v_exp_f32 v78, v78
v_exp_f32 v79, v79
v_pk_add_f32 v[64:65], v[64:65], s[70:71]
v_pk_add_f32 v[66:67], v[66:67], s[70:71]
v_pk_add_f32 v[68:69], v[68:69], s[70:71]
v_pk_add_f32 v[70:71], v[70:71], s[70:71]
v_pk_add_f32 v[72:73], v[72:73], s[70:71]
v_pk_add_f32 v[74:75], v[74:75], s[70:71]
v_pk_add_f32 v[76:77], v[76:77], s[70:71]
v_pk_add_f32 v[78:79], v[78:79], s[70:71]
v_mfma_f32_32x32x16_bf16 v[48:63], a[72:75], a[120:123], v[48:63]
ds_read_b128 a[120:123], v1 offset:18432
v_rcp_f32_e64 v64, v64
v_cvt_pk_bf16_f32 v180, v88, v89
v_rcp_f32_e64 v65, v65
v_mfma_f32_32x32x16_bf16 v[48:63], a[76:79], a[124:127], v[48:63]
ds_read_b128 a[124:127], v1 offset:19456
v_rcp_f32_e64 v66, v66
v_cvt_pk_bf16_f32 v181, v90, v91
v_rcp_f32_e64 v67, v67
v_mfma_f32_32x32x16_bf16 v[48:63], a[80:83], a[128:131], v[48:63]
ds_read_b128 a[128:131], v1 offset:20480
v_rcp_f32_e64 v68, v68
v_cvt_pk_bf16_f32 v182, v92, v93
v_rcp_f32_e64 v69, v69
v_mfma_f32_32x32x16_bf16 v[48:63], a[84:87], a[132:135], v[48:63]
ds_read_b128 a[132:135], v1 offset:21504
v_rcp_f32_e64 v70, v70
v_cvt_pk_bf16_f32 v183, v94, v95
v_rcp_f32_e64 v71, v71
v_mfma_f32_32x32x16_bf16 v[48:63], a[88:91], a[136:139], v[48:63]
ds_read_b128 a[136:139], v1 offset:22528
v_rcp_f32 v72, v72
v_rcp_f32_e64 v73, v73
s_waitcnt lgkmcnt(5)
v_mfma_f32_32x32x16_bf16 v[48:63], a[92:95], a[140:143], v[48:63]
ds_read_b128 a[140:143], v1 offset:23552
v_rcp_f32 v74, v74
v_rcp_f32 v75, v75
v_rcp_f32 v76, v76
v_rcp_f32 v77, v77
v_rcp_f32 v78, v78
v_rcp_f32 v79, v79
v_pk_mul_f32 v[64:65], v[32:33], v[64:65]
v_pk_mul_f32 v[66:67], v[34:35], v[66:67]
v_pk_mul_f32 v[68:69], v[36:37], v[68:69]
v_pk_mul_f32 v[70:71], v[38:39], v[70:71]
v_pk_mul_f32 v[72:73], v[40:41], v[72:73]
v_pk_mul_f32 v[74:75], v[42:43], v[74:75]
v_pk_mul_f32 v[76:77], v[44:45], v[76:77]
v_pk_mul_f32 v[78:79], v[46:47], v[78:79]
v_pk_fma_f32 v[16:17], v[64:65], v[64:65], v[16:17]
v_pk_fma_f32 v[18:19], v[66:67], v[66:67], v[18:19]
v_pk_fma_f32 v[20:21], v[68:69], v[68:69], v[20:21]
v_pk_fma_f32 v[22:23], v[70:71], v[70:71], v[22:23]
v_pk_fma_f32 v[24:25], v[72:73], v[72:73], v[24:25]
v_pk_fma_f32 v[26:27], v[74:75], v[74:75], v[26:27]
v_pk_fma_f32 v[28:29], v[76:77], v[76:77], v[28:29]
v_pk_fma_f32 v[30:31], v[78:79], v[78:79], v[30:31]
v_pk_fma_f32 v[80:81], v[48:49], v[48:49], s[68:69]
v_pk_fma_f32 v[82:83], v[50:51], v[50:51], s[68:69]
v_pk_fma_f32 v[84:85], v[52:53], v[52:53], s[68:69]
v_pk_fma_f32 v[86:87], v[54:55], v[54:55], s[68:69]
v_pk_fma_f32 v[88:89], v[56:57], v[56:57], s[68:69]
v_pk_fma_f32 v[90:91], v[58:59], v[58:59], s[68:69]
v_pk_fma_f32 v[92:93], v[60:61], v[60:61], s[68:69]
v_pk_fma_f32 v[94:95], v[62:63], v[62:63], s[68:69]
v_pk_mul_f32 v[80:81], v[48:49], v[80:81] neg_lo:[1,0] neg_hi:[1,0]
v_pk_mul_f32 v[82:83], v[50:51], v[82:83] neg_lo:[1,0] neg_hi:[1,0]
v_pk_mul_f32 v[84:85], v[52:53], v[84:85] neg_lo:[1,0] neg_hi:[1,0]
v_pk_mul_f32 v[86:87], v[54:55], v[86:87] neg_lo:[1,0] neg_hi:[1,0]
v_pk_mul_f32 v[88:89], v[56:57], v[88:89] neg_lo:[1,0] neg_hi:[1,0]
v_pk_mul_f32 v[90:91], v[58:59], v[90:91] neg_lo:[1,0] neg_hi:[1,0]
v_pk_mul_f32 v[92:93], v[60:61], v[92:93] neg_lo:[1,0] neg_hi:[1,0]
v_pk_mul_f32 v[94:95], v[62:63], v[94:95] neg_lo:[1,0] neg_hi:[1,0]
v_mfma_f32_32x32x16_bf16 v[32:47], a[0:3], a[96:99], 0
v_exp_f32_e64 v80, v80
v_cvt_pk_bf16_f32 v64, v64, v65
v_exp_f32_e64 v81, v81
v_cvt_pk_bf16_f32 v65, v66, v67
v_mfma_f32_32x32x16_bf16 v[32:47], a[4:7], a[100:103], v[32:47]
v_exp_f32_e64 v82, v82
v_cvt_pk_bf16_f32 v66, v68, v69
v_exp_f32_e64 v83, v83
v_cvt_pk_bf16_f32 v67, v70, v71
v_mfma_f32_32x32x16_bf16 v[32:47], a[8:11], a[104:107], v[32:47]
v_exp_f32_e64 v84, v84
v_accvgpr_write_b32 a224, v64
v_exp_f32_e64 v85, v85
v_accvgpr_write_b32 a225, v65
v_mfma_f32_32x32x16_bf16 v[32:47], a[12:15], a[108:111], v[32:47]
v_exp_f32 v86, v86
v_exp_f32 v87, v87
v_exp_f32_e64 v88, v88
v_mfma_f32_32x32x16_bf16 v[32:47], a[16:19], a[112:115], v[32:47]
v_exp_f32_e64 v89, v89
v_accvgpr_write_b32 a226, v66
v_exp_f32 v90, v90
s_waitcnt lgkmcnt(0)
v_mfma_f32_32x32x16_bf16 v[32:47], a[20:23], a[116:119], v[32:47]
v_exp_f32_e64 v91, v91
v_accvgpr_write_b32 a227, v67
v_exp_f32 v92, v92
v_exp_f32 v93, v93
v_exp_f32 v94, v94
v_exp_f32 v95, v95
v_pk_add_f32 v[80:81], v[80:81], s[70:71]
v_pk_add_f32 v[82:83], v[82:83], s[70:71]
v_pk_add_f32 v[84:85], v[84:85], s[70:71]
v_pk_add_f32 v[86:87], v[86:87], s[70:71]
v_pk_add_f32 v[88:89], v[88:89], s[70:71]
v_pk_add_f32 v[90:91], v[90:91], s[70:71]
v_pk_add_f32 v[92:93], v[92:93], s[70:71]
v_pk_add_f32 v[94:95], v[94:95], s[70:71]
v_mfma_f32_32x32x16_bf16 v[32:47], a[24:27], a[120:123], v[32:47]
v_rcp_f32_e64 v80, v80
v_cvt_pk_bf16_f32 v68, v72, v73
v_rcp_f32_e64 v81, v81
v_cvt_pk_bf16_f32 v69, v74, v75
v_mfma_f32_32x32x16_bf16 v[32:47], a[28:31], a[124:127], v[32:47]
v_rcp_f32_e64 v82, v82
v_cvt_pk_bf16_f32 v70, v76, v77
v_rcp_f32_e64 v83, v83
v_cvt_pk_bf16_f32 v71, v78, v79
v_mfma_f32_32x32x16_bf16 v[32:47], a[32:35], a[128:131], v[32:47]
v_rcp_f32_e64 v84, v84
v_accvgpr_write_b32 a228, v68
v_rcp_f32_e64 v85, v85
v_accvgpr_write_b32 a229, v69
v_mfma_f32_32x32x16_bf16 v[32:47], a[36:39], a[132:135], v[32:47]
v_rcp_f32 v86, v86
v_rcp_f32 v87, v87
v_rcp_f32_e64 v88, v88
v_mfma_f32_32x32x16_bf16 v[32:47], a[40:43], a[136:139], v[32:47]
v_rcp_f32_e64 v89, v89
v_accvgpr_write_b32 a230, v70
v_rcp_f32_e64 v90, v90
v_mfma_f32_32x32x16_bf16 v[32:47], a[44:47], a[140:143], v[32:47]
v_rcp_f32_e64 v91, v91
v_accvgpr_write_b32 a231, v71
v_rcp_f32 v92, v92
v_rcp_f32 v93, v93
v_rcp_f32 v94, v94
v_rcp_f32 v95, v95
v_pk_mul_f32 v[80:81], v[48:49], v[80:81]
v_pk_mul_f32 v[82:83], v[50:51], v[82:83]
v_pk_mul_f32 v[84:85], v[52:53], v[84:85]
v_pk_mul_f32 v[86:87], v[54:55], v[86:87]
v_pk_mul_f32 v[88:89], v[56:57], v[88:89]
v_pk_mul_f32 v[90:91], v[58:59], v[90:91]
v_pk_mul_f32 v[92:93], v[60:61], v[92:93]
v_pk_mul_f32 v[94:95], v[62:63], v[94:95]
v_pk_fma_f32 v[240:241], v[80:81], v[80:81], v[240:241]
v_pk_fma_f32 v[242:243], v[82:83], v[82:83], v[242:243]
v_pk_fma_f32 v[244:245], v[84:85], v[84:85], v[244:245]
v_pk_fma_f32 v[246:247], v[86:87], v[86:87], v[246:247]
v_pk_fma_f32 v[248:249], v[88:89], v[88:89], v[248:249]
v_pk_fma_f32 v[250:251], v[90:91], v[90:91], v[250:251]
v_pk_fma_f32 v[252:253], v[92:93], v[92:93], v[252:253]
v_pk_fma_f32 v[254:255], v[94:95], v[94:95], v[254:255]
v_pk_fma_f32 v[64:65], v[32:33], v[32:33], s[68:69]
v_pk_fma_f32 v[66:67], v[34:35], v[34:35], s[68:69]
v_pk_fma_f32 v[68:69], v[36:37], v[36:37], s[68:69]
v_pk_fma_f32 v[70:71], v[38:39], v[38:39], s[68:69]
v_pk_fma_f32 v[72:73], v[40:41], v[40:41], s[68:69]
v_pk_fma_f32 v[74:75], v[42:43], v[42:43], s[68:69]
v_pk_fma_f32 v[76:77], v[44:45], v[44:45], s[68:69]
v_pk_fma_f32 v[78:79], v[46:47], v[46:47], s[68:69]
v_pk_mul_f32 v[64:65], v[32:33], v[64:65] neg_lo:[1,0] neg_hi:[1,0]
v_pk_mul_f32 v[66:67], v[34:35], v[66:67] neg_lo:[1,0] neg_hi:[1,0]
v_pk_mul_f32 v[68:69], v[36:37], v[68:69] neg_lo:[1,0] neg_hi:[1,0]
v_pk_mul_f32 v[70:71], v[38:39], v[70:71] neg_lo:[1,0] neg_hi:[1,0]
v_pk_mul_f32 v[72:73], v[40:41], v[72:73] neg_lo:[1,0] neg_hi:[1,0]
v_pk_mul_f32 v[74:75], v[42:43], v[74:75] neg_lo:[1,0] neg_hi:[1,0]
v_pk_mul_f32 v[76:77], v[44:45], v[76:77] neg_lo:[1,0] neg_hi:[1,0]
v_pk_mul_f32 v[78:79], v[46:47], v[78:79] neg_lo:[1,0] neg_hi:[1,0]
v_mfma_f32_32x32x16_bf16 v[48:63], a[48:51], a[96:99], 0
ds_read_b128 a[96:99], v1 offset:24576
v_exp_f32_e64 v64, v64
v_cvt_pk_bf16_f32 v184, v80, v81
v_exp_f32_e64 v65, v65
v_mfma_f32_32x32x16_bf16 v[48:63], a[52:55], a[100:103], v[48:63]
ds_read_b128 a[100:103], v1 offset:25600
v_exp_f32_e64 v66, v66
v_cvt_pk_bf16_f32 v185, v82, v83
v_exp_f32_e64 v67, v67
v_mfma_f32_32x32x16_bf16 v[48:63], a[56:59], a[104:107], v[48:63]
ds_read_b128 a[104:107], v1 offset:26624
v_exp_f32_e64 v68, v68
v_cvt_pk_bf16_f32 v186, v84, v85
v_exp_f32_e64 v69, v69
v_mfma_f32_32x32x16_bf16 v[48:63], a[60:63], a[108:111], v[48:63]
ds_read_b128 a[108:111], v1 offset:27648
v_exp_f32_e64 v70, v70
v_cvt_pk_bf16_f32 v187, v86, v87
v_exp_f32_e64 v71, v71
v_mfma_f32_32x32x16_bf16 v[48:63], a[64:67], a[112:115], v[48:63]
ds_read_b128 a[112:115], v1 offset:28672
v_exp_f32 v72, v72
v_exp_f32 v73, v73
v_mfma_f32_32x32x16_bf16 v[48:63], a[68:71], a[116:119], v[48:63]
ds_read_b128 a[116:119], v1 offset:29696
v_exp_f32 v74, v74
v_exp_f32 v75, v75
v_exp_f32 v76, v76
v_exp_f32 v77, v77
v_exp_f32 v78, v78
v_exp_f32 v79, v79
v_pk_add_f32 v[64:65], v[64:65], s[70:71]
v_pk_add_f32 v[66:67], v[66:67], s[70:71]
v_pk_add_f32 v[68:69], v[68:69], s[70:71]
v_pk_add_f32 v[70:71], v[70:71], s[70:71]
v_pk_add_f32 v[72:73], v[72:73], s[70:71]
v_pk_add_f32 v[74:75], v[74:75], s[70:71]
v_pk_add_f32 v[76:77], v[76:77], s[70:71]
v_pk_add_f32 v[78:79], v[78:79], s[70:71]
v_mfma_f32_32x32x16_bf16 v[48:63], a[72:75], a[120:123], v[48:63]
ds_read_b128 a[120:123], v1 offset:30720
v_rcp_f32_e64 v64, v64
v_cvt_pk_bf16_f32 v188, v88, v89
v_rcp_f32_e64 v65, v65
v_mfma_f32_32x32x16_bf16 v[48:63], a[76:79], a[124:127], v[48:63]
ds_read_b128 a[124:127], v1 offset:31744
v_rcp_f32_e64 v66, v66
v_cvt_pk_bf16_f32 v189, v90, v91
v_rcp_f32_e64 v67, v67
v_mfma_f32_32x32x16_bf16 v[48:63], a[80:83], a[128:131], v[48:63]
ds_read_b128 a[128:131], v1 offset:32768
v_rcp_f32_e64 v68, v68
v_cvt_pk_bf16_f32 v190, v92, v93
v_rcp_f32_e64 v69, v69
v_mfma_f32_32x32x16_bf16 v[48:63], a[84:87], a[132:135], v[48:63]
ds_read_b128 a[132:135], v1 offset:33792
v_rcp_f32_e64 v70, v70
v_cvt_pk_bf16_f32 v191, v94, v95
v_rcp_f32_e64 v71, v71
v_mfma_f32_32x32x16_bf16 v[48:63], a[88:91], a[136:139], v[48:63]
ds_read_b128 a[136:139], v1 offset:34816
v_rcp_f32 v72, v72
v_rcp_f32_e64 v73, v73
s_waitcnt lgkmcnt(5)
v_mfma_f32_32x32x16_bf16 v[48:63], a[92:95], a[140:143], v[48:63]
ds_read_b128 a[140:143], v1 offset:35840
v_rcp_f32 v74, v74
v_rcp_f32 v75, v75
v_rcp_f32 v76, v76
v_rcp_f32 v77, v77
v_rcp_f32 v78, v78
v_rcp_f32 v79, v79
v_pk_mul_f32 v[64:65], v[32:33], v[64:65]
v_pk_mul_f32 v[66:67], v[34:35], v[66:67]
v_pk_mul_f32 v[68:69], v[36:37], v[68:69]
v_pk_mul_f32 v[70:71], v[38:39], v[70:71]
v_pk_mul_f32 v[72:73], v[40:41], v[72:73]
v_pk_mul_f32 v[74:75], v[42:43], v[74:75]
v_pk_mul_f32 v[76:77], v[44:45], v[76:77]
v_pk_mul_f32 v[78:79], v[46:47], v[78:79]
v_pk_fma_f32 v[16:17], v[64:65], v[64:65], v[16:17]
v_pk_fma_f32 v[18:19], v[66:67], v[66:67], v[18:19]
v_pk_fma_f32 v[20:21], v[68:69], v[68:69], v[20:21]
v_pk_fma_f32 v[22:23], v[70:71], v[70:71], v[22:23]
v_pk_fma_f32 v[24:25], v[72:73], v[72:73], v[24:25]
v_pk_fma_f32 v[26:27], v[74:75], v[74:75], v[26:27]
v_pk_fma_f32 v[28:29], v[76:77], v[76:77], v[28:29]
v_pk_fma_f32 v[30:31], v[78:79], v[78:79], v[30:31]
v_pk_fma_f32 v[80:81], v[48:49], v[48:49], s[68:69]
v_pk_fma_f32 v[82:83], v[50:51], v[50:51], s[68:69]
v_pk_fma_f32 v[84:85], v[52:53], v[52:53], s[68:69]
v_pk_fma_f32 v[86:87], v[54:55], v[54:55], s[68:69]
v_pk_fma_f32 v[88:89], v[56:57], v[56:57], s[68:69]
v_pk_fma_f32 v[90:91], v[58:59], v[58:59], s[68:69]
v_pk_fma_f32 v[92:93], v[60:61], v[60:61], s[68:69]
v_pk_fma_f32 v[94:95], v[62:63], v[62:63], s[68:69]
v_pk_mul_f32 v[80:81], v[48:49], v[80:81] neg_lo:[1,0] neg_hi:[1,0]
v_pk_mul_f32 v[82:83], v[50:51], v[82:83] neg_lo:[1,0] neg_hi:[1,0]
v_pk_mul_f32 v[84:85], v[52:53], v[84:85] neg_lo:[1,0] neg_hi:[1,0]
v_pk_mul_f32 v[86:87], v[54:55], v[86:87] neg_lo:[1,0] neg_hi:[1,0]
v_pk_mul_f32 v[88:89], v[56:57], v[88:89] neg_lo:[1,0] neg_hi:[1,0]
v_pk_mul_f32 v[90:91], v[58:59], v[90:91] neg_lo:[1,0] neg_hi:[1,0]
v_pk_mul_f32 v[92:93], v[60:61], v[92:93] neg_lo:[1,0] neg_hi:[1,0]
v_pk_mul_f32 v[94:95], v[62:63], v[94:95] neg_lo:[1,0] neg_hi:[1,0]
v_mfma_f32_32x32x16_bf16 v[32:47], a[0:3], a[96:99], 0
v_exp_f32_e64 v80, v80
v_cvt_pk_bf16_f32 v64, v64, v65
v_exp_f32_e64 v81, v81
v_cvt_pk_bf16_f32 v65, v66, v67
v_mfma_f32_32x32x16_bf16 v[32:47], a[4:7], a[100:103], v[32:47]
v_exp_f32_e64 v82, v82
v_cvt_pk_bf16_f32 v66, v68, v69
v_exp_f32_e64 v83, v83
v_cvt_pk_bf16_f32 v67, v70, v71
v_mfma_f32_32x32x16_bf16 v[32:47], a[8:11], a[104:107], v[32:47]
v_exp_f32_e64 v84, v84
v_accvgpr_write_b32 a232, v64
v_exp_f32_e64 v85, v85
v_accvgpr_write_b32 a233, v65
v_mfma_f32_32x32x16_bf16 v[32:47], a[12:15], a[108:111], v[32:47]
v_exp_f32 v86, v86
v_exp_f32 v87, v87
v_exp_f32_e64 v88, v88
v_mfma_f32_32x32x16_bf16 v[32:47], a[16:19], a[112:115], v[32:47]
v_exp_f32_e64 v89, v89
v_accvgpr_write_b32 a234, v66
v_exp_f32 v90, v90
s_waitcnt lgkmcnt(0)
v_mfma_f32_32x32x16_bf16 v[32:47], a[20:23], a[116:119], v[32:47]
v_exp_f32_e64 v91, v91
v_accvgpr_write_b32 a235, v67
v_exp_f32 v92, v92
v_exp_f32 v93, v93
v_exp_f32 v94, v94
v_exp_f32 v95, v95
v_pk_add_f32 v[80:81], v[80:81], s[70:71]
v_pk_add_f32 v[82:83], v[82:83], s[70:71]
v_pk_add_f32 v[84:85], v[84:85], s[70:71]
v_pk_add_f32 v[86:87], v[86:87], s[70:71]
v_pk_add_f32 v[88:89], v[88:89], s[70:71]
v_pk_add_f32 v[90:91], v[90:91], s[70:71]
v_pk_add_f32 v[92:93], v[92:93], s[70:71]
v_pk_add_f32 v[94:95], v[94:95], s[70:71]
v_mfma_f32_32x32x16_bf16 v[32:47], a[24:27], a[120:123], v[32:47]
v_rcp_f32_e64 v80, v80
v_cvt_pk_bf16_f32 v68, v72, v73
v_rcp_f32_e64 v81, v81
v_cvt_pk_bf16_f32 v69, v74, v75
v_mfma_f32_32x32x16_bf16 v[32:47], a[28:31], a[124:127], v[32:47]
v_rcp_f32_e64 v82, v82
v_cvt_pk_bf16_f32 v70, v76, v77
v_rcp_f32_e64 v83, v83
v_cvt_pk_bf16_f32 v71, v78, v79
v_mfma_f32_32x32x16_bf16 v[32:47], a[32:35], a[128:131], v[32:47]
v_rcp_f32_e64 v84, v84
v_accvgpr_write_b32 a236, v68
v_rcp_f32_e64 v85, v85
v_accvgpr_write_b32 a237, v69
v_mfma_f32_32x32x16_bf16 v[32:47], a[36:39], a[132:135], v[32:47]
v_rcp_f32_e64 v86, v86
v_accvgpr_write_b32 a238, v70
v_rcp_f32_e64 v87, v87
v_accvgpr_write_b32 a239, v71
v_mfma_f32_32x32x16_bf16 v[32:47], a[40:43], a[136:139], v[32:47]
buffer_load_dwordx4 a[0:3], v1, s[32:35], s57 offen offset:0 sc1
v_rcp_f32 v88, v88
v_rcp_f32 v89, v89
v_mfma_f32_32x32x16_bf16 v[32:47], a[44:47], a[140:143], v[32:47]
buffer_load_dwordx4 a[4:7], v1, s[32:35], s57 offen offset:1024 sc1
buffer_load_dwordx4 a[8:11], v1, s[32:35], s57 offen offset:2048 sc1
buffer_load_dwordx4 a[12:15], v1, s[32:35], s57 offen offset:3072 sc1
v_rcp_f32 v90, v90
v_rcp_f32 v91, v91
v_rcp_f32 v92, v92
v_rcp_f32 v93, v93
v_rcp_f32 v94, v94
v_rcp_f32 v95, v95
v_pk_mul_f32 v[80:81], v[48:49], v[80:81]
v_pk_mul_f32 v[82:83], v[50:51], v[82:83]
v_pk_mul_f32 v[84:85], v[52:53], v[84:85]
v_pk_mul_f32 v[86:87], v[54:55], v[86:87]
v_pk_mul_f32 v[88:89], v[56:57], v[88:89]
v_pk_mul_f32 v[90:91], v[58:59], v[90:91]
v_pk_mul_f32 v[92:93], v[60:61], v[92:93]
v_pk_mul_f32 v[94:95], v[62:63], v[94:95]
v_pk_fma_f32 v[240:241], v[80:81], v[80:81], v[240:241]
v_pk_fma_f32 v[242:243], v[82:83], v[82:83], v[242:243]
v_pk_fma_f32 v[244:245], v[84:85], v[84:85], v[244:245]
v_pk_fma_f32 v[246:247], v[86:87], v[86:87], v[246:247]
v_pk_fma_f32 v[248:249], v[88:89], v[88:89], v[248:249]
v_pk_fma_f32 v[250:251], v[90:91], v[90:91], v[250:251]
v_pk_fma_f32 v[252:253], v[92:93], v[92:93], v[252:253]
v_pk_fma_f32 v[254:255], v[94:95], v[94:95], v[254:255]
v_pk_fma_f32 v[64:65], v[32:33], v[32:33], s[68:69]
v_pk_fma_f32 v[66:67], v[34:35], v[34:35], s[68:69]
v_pk_fma_f32 v[68:69], v[36:37], v[36:37], s[68:69]
v_pk_fma_f32 v[70:71], v[38:39], v[38:39], s[68:69]
v_pk_fma_f32 v[72:73], v[40:41], v[40:41], s[68:69]
v_pk_fma_f32 v[74:75], v[42:43], v[42:43], s[68:69]
v_pk_fma_f32 v[76:77], v[44:45], v[44:45], s[68:69]
v_pk_fma_f32 v[78:79], v[46:47], v[46:47], s[68:69]
v_pk_mul_f32 v[64:65], v[32:33], v[64:65] neg_lo:[1,0] neg_hi:[1,0]
v_pk_mul_f32 v[66:67], v[34:35], v[66:67] neg_lo:[1,0] neg_hi:[1,0]
v_pk_mul_f32 v[68:69], v[36:37], v[68:69] neg_lo:[1,0] neg_hi:[1,0]
v_pk_mul_f32 v[70:71], v[38:39], v[70:71] neg_lo:[1,0] neg_hi:[1,0]
v_pk_mul_f32 v[72:73], v[40:41], v[72:73] neg_lo:[1,0] neg_hi:[1,0]
v_pk_mul_f32 v[74:75], v[42:43], v[74:75] neg_lo:[1,0] neg_hi:[1,0]
v_pk_mul_f32 v[76:77], v[44:45], v[76:77] neg_lo:[1,0] neg_hi:[1,0]
v_pk_mul_f32 v[78:79], v[46:47], v[78:79] neg_lo:[1,0] neg_hi:[1,0]
v_mfma_f32_32x32x16_bf16 v[48:63], a[48:51], a[96:99], 0
ds_read_b128 a[96:99], v4 offset:0
v_exp_f32_e64 v64, v64
v_cvt_pk_bf16_f32 v192, v80, v81
v_exp_f32_e64 v65, v65
v_mfma_f32_32x32x16_bf16 v[48:63], a[52:55], a[100:103], v[48:63]
ds_read_b128 a[100:103], v4 offset:1024
v_exp_f32_e64 v66, v66
v_cvt_pk_bf16_f32 v193, v82, v83
v_exp_f32_e64 v67, v67
v_mfma_f32_32x32x16_bf16 v[48:63], a[56:59], a[104:107], v[48:63]
ds_read_b128 a[104:107], v4 offset:2048
v_exp_f32_e64 v68, v68
v_cvt_pk_bf16_f32 v194, v84, v85
v_exp_f32_e64 v69, v69
v_mfma_f32_32x32x16_bf16 v[48:63], a[60:63], a[108:111], v[48:63]
ds_read_b128 a[108:111], v4 offset:3072
v_exp_f32_e64 v70, v70
v_cvt_pk_bf16_f32 v195, v86, v87
v_exp_f32_e64 v71, v71
v_mfma_f32_32x32x16_bf16 v[48:63], a[64:67], a[112:115], v[48:63]
ds_read_b128 a[112:115], v4 offset:4096
buffer_load_dwordx4 a[16:19], v2, s[32:35], s57 offen offset:0 sc1
buffer_load_dwordx4 a[20:23], v2, s[32:35], s57 offen offset:1024 sc1
v_exp_f32_e64 v72, v72
v_mfma_f32_32x32x16_bf16 v[48:63], a[68:71], a[116:119], v[48:63]
ds_read_b128 a[116:119], v4 offset:5120
buffer_load_dwordx4 a[24:27], v2, s[32:35], s57 offen offset:2048 sc1
buffer_load_dwordx4 a[28:31], v2, s[32:35], s57 offen offset:3072 sc1
v_exp_f32 v73, v73
v_exp_f32 v74, v74
v_exp_f32 v75, v75
v_exp_f32 v76, v76
v_exp_f32 v77, v77
v_exp_f32 v78, v78
v_exp_f32_e64 v79, v79
v_pk_add_f32 v[64:65], v[64:65], s[70:71]
v_pk_add_f32 v[66:67], v[66:67], s[70:71]
v_pk_add_f32 v[68:69], v[68:69], s[70:71]
v_pk_add_f32 v[70:71], v[70:71], s[70:71]
v_pk_add_f32 v[72:73], v[72:73], s[70:71]
v_pk_add_f32 v[74:75], v[74:75], s[70:71]
v_pk_add_f32 v[76:77], v[76:77], s[70:71]
v_pk_add_f32 v[78:79], v[78:79], s[70:71]
v_mfma_f32_32x32x16_bf16 v[48:63], a[72:75], a[120:123], v[48:63]
ds_read_b128 a[120:123], v4 offset:6144
v_rcp_f32_e64 v64, v64
v_cvt_pk_bf16_f32 v196, v88, v89
v_rcp_f32_e64 v65, v65
v_mfma_f32_32x32x16_bf16 v[48:63], a[76:79], a[124:127], v[48:63]
ds_read_b128 a[124:127], v4 offset:7168
v_rcp_f32_e64 v66, v66
v_cvt_pk_bf16_f32 v197, v90, v91
v_rcp_f32_e64 v67, v67
v_mfma_f32_32x32x16_bf16 v[48:63], a[80:83], a[128:131], v[48:63]
ds_read_b128 a[128:131], v4 offset:8192
v_rcp_f32_e64 v68, v68
v_cvt_pk_bf16_f32 v198, v92, v93
v_rcp_f32_e64 v69, v69
v_mfma_f32_32x32x16_bf16 v[48:63], a[84:87], a[132:135], v[48:63]
ds_read_b128 a[132:135], v4 offset:9216
v_rcp_f32_e64 v70, v70
v_cvt_pk_bf16_f32 v199, v94, v95
v_rcp_f32_e64 v71, v71
v_mfma_f32_32x32x16_bf16 v[48:63], a[88:91], a[136:139], v[48:63]
ds_read_b128 a[136:139], v4 offset:10240
buffer_load_dwordx4 a[32:35], v3, s[32:35], s57 offen offset:0 sc1
buffer_load_dwordx4 a[36:39], v3, s[32:35], s57 offen offset:1024 sc1
v_rcp_f32 v72, v72
s_waitcnt vmcnt(16) lgkmcnt(5)
v_mfma_f32_32x32x16_bf16 v[48:63], a[92:95], a[140:143], v[48:63]
ds_read_b128 a[140:143], v4 offset:11264
buffer_load_dwordx4 a[40:43], v3, s[32:35], s57 offen offset:2048 sc1
buffer_load_dwordx4 a[44:47], v3, s[32:35], s57 offen offset:3072 sc1
v_rcp_f32 v73, v73
v_rcp_f32 v74, v74
v_rcp_f32 v75, v75
v_rcp_f32 v76, v76
v_rcp_f32 v77, v77
v_rcp_f32 v78, v78
v_rcp_f32_e64 v79, v79
v_pk_mul_f32 v[64:65], v[32:33], v[64:65]
v_pk_mul_f32 v[66:67], v[34:35], v[66:67]
v_pk_mul_f32 v[68:69], v[36:37], v[68:69]
v_pk_mul_f32 v[70:71], v[38:39], v[70:71]
v_pk_mul_f32 v[72:73], v[40:41], v[72:73]
v_pk_mul_f32 v[74:75], v[42:43], v[74:75]
v_pk_mul_f32 v[76:77], v[44:45], v[76:77]
v_pk_mul_f32 v[78:79], v[46:47], v[78:79]
v_pk_fma_f32 v[16:17], v[64:65], v[64:65], v[16:17]
v_pk_fma_f32 v[18:19], v[66:67], v[66:67], v[18:19]
v_pk_fma_f32 v[20:21], v[68:69], v[68:69], v[20:21]
v_pk_fma_f32 v[22:23], v[70:71], v[70:71], v[22:23]
v_pk_fma_f32 v[24:25], v[72:73], v[72:73], v[24:25]
v_pk_fma_f32 v[26:27], v[74:75], v[74:75], v[26:27]
v_pk_fma_f32 v[28:29], v[76:77], v[76:77], v[28:29]
v_pk_fma_f32 v[30:31], v[78:79], v[78:79], v[30:31]
v_pk_fma_f32 v[80:81], v[48:49], v[48:49], s[68:69]
v_pk_fma_f32 v[82:83], v[50:51], v[50:51], s[68:69]
v_pk_fma_f32 v[84:85], v[52:53], v[52:53], s[68:69]
v_pk_fma_f32 v[86:87], v[54:55], v[54:55], s[68:69]
v_pk_fma_f32 v[88:89], v[56:57], v[56:57], s[68:69]
v_pk_fma_f32 v[90:91], v[58:59], v[58:59], s[68:69]
v_pk_fma_f32 v[92:93], v[60:61], v[60:61], s[68:69]
v_pk_fma_f32 v[94:95], v[62:63], v[62:63], s[68:69]
v_pk_mul_f32 v[80:81], v[48:49], v[80:81] neg_lo:[1,0] neg_hi:[1,0]
v_pk_mul_f32 v[82:83], v[50:51], v[82:83] neg_lo:[1,0] neg_hi:[1,0]
v_pk_mul_f32 v[84:85], v[52:53], v[84:85] neg_lo:[1,0] neg_hi:[1,0]
v_pk_mul_f32 v[86:87], v[54:55], v[86:87] neg_lo:[1,0] neg_hi:[1,0]
v_pk_mul_f32 v[88:89], v[56:57], v[88:89] neg_lo:[1,0] neg_hi:[1,0]
v_pk_mul_f32 v[90:91], v[58:59], v[90:91] neg_lo:[1,0] neg_hi:[1,0]
v_pk_mul_f32 v[92:93], v[60:61], v[92:93] neg_lo:[1,0] neg_hi:[1,0]
v_pk_mul_f32 v[94:95], v[62:63], v[94:95] neg_lo:[1,0] neg_hi:[1,0]
v_mfma_f32_32x32x16_bf16 v[32:47], a[144:147], a[96:99], 0
v_exp_f32_e64 v80, v80
v_cvt_pk_bf16_f32 v64, v64, v65
v_cvt_pk_bf16_f32 v65, v66, v67
v_exp_f32_e64 v81, v81
v_cvt_pk_bf16_f32 v66, v68, v69
v_mfma_f32_32x32x16_bf16 v[32:47], a[148:151], a[100:103], v[32:47]
v_exp_f32_e64 v82, v82
v_cvt_pk_bf16_f32 v67, v70, v71
v_accvgpr_write_b32 a240, v64
v_exp_f32_e64 v83, v83
v_accvgpr_write_b32 a241, v65
v_mfma_f32_32x32x16_bf16 v[32:47], a[152:155], a[104:107], v[32:47]
v_exp_f32_e64 v84, v84
v_accvgpr_write_b32 a242, v66
v_accvgpr_write_b32 a243, v67
v_exp_f32_e64 v85, v85
v_add_f32_dpp v16, v16, v16 row_ror:8 row_mask:0xf bank_mask:0x3
v_mfma_f32_32x32x16_bf16 v[32:47], a[156:159], a[108:111], v[32:47]
v_exp_f32_e64 v86, v86
v_add_f32_dpp v17, v17, v17 row_ror:8 row_mask:0xf bank_mask:0x3
v_add_f32_dpp v18, v18, v18 row_ror:8 row_mask:0xf bank_mask:0x3
v_exp_f32_e64 v87, v87
v_add_f32_dpp v19, v19, v19 row_ror:8 row_mask:0xf bank_mask:0x3
v_mfma_f32_32x32x16_bf16 v[32:47], a[160:163], a[112:115], v[32:47]
v_exp_f32_e64 v88, v88
v_add_f32_dpp v24, v24, v24 row_ror:8 row_mask:0xf bank_mask:0x3
v_exp_f32_e64 v89, v89
v_add_f32_dpp v25, v25, v25 row_ror:8 row_mask:0xf bank_mask:0x3
s_waitcnt vmcnt(12) lgkmcnt(0)
v_mfma_f32_32x32x16_bf16 v[32:47], a[164:167], a[116:119], v[32:47]
v_exp_f32 v90, v90
v_add_f32_dpp v26, v26, v26 row_ror:8 row_mask:0xf bank_mask:0x3
v_add_f32_dpp v27, v27, v27 row_ror:8 row_mask:0xf bank_mask:0x3
v_exp_f32_e64 v91, v91
v_add_f32_dpp v16, v20, v20 row_ror:8 row_mask:0xf bank_mask:0xc
v_add_f32_dpp v17, v21, v21 row_ror:8 row_mask:0xf bank_mask:0xc
v_exp_f32_e64 v92, v92
v_add_f32_dpp v18, v22, v22 row_ror:8 row_mask:0xf bank_mask:0xc
v_add_f32_dpp v19, v23, v23 row_ror:8 row_mask:0xf bank_mask:0xc
v_exp_f32_e64 v93, v93
v_add_f32_dpp v24, v28, v28 row_ror:8 row_mask:0xf bank_mask:0xc
v_add_f32_dpp v25, v29, v29 row_ror:8 row_mask:0xf bank_mask:0xc
v_exp_f32_e64 v94, v94
v_add_f32_dpp v26, v30, v30 row_ror:8 row_mask:0xf bank_mask:0xc
v_exp_f32_e64 v95, v95
v_add_f32_dpp v27, v31, v31 row_ror:8 row_mask:0xf bank_mask:0xc
v_pk_add_f32 v[80:81], v[80:81], s[70:71]
v_pk_add_f32 v[82:83], v[82:83], s[70:71]
v_pk_add_f32 v[84:85], v[84:85], s[70:71]
v_pk_add_f32 v[86:87], v[86:87], s[70:71]
v_pk_add_f32 v[88:89], v[88:89], s[70:71]
v_pk_add_f32 v[90:91], v[90:91], s[70:71]
v_pk_add_f32 v[92:93], v[92:93], s[70:71]
v_pk_add_f32 v[94:95], v[94:95], s[70:71]
v_mfma_f32_32x32x16_bf16 v[32:47], a[168:171], a[120:123], v[32:47]
v_rcp_f32_e64 v80, v80
v_cvt_pk_bf16_f32 v68, v72, v73
v_cvt_pk_bf16_f32 v69, v74, v75
v_rcp_f32_e64 v81, v81
v_cvt_pk_bf16_f32 v70, v76, v77
v_mfma_f32_32x32x16_bf16 v[32:47], a[172:175], a[124:127], v[32:47]
v_rcp_f32_e64 v82, v82
v_cvt_pk_bf16_f32 v71, v78, v79
v_accvgpr_write_b32 a244, v68
v_rcp_f32_e64 v83, v83
v_accvgpr_write_b32 a245, v69
v_mfma_f32_32x32x16_bf16 v[32:47], a[176:179], a[128:131], v[32:47]
v_rcp_f32_e64 v84, v84
v_accvgpr_write_b32 a246, v70
v_accvgpr_write_b32 a247, v71
v_rcp_f32_e64 v85, v85
v_add_f32_dpp v16, v16, v16 row_shl:4 row_mask:0xf bank_mask:0x5
v_mfma_f32_32x32x16_bf16 v[32:47], a[180:183], a[132:135], v[32:47]
v_rcp_f32_e64 v86, v86
v_add_f32_dpp v17, v17, v17 row_shl:4 row_mask:0xf bank_mask:0x5
v_add_f32_dpp v24, v24, v24 row_shl:4 row_mask:0xf bank_mask:0x5
v_rcp_f32_e64 v87, v87
v_add_f32_dpp v25, v25, v25 row_shl:4 row_mask:0xf bank_mask:0x5
v_mfma_f32_32x32x16_bf16 v[32:47], a[184:187], a[136:139], v[32:47]
v_rcp_f32_e64 v88, v88
v_add_f32_dpp v16, v18, v18 row_shr:4 row_mask:0xf bank_mask:0xa
v_rcp_f32_e64 v89, v89
v_add_f32_dpp v17, v19, v19 row_shr:4 row_mask:0xf bank_mask:0xa
s_waitcnt vmcnt(6)
v_mfma_f32_32x32x16_bf16 v[32:47], a[188:191], a[140:143], v[32:47]
v_rcp_f32 v90, v90
v_add_f32_dpp v24, v26, v26 row_shr:4 row_mask:0xf bank_mask:0xa
v_add_f32_dpp v25, v27, v27 row_shr:4 row_mask:0xf bank_mask:0xa
v_rcp_f32 v91, v91
v_permlane16_swap_b32 v16, v24
v_permlane16_swap_b32 v17, v25
v_rcp_f32 v92, v92
v_add_f32 v16, v16, v24
v_add_f32 v17, v17, v25
v_rcp_f32_e64 v93, v93
v_add_f32_dpp v16, v16, v16 quad_perm:[1,0,3,2] row_mask:0xf bank_mask:0xf
v_add_f32_dpp v17, v17, v17 quad_perm:[1,0,3,2] row_mask:0xf bank_mask:0xf
v_rcp_f32_e64 v94, v94
v_cndmask_b32_e64 v16, v16, v17, s[72:73]
s_nop 1
v_add_f32_dpp v13, v16, v16 quad_perm:[2,3,0,1] row_mask:0xf bank_mask:0xf
v_rcp_f32 v95, v95
buffer_atomic_add_f32 v13, v7, s[32:35], s66 offen offset:256 sc1
v_pk_mul_f32 v[80:81], v[48:49], v[80:81]
v_pk_mul_f32 v[82:83], v[50:51], v[82:83]
v_pk_mul_f32 v[84:85], v[52:53], v[84:85]
v_pk_mul_f32 v[86:87], v[54:55], v[86:87]
v_pk_mul_f32 v[88:89], v[56:57], v[88:89]
v_pk_mul_f32 v[90:91], v[58:59], v[90:91]
v_pk_mul_f32 v[92:93], v[60:61], v[92:93]
v_pk_mul_f32 v[94:95], v[62:63], v[94:95]
v_pk_fma_f32 v[240:241], v[80:81], v[80:81], v[240:241]
v_pk_fma_f32 v[242:243], v[82:83], v[82:83], v[242:243]
v_pk_fma_f32 v[244:245], v[84:85], v[84:85], v[244:245]
v_pk_fma_f32 v[246:247], v[86:87], v[86:87], v[246:247]
v_pk_fma_f32 v[248:249], v[88:89], v[88:89], v[248:249]
v_pk_fma_f32 v[250:251], v[90:91], v[90:91], v[250:251]
v_pk_fma_f32 v[252:253], v[92:93], v[92:93], v[252:253]
v_pk_fma_f32 v[254:255], v[94:95], v[94:95], v[254:255]
v_pk_fma_f32 v[64:65], v[32:33], v[32:33], s[68:69]
v_pk_fma_f32 v[66:67], v[34:35], v[34:35], s[68:69]
v_pk_fma_f32 v[68:69], v[36:37], v[36:37], s[68:69]
v_pk_fma_f32 v[70:71], v[38:39], v[38:39], s[68:69]
v_pk_fma_f32 v[72:73], v[40:41], v[40:41], s[68:69]
v_pk_fma_f32 v[74:75], v[42:43], v[42:43], s[68:69]
v_pk_fma_f32 v[76:77], v[44:45], v[44:45], s[68:69]
v_pk_fma_f32 v[78:79], v[46:47], v[46:47], s[68:69]
v_pk_mul_f32 v[64:65], v[32:33], v[64:65] neg_lo:[1,0] neg_hi:[1,0]
v_pk_mul_f32 v[66:67], v[34:35], v[66:67] neg_lo:[1,0] neg_hi:[1,0]
v_pk_mul_f32 v[68:69], v[36:37], v[68:69] neg_lo:[1,0] neg_hi:[1,0]
v_pk_mul_f32 v[70:71], v[38:39], v[70:71] neg_lo:[1,0] neg_hi:[1,0]
v_pk_mul_f32 v[72:73], v[40:41], v[72:73] neg_lo:[1,0] neg_hi:[1,0]
v_pk_mul_f32 v[74:75], v[42:43], v[74:75] neg_lo:[1,0] neg_hi:[1,0]
v_pk_mul_f32 v[76:77], v[44:45], v[76:77] neg_lo:[1,0] neg_hi:[1,0]
v_pk_mul_f32 v[78:79], v[46:47], v[78:79] neg_lo:[1,0] neg_hi:[1,0]
v_mfma_f32_32x32x16_bf16 v[48:63], a[0:3], a[96:99], 0
ds_read_b128 a[96:99], v4 offset:12288
v_exp_f32_e64 v64, v64
v_cvt_pk_bf16_f32 v200, v80, v81
v_exp_f32_e64 v65, v65
v_cvt_pk_bf16_f32 v201, v82, v83
v_mfma_f32_32x32x16_bf16 v[48:63], a[4:7], a[100:103], v[48:63]
ds_read_b128 a[100:103], v4 offset:13312
v_exp_f32_e64 v66, v66
v_cvt_pk_bf16_f32 v202, v84, v85
v_exp_f32_e64 v67, v67
v_cvt_pk_bf16_f32 v203, v86, v87
v_mfma_f32_32x32x16_bf16 v[48:63], a[8:11], a[104:107], v[48:63]
ds_read_b128 a[104:107], v4 offset:14336
v_exp_f32_e64 v68, v68
v_add_f32_dpp v240, v240, v240 row_ror:8 row_mask:0xf bank_mask:0x3
v_exp_f32_e64 v69, v69
v_add_f32_dpp v241, v241, v241 row_ror:8 row_mask:0xf bank_mask:0x3
v_mfma_f32_32x32x16_bf16 v[48:63], a[12:15], a[108:111], v[48:63]
ds_read_b128 a[108:111], v4 offset:15360
v_exp_f32_e64 v70, v70
v_add_f32_dpp v242, v242, v242 row_ror:8 row_mask:0xf bank_mask:0x3
v_exp_f32_e64 v71, v71
v_add_f32_dpp v243, v243, v243 row_ror:8 row_mask:0xf bank_mask:0x3
v_mfma_f32_32x32x16_bf16 v[48:63], a[16:19], a[112:115], v[48:63]
ds_read_b128 a[112:115], v4 offset:16384
v_exp_f32_e64 v72, v72
v_add_f32_dpp v248, v248, v248 row_ror:8 row_mask:0xf bank_mask:0x3
v_exp_f32 v73, v73
s_waitcnt vmcnt(1)
v_mfma_f32_32x32x16_bf16 v[48:63], a[20:23], a[116:119], v[48:63]
ds_read_b128 a[116:119], v4 offset:17408
v_exp_f32_e64 v74, v74
v_add_f32_dpp v249, v249, v249 row_ror:8 row_mask:0xf bank_mask:0x3
v_add_f32_dpp v250, v250, v250 row_ror:8 row_mask:0xf bank_mask:0x3
v_exp_f32_e64 v75, v75
v_add_f32_dpp v251, v251, v251 row_ror:8 row_mask:0xf bank_mask:0x3
v_add_f32_dpp v240, v244, v244 row_ror:8 row_mask:0xf bank_mask:0xc
v_exp_f32_e64 v76, v76
v_add_f32_dpp v241, v245, v245 row_ror:8 row_mask:0xf bank_mask:0xc
v_add_f32_dpp v242, v246, v246 row_ror:8 row_mask:0xf bank_mask:0xc
v_exp_f32_e64 v77, v77
v_add_f32_dpp v243, v247, v247 row_ror:8 row_mask:0xf bank_mask:0xc
v_add_f32_dpp v248, v252, v252 row_ror:8 row_mask:0xf bank_mask:0xc
v_exp_f32_e64 v78, v78
v_add_f32_dpp v249, v253, v253 row_ror:8 row_mask:0xf bank_mask:0xc
v_add_f32_dpp v250, v254, v254 row_ror:8 row_mask:0xf bank_mask:0xc
v_exp_f32_e64 v79, v79
v_add_f32_dpp v251, v255, v255 row_ror:8 row_mask:0xf bank_mask:0xc
v_pk_add_f32 v[64:65], v[64:65], s[70:71]
v_pk_add_f32 v[66:67], v[66:67], s[70:71]
v_pk_add_f32 v[68:69], v[68:69], s[70:71]
v_pk_add_f32 v[70:71], v[70:71], s[70:71]
v_pk_add_f32 v[72:73], v[72:73], s[70:71]
v_pk_add_f32 v[74:75], v[74:75], s[70:71]
v_pk_add_f32 v[76:77], v[76:77], s[70:71]
v_pk_add_f32 v[78:79], v[78:79], s[70:71]
v_mfma_f32_32x32x16_bf16 v[48:63], a[24:27], a[120:123], v[48:63]
ds_read_b128 a[120:123], v4 offset:18432
v_rcp_f32_e64 v64, v64
v_cvt_pk_bf16_f32 v204, v88, v89
v_rcp_f32_e64 v65, v65
v_cvt_pk_bf16_f32 v205, v90, v91
v_mfma_f32_32x32x16_bf16 v[48:63], a[28:31], a[124:127], v[48:63]
ds_read_b128 a[124:127], v4 offset:19456
v_rcp_f32_e64 v66, v66
v_cvt_pk_bf16_f32 v206, v92, v93
v_rcp_f32_e64 v67, v67
v_cvt_pk_bf16_f32 v207, v94, v95
v_mfma_f32_32x32x16_bf16 v[48:63], a[32:35], a[128:131], v[48:63]
ds_read_b128 a[128:131], v4 offset:20480
v_rcp_f32_e64 v68, v68
v_add_f32_dpp v240, v240, v240 row_shl:4 row_mask:0xf bank_mask:0x5
v_rcp_f32_e64 v69, v69
v_add_f32_dpp v241, v241, v241 row_shl:4 row_mask:0xf bank_mask:0x5
v_mfma_f32_32x32x16_bf16 v[48:63], a[36:39], a[132:135], v[48:63]
ds_read_b128 a[132:135], v4 offset:21504
v_rcp_f32_e64 v70, v70
v_add_f32_dpp v248, v248, v248 row_shl:4 row_mask:0xf bank_mask:0x5
v_rcp_f32_e64 v71, v71
v_add_f32_dpp v249, v249, v249 row_shl:4 row_mask:0xf bank_mask:0x5
v_mfma_f32_32x32x16_bf16 v[48:63], a[40:43], a[136:139], v[48:63]
ds_read_b128 a[136:139], v4 offset:22528
v_rcp_f32_e64 v72, v72
v_add_f32_dpp v240, v242, v242 row_shr:4 row_mask:0xf bank_mask:0xa
v_rcp_f32 v73, v73
s_waitcnt lgkmcnt(5)
v_mfma_f32_32x32x16_bf16 v[48:63], a[44:47], a[140:143], v[48:63]
ds_read_b128 a[140:143], v4 offset:23552
v_rcp_f32_e64 v74, v74
v_add_f32_dpp v241, v243, v243 row_shr:4 row_mask:0xf bank_mask:0xa
v_add_f32_dpp v248, v250, v250 row_shr:4 row_mask:0xf bank_mask:0xa
v_rcp_f32_e64 v75, v75
v_add_f32_dpp v249, v251, v251 row_shr:4 row_mask:0xf bank_mask:0xa
v_permlane16_swap_b32 v240, v248
v_rcp_f32 v76, v76
v_permlane16_swap_b32 v241, v249
v_add_f32 v240, v240, v248
v_rcp_f32 v77, v77
v_add_f32 v241, v241, v249
v_add_f32_dpp v240, v240, v240 quad_perm:[1,0,3,2] row_mask:0xf bank_mask:0xf
v_rcp_f32_e64 v78, v78
v_add_f32_dpp v241, v241, v241 quad_perm:[1,0,3,2] row_mask:0xf bank_mask:0xf
v_cndmask_b32_e64 v240, v240, v241, s[72:73]
v_rcp_f32 v79, v79
s_nop 0
v_add_f32_dpp v13, v240, v240 quad_perm:[2,3,0,1] row_mask:0xf bank_mask:0xf
buffer_atomic_add_f32 v13, v7, s[32:35], s66 offen offset:384 sc1
v_pk_mul_f32 v[64:65], v[32:33], v[64:65]
v_pk_mul_f32 v[66:67], v[34:35], v[66:67]
v_pk_mul_f32 v[68:69], v[36:37], v[68:69]
v_pk_mul_f32 v[70:71], v[38:39], v[70:71]
v_pk_mul_f32 v[72:73], v[40:41], v[72:73]
v_pk_mul_f32 v[74:75], v[42:43], v[74:75]
v_pk_mul_f32 v[76:77], v[44:45], v[76:77]
v_pk_mul_f32 v[78:79], v[46:47], v[78:79]
v_pk_mul_f32 v[16:17], v[64:65], v[64:65]
v_pk_mul_f32 v[18:19], v[66:67], v[66:67]
v_pk_mul_f32 v[20:21], v[68:69], v[68:69]
v_pk_mul_f32 v[22:23], v[70:71], v[70:71]
v_pk_mul_f32 v[24:25], v[72:73], v[72:73]
v_pk_mul_f32 v[26:27], v[74:75], v[74:75]
v_pk_mul_f32 v[28:29], v[76:77], v[76:77]
v_pk_mul_f32 v[30:31], v[78:79], v[78:79]
v_pk_fma_f32 v[80:81], v[48:49], v[48:49], s[68:69]
v_pk_fma_f32 v[82:83], v[50:51], v[50:51], s[68:69]
v_pk_fma_f32 v[84:85], v[52:53], v[52:53], s[68:69]
v_pk_fma_f32 v[86:87], v[54:55], v[54:55], s[68:69]
v_pk_fma_f32 v[88:89], v[56:57], v[56:57], s[68:69]
v_pk_fma_f32 v[90:91], v[58:59], v[58:59], s[68:69]
v_pk_fma_f32 v[92:93], v[60:61], v[60:61], s[68:69]
v_pk_fma_f32 v[94:95], v[62:63], v[62:63], s[68:69]
v_pk_mul_f32 v[80:81], v[48:49], v[80:81] neg_lo:[1,0] neg_hi:[1,0]
v_pk_mul_f32 v[82:83], v[50:51], v[82:83] neg_lo:[1,0] neg_hi:[1,0]
v_pk_mul_f32 v[84:85], v[52:53], v[84:85] neg_lo:[1,0] neg_hi:[1,0]
v_pk_mul_f32 v[86:87], v[54:55], v[86:87] neg_lo:[1,0] neg_hi:[1,0]
v_pk_mul_f32 v[88:89], v[56:57], v[88:89] neg_lo:[1,0] neg_hi:[1,0]
v_pk_mul_f32 v[90:91], v[58:59], v[90:91] neg_lo:[1,0] neg_hi:[1,0]
v_pk_mul_f32 v[92:93], v[60:61], v[92:93] neg_lo:[1,0] neg_hi:[1,0]
v_pk_mul_f32 v[94:95], v[62:63], v[94:95] neg_lo:[1,0] neg_hi:[1,0]
v_mfma_f32_32x32x16_bf16 v[32:47], a[144:147], a[96:99], 0
v_exp_f32_e64 v80, v80
v_cvt_pk_bf16_f32 v64, v64, v65
v_exp_f32_e64 v81, v81
v_cvt_pk_bf16_f32 v65, v66, v67
v_mfma_f32_32x32x16_bf16 v[32:47], a[148:151], a[100:103], v[32:47]
v_exp_f32_e64 v82, v82
v_cvt_pk_bf16_f32 v66, v68, v69
v_exp_f32_e64 v83, v83
v_cvt_pk_bf16_f32 v67, v70, v71
v_mfma_f32_32x32x16_bf16 v[32:47], a[152:155], a[104:107], v[32:47]
v_exp_f32_e64 v84, v84
v_accvgpr_write_b32 a48, v64
v_exp_f32_e64 v85, v85
v_accvgpr_write_b32 a49, v65
v_mfma_f32_32x32x16_bf16 v[32:47], a[156:159], a[108:111], v[32:47]
v_exp_f32 v86, v86
v_exp_f32 v87, v87
v_exp_f32_e64 v88, v88
v_mfma_f32_32x32x16_bf16 v[32:47], a[160:163], a[112:115], v[32:47]
v_exp_f32_e64 v89, v89
v_accvgpr_write_b32 a50, v66
v_exp_f32 v90, v90
s_waitcnt lgkmcnt(0)
v_mfma_f32_32x32x16_bf16 v[32:47], a[164:167], a[116:119], v[32:47]
v_exp_f32_e64 v91, v91
v_accvgpr_write_b32 a51, v67
v_exp_f32 v92, v92
v_exp_f32 v93, v93
v_exp_f32 v94, v94
v_exp_f32 v95, v95
v_pk_add_f32 v[80:81], v[80:81], s[70:71]
v_pk_add_f32 v[82:83], v[82:83], s[70:71]
v_pk_add_f32 v[84:85], v[84:85], s[70:71]
v_pk_add_f32 v[86:87], v[86:87], s[70:71]
v_pk_add_f32 v[88:89], v[88:89], s[70:71]
v_pk_add_f32 v[90:91], v[90:91], s[70:71]
v_pk_add_f32 v[92:93], v[92:93], s[70:71]
v_pk_add_f32 v[94:95], v[94:95], s[70:71]
v_mfma_f32_32x32x16_bf16 v[32:47], a[168:171], a[120:123], v[32:47]
v_rcp_f32_e64 v80, v80
v_cvt_pk_bf16_f32 v68, v72, v73
v_rcp_f32_e64 v81, v81
v_cvt_pk_bf16_f32 v69, v74, v75
v_mfma_f32_32x32x16_bf16 v[32:47], a[172:175], a[124:127], v[32:47]
v_rcp_f32_e64 v82, v82
v_cvt_pk_bf16_f32 v70, v76, v77
v_rcp_f32_e64 v83, v83
v_cvt_pk_bf16_f32 v71, v78, v79
v_mfma_f32_32x32x16_bf16 v[32:47], a[176:179], a[128:131], v[32:47]
v_rcp_f32_e64 v84, v84
v_accvgpr_write_b32 a52, v68
v_rcp_f32_e64 v85, v85
v_accvgpr_write_b32 a53, v69
v_mfma_f32_32x32x16_bf16 v[32:47], a[180:183], a[132:135], v[32:47]
v_rcp_f32 v86, v86
v_rcp_f32 v87, v87
v_rcp_f32_e64 v88, v88
v_mfma_f32_32x32x16_bf16 v[32:47], a[184:187], a[136:139], v[32:47]
v_rcp_f32_e64 v89, v89
v_accvgpr_write_b32 a54, v70
v_rcp_f32_e64 v90, v90
v_mfma_f32_32x32x16_bf16 v[32:47], a[188:191], a[140:143], v[32:47]
v_rcp_f32_e64 v91, v91
v_accvgpr_write_b32 a55, v71
v_rcp_f32 v92, v92
v_rcp_f32 v93, v93
v_rcp_f32 v94, v94
v_rcp_f32 v95, v95
v_pk_mul_f32 v[80:81], v[48:49], v[80:81]
v_pk_mul_f32 v[82:83], v[50:51], v[82:83]
v_pk_mul_f32 v[84:85], v[52:53], v[84:85]
v_pk_mul_f32 v[86:87], v[54:55], v[86:87]
v_pk_mul_f32 v[88:89], v[56:57], v[88:89]
v_pk_mul_f32 v[90:91], v[58:59], v[90:91]
v_pk_mul_f32 v[92:93], v[60:61], v[92:93]
v_pk_mul_f32 v[94:95], v[62:63], v[94:95]
v_pk_mul_f32 v[240:241], v[80:81], v[80:81]
v_pk_mul_f32 v[242:243], v[82:83], v[82:83]
v_pk_mul_f32 v[244:245], v[84:85], v[84:85]
v_pk_mul_f32 v[246:247], v[86:87], v[86:87]
v_pk_mul_f32 v[248:249], v[88:89], v[88:89]
v_pk_mul_f32 v[250:251], v[90:91], v[90:91]
v_pk_mul_f32 v[252:253], v[92:93], v[92:93]
v_pk_mul_f32 v[254:255], v[94:95], v[94:95]
v_pk_fma_f32 v[64:65], v[32:33], v[32:33], s[68:69]
v_pk_fma_f32 v[66:67], v[34:35], v[34:35], s[68:69]
v_pk_fma_f32 v[68:69], v[36:37], v[36:37], s[68:69]
v_pk_fma_f32 v[70:71], v[38:39], v[38:39], s[68:69]
v_pk_fma_f32 v[72:73], v[40:41], v[40:41], s[68:69]
v_pk_fma_f32 v[74:75], v[42:43], v[42:43], s[68:69]
v_pk_fma_f32 v[76:77], v[44:45], v[44:45], s[68:69]
v_pk_fma_f32 v[78:79], v[46:47], v[46:47], s[68:69]
v_pk_mul_f32 v[64:65], v[32:33], v[64:65] neg_lo:[1,0] neg_hi:[1,0]
v_pk_mul_f32 v[66:67], v[34:35], v[66:67] neg_lo:[1,0] neg_hi:[1,0]
v_pk_mul_f32 v[68:69], v[36:37], v[68:69] neg_lo:[1,0] neg_hi:[1,0]
v_pk_mul_f32 v[70:71], v[38:39], v[70:71] neg_lo:[1,0] neg_hi:[1,0]
v_pk_mul_f32 v[72:73], v[40:41], v[72:73] neg_lo:[1,0] neg_hi:[1,0]
v_pk_mul_f32 v[74:75], v[42:43], v[74:75] neg_lo:[1,0] neg_hi:[1,0]
v_pk_mul_f32 v[76:77], v[44:45], v[76:77] neg_lo:[1,0] neg_hi:[1,0]
v_pk_mul_f32 v[78:79], v[46:47], v[78:79] neg_lo:[1,0] neg_hi:[1,0]
v_mfma_f32_32x32x16_bf16 v[48:63], a[0:3], a[96:99], 0
ds_read_b128 a[96:99], v4 offset:24576
v_exp_f32_e64 v64, v64
v_cvt_pk_bf16_f32 v208, v80, v81
v_exp_f32_e64 v65, v65
v_mfma_f32_32x32x16_bf16 v[48:63], a[4:7], a[100:103], v[48:63]
ds_read_b128 a[100:103], v4 offset:25600
v_exp_f32_e64 v66, v66
v_cvt_pk_bf16_f32 v209, v82, v83
v_exp_f32_e64 v67, v67
v_mfma_f32_32x32x16_bf16 v[48:63], a[8:11], a[104:107], v[48:63]
ds_read_b128 a[104:107], v4 offset:26624
v_exp_f32_e64 v68, v68
v_cvt_pk_bf16_f32 v210, v84, v85
v_exp_f32_e64 v69, v69
v_mfma_f32_32x32x16_bf16 v[48:63], a[12:15], a[108:111], v[48:63]
ds_read_b128 a[108:111], v4 offset:27648
v_exp_f32_e64 v70, v70
v_cvt_pk_bf16_f32 v211, v86, v87
v_exp_f32_e64 v71, v71
v_mfma_f32_32x32x16_bf16 v[48:63], a[16:19], a[112:115], v[48:63]
ds_read_b128 a[112:115], v4 offset:28672
v_exp_f32 v72, v72
v_exp_f32 v73, v73
v_mfma_f32_32x32x16_bf16 v[48:63], a[20:23], a[116:119], v[48:63]
ds_read_b128 a[116:119], v4 offset:29696
v_exp_f32 v74, v74
v_exp_f32 v75, v75
v_exp_f32 v76, v76
v_exp_f32 v77, v77
v_exp_f32 v78, v78
v_exp_f32 v79, v79
v_pk_add_f32 v[64:65], v[64:65], s[70:71]
v_pk_add_f32 v[66:67], v[66:67], s[70:71]
v_pk_add_f32 v[68:69], v[68:69], s[70:71]
v_pk_add_f32 v[70:71], v[70:71], s[70:71]
v_pk_add_f32 v[72:73], v[72:73], s[70:71]
v_pk_add_f32 v[74:75], v[74:75], s[70:71]
v_pk_add_f32 v[76:77], v[76:77], s[70:71]
v_pk_add_f32 v[78:79], v[78:79], s[70:71]
v_mfma_f32_32x32x16_bf16 v[48:63], a[24:27], a[120:123], v[48:63]
ds_read_b128 a[120:123], v4 offset:30720
v_rcp_f32_e64 v64, v64
v_cvt_pk_bf16_f32 v212, v88, v89
v_rcp_f32_e64 v65, v65
v_mfma_f32_32x32x16_bf16 v[48:63], a[28:31], a[124:127], v[48:63]
ds_read_b128 a[124:127], v4 offset:31744
v_rcp_f32_e64 v66, v66
v_cvt_pk_bf16_f32 v213, v90, v91
v_rcp_f32_e64 v67, v67
v_mfma_f32_32x32x16_bf16 v[48:63], a[32:35], a[128:131], v[48:63]
ds_read_b128 a[128:131], v4 offset:32768
v_rcp_f32_e64 v68, v68
v_cvt_pk_bf16_f32 v214, v92, v93
v_rcp_f32_e64 v69, v69
v_mfma_f32_32x32x16_bf16 v[48:63], a[36:39], a[132:135], v[48:63]
ds_read_b128 a[132:135], v4 offset:33792
v_rcp_f32_e64 v70, v70
v_cvt_pk_bf16_f32 v215, v94, v95
v_rcp_f32_e64 v71, v71
v_mfma_f32_32x32x16_bf16 v[48:63], a[40:43], a[136:139], v[48:63]
ds_read_b128 a[136:139], v4 offset:34816
v_rcp_f32 v72, v72
v_rcp_f32_e64 v73, v73
s_waitcnt lgkmcnt(5)
v_mfma_f32_32x32x16_bf16 v[48:63], a[44:47], a[140:143], v[48:63]
ds_read_b128 a[140:143], v4 offset:35840
v_rcp_f32 v74, v74
v_rcp_f32 v75, v75
v_rcp_f32 v76, v76
v_rcp_f32 v77, v77
v_rcp_f32 v78, v78
v_rcp_f32 v79, v79
v_pk_mul_f32 v[64:65], v[32:33], v[64:65]
v_pk_mul_f32 v[66:67], v[34:35], v[66:67]
v_pk_mul_f32 v[68:69], v[36:37], v[68:69]
v_pk_mul_f32 v[70:71], v[38:39], v[70:71]
v_pk_mul_f32 v[72:73], v[40:41], v[72:73]
v_pk_mul_f32 v[74:75], v[42:43], v[74:75]
v_pk_mul_f32 v[76:77], v[44:45], v[76:77]
v_pk_mul_f32 v[78:79], v[46:47], v[78:79]
v_pk_fma_f32 v[16:17], v[64:65], v[64:65], v[16:17]
v_pk_fma_f32 v[18:19], v[66:67], v[66:67], v[18:19]
v_pk_fma_f32 v[20:21], v[68:69], v[68:69], v[20:21]
v_pk_fma_f32 v[22:23], v[70:71], v[70:71], v[22:23]
v_pk_fma_f32 v[24:25], v[72:73], v[72:73], v[24:25]
v_pk_fma_f32 v[26:27], v[74:75], v[74:75], v[26:27]
v_pk_fma_f32 v[28:29], v[76:77], v[76:77], v[28:29]
v_pk_fma_f32 v[30:31], v[78:79], v[78:79], v[30:31]
v_pk_fma_f32 v[80:81], v[48:49], v[48:49], s[68:69]
v_pk_fma_f32 v[82:83], v[50:51], v[50:51], s[68:69]
v_pk_fma_f32 v[84:85], v[52:53], v[52:53], s[68:69]
v_pk_fma_f32 v[86:87], v[54:55], v[54:55], s[68:69]
v_pk_fma_f32 v[88:89], v[56:57], v[56:57], s[68:69]
v_pk_fma_f32 v[90:91], v[58:59], v[58:59], s[68:69]
v_pk_fma_f32 v[92:93], v[60:61], v[60:61], s[68:69]
v_pk_fma_f32 v[94:95], v[62:63], v[62:63], s[68:69]
v_pk_mul_f32 v[80:81], v[48:49], v[80:81] neg_lo:[1,0] neg_hi:[1,0]
v_pk_mul_f32 v[82:83], v[50:51], v[82:83] neg_lo:[1,0] neg_hi:[1,0]
v_pk_mul_f32 v[84:85], v[52:53], v[84:85] neg_lo:[1,0] neg_hi:[1,0]
v_pk_mul_f32 v[86:87], v[54:55], v[86:87] neg_lo:[1,0] neg_hi:[1,0]
v_pk_mul_f32 v[88:89], v[56:57], v[88:89] neg_lo:[1,0] neg_hi:[1,0]
v_pk_mul_f32 v[90:91], v[58:59], v[90:91] neg_lo:[1,0] neg_hi:[1,0]
v_pk_mul_f32 v[92:93], v[60:61], v[92:93] neg_lo:[1,0] neg_hi:[1,0]
v_pk_mul_f32 v[94:95], v[62:63], v[94:95] neg_lo:[1,0] neg_hi:[1,0]
v_mfma_f32_32x32x16_bf16 v[32:47], a[144:147], a[96:99], 0
v_exp_f32_e64 v80, v80
v_cvt_pk_bf16_f32 v64, v64, v65
v_exp_f32_e64 v81, v81
v_cvt_pk_bf16_f32 v65, v66, v67
v_mfma_f32_32x32x16_bf16 v[32:47], a[148:151], a[100:103], v[32:47]
v_exp_f32_e64 v82, v82
v_cvt_pk_bf16_f32 v66, v68, v69
v_exp_f32_e64 v83, v83
v_cvt_pk_bf16_f32 v67, v70, v71
v_mfma_f32_32x32x16_bf16 v[32:47], a[152:155], a[104:107], v[32:47]
v_exp_f32_e64 v84, v84
v_accvgpr_write_b32 a56, v64
v_exp_f32_e64 v85, v85
v_accvgpr_write_b32 a57, v65
v_mfma_f32_32x32x16_bf16 v[32:47], a[156:159], a[108:111], v[32:47]
v_exp_f32 v86, v86
v_exp_f32 v87, v87
v_exp_f32_e64 v88, v88
v_mfma_f32_32x32x16_bf16 v[32:47], a[160:163], a[112:115], v[32:47]
v_exp_f32_e64 v89, v89
v_accvgpr_write_b32 a58, v66
v_exp_f32 v90, v90
s_waitcnt lgkmcnt(0)
v_mfma_f32_32x32x16_bf16 v[32:47], a[164:167], a[116:119], v[32:47]
v_exp_f32_e64 v91, v91
v_accvgpr_write_b32 a59, v67
v_exp_f32 v92, v92
v_exp_f32 v93, v93
v_exp_f32 v94, v94
v_exp_f32 v95, v95
v_pk_add_f32 v[80:81], v[80:81], s[70:71]
v_pk_add_f32 v[82:83], v[82:83], s[70:71]
v_pk_add_f32 v[84:85], v[84:85], s[70:71]
v_pk_add_f32 v[86:87], v[86:87], s[70:71]
v_pk_add_f32 v[88:89], v[88:89], s[70:71]
v_pk_add_f32 v[90:91], v[90:91], s[70:71]
v_pk_add_f32 v[92:93], v[92:93], s[70:71]
v_pk_add_f32 v[94:95], v[94:95], s[70:71]
v_mfma_f32_32x32x16_bf16 v[32:47], a[168:171], a[120:123], v[32:47]
v_rcp_f32_e64 v80, v80
v_cvt_pk_bf16_f32 v68, v72, v73
v_rcp_f32_e64 v81, v81
v_cvt_pk_bf16_f32 v69, v74, v75
v_mfma_f32_32x32x16_bf16 v[32:47], a[172:175], a[124:127], v[32:47]
v_rcp_f32_e64 v82, v82
v_cvt_pk_bf16_f32 v70, v76, v77
v_rcp_f32_e64 v83, v83
v_cvt_pk_bf16_f32 v71, v78, v79
v_mfma_f32_32x32x16_bf16 v[32:47], a[176:179], a[128:131], v[32:47]
v_rcp_f32_e64 v84, v84
v_accvgpr_write_b32 a60, v68
v_rcp_f32_e64 v85, v85
v_accvgpr_write_b32 a61, v69
v_mfma_f32_32x32x16_bf16 v[32:47], a[180:183], a[132:135], v[32:47]
v_rcp_f32 v86, v86
v_rcp_f32 v87, v87
v_rcp_f32_e64 v88, v88
v_mfma_f32_32x32x16_bf16 v[32:47], a[184:187], a[136:139], v[32:47]
v_rcp_f32_e64 v89, v89
v_accvgpr_write_b32 a62, v70
v_rcp_f32_e64 v90, v90
v_mfma_f32_32x32x16_bf16 v[32:47], a[188:191], a[140:143], v[32:47]
v_rcp_f32_e64 v91, v91
v_accvgpr_write_b32 a63, v71
v_rcp_f32 v92, v92
v_rcp_f32 v93, v93
v_rcp_f32 v94, v94
v_rcp_f32 v95, v95
v_pk_mul_f32 v[80:81], v[48:49], v[80:81]
v_pk_mul_f32 v[82:83], v[50:51], v[82:83]
v_pk_mul_f32 v[84:85], v[52:53], v[84:85]
v_pk_mul_f32 v[86:87], v[54:55], v[86:87]
v_pk_mul_f32 v[88:89], v[56:57], v[88:89]
v_pk_mul_f32 v[90:91], v[58:59], v[90:91]
v_pk_mul_f32 v[92:93], v[60:61], v[92:93]
v_pk_mul_f32 v[94:95], v[62:63], v[94:95]
v_pk_fma_f32 v[240:241], v[80:81], v[80:81], v[240:241]
v_pk_fma_f32 v[242:243], v[82:83], v[82:83], v[242:243]
v_pk_fma_f32 v[244:245], v[84:85], v[84:85], v[244:245]
v_pk_fma_f32 v[246:247], v[86:87], v[86:87], v[246:247]
v_pk_fma_f32 v[248:249], v[88:89], v[88:89], v[248:249]
v_pk_fma_f32 v[250:251], v[90:91], v[90:91], v[250:251]
v_pk_fma_f32 v[252:253], v[92:93], v[92:93], v[252:253]
v_pk_fma_f32 v[254:255], v[94:95], v[94:95], v[254:255]
v_pk_fma_f32 v[64:65], v[32:33], v[32:33], s[68:69]
v_pk_fma_f32 v[66:67], v[34:35], v[34:35], s[68:69]
v_pk_fma_f32 v[68:69], v[36:37], v[36:37], s[68:69]
v_pk_fma_f32 v[70:71], v[38:39], v[38:39], s[68:69]
v_pk_fma_f32 v[72:73], v[40:41], v[40:41], s[68:69]
v_pk_fma_f32 v[74:75], v[42:43], v[42:43], s[68:69]
v_pk_fma_f32 v[76:77], v[44:45], v[44:45], s[68:69]
v_pk_fma_f32 v[78:79], v[46:47], v[46:47], s[68:69]
v_pk_mul_f32 v[64:65], v[32:33], v[64:65] neg_lo:[1,0] neg_hi:[1,0]
v_pk_mul_f32 v[66:67], v[34:35], v[66:67] neg_lo:[1,0] neg_hi:[1,0]
v_pk_mul_f32 v[68:69], v[36:37], v[68:69] neg_lo:[1,0] neg_hi:[1,0]
v_pk_mul_f32 v[70:71], v[38:39], v[70:71] neg_lo:[1,0] neg_hi:[1,0]
v_pk_mul_f32 v[72:73], v[40:41], v[72:73] neg_lo:[1,0] neg_hi:[1,0]
v_pk_mul_f32 v[74:75], v[42:43], v[74:75] neg_lo:[1,0] neg_hi:[1,0]
v_pk_mul_f32 v[76:77], v[44:45], v[76:77] neg_lo:[1,0] neg_hi:[1,0]
v_pk_mul_f32 v[78:79], v[46:47], v[78:79] neg_lo:[1,0] neg_hi:[1,0]
v_mfma_f32_32x32x16_bf16 v[48:63], a[0:3], a[96:99], 0
ds_read_b128 a[96:99], v4 offset:36864
v_exp_f32_e64 v64, v64
v_cvt_pk_bf16_f32 v216, v80, v81
v_exp_f32_e64 v65, v65
v_mfma_f32_32x32x16_bf16 v[48:63], a[4:7], a[100:103], v[48:63]
ds_read_b128 a[100:103], v4 offset:37888
v_exp_f32_e64 v66, v66
v_cvt_pk_bf16_f32 v217, v82, v83
v_exp_f32_e64 v67, v67
v_mfma_f32_32x32x16_bf16 v[48:63], a[8:11], a[104:107], v[48:63]
ds_read_b128 a[104:107], v4 offset:38912
v_exp_f32_e64 v68, v68
v_cvt_pk_bf16_f32 v218, v84, v85
v_exp_f32_e64 v69, v69
v_mfma_f32_32x32x16_bf16 v[48:63], a[12:15], a[108:111], v[48:63]
ds_read_b128 a[108:111], v4 offset:39936
v_exp_f32_e64 v70, v70
v_cvt_pk_bf16_f32 v219, v86, v87
v_exp_f32_e64 v71, v71
v_mfma_f32_32x32x16_bf16 v[48:63], a[16:19], a[112:115], v[48:63]
ds_read_b128 a[112:115], v4 offset:40960
v_exp_f32 v72, v72
v_exp_f32 v73, v73
v_mfma_f32_32x32x16_bf16 v[48:63], a[20:23], a[116:119], v[48:63]
ds_read_b128 a[116:119], v4 offset:41984
v_exp_f32 v74, v74
v_exp_f32 v75, v75
v_exp_f32 v76, v76
v_exp_f32 v77, v77
v_exp_f32 v78, v78
v_exp_f32 v79, v79
v_pk_add_f32 v[64:65], v[64:65], s[70:71]
v_pk_add_f32 v[66:67], v[66:67], s[70:71]
v_pk_add_f32 v[68:69], v[68:69], s[70:71]
v_pk_add_f32 v[70:71], v[70:71], s[70:71]
v_pk_add_f32 v[72:73], v[72:73], s[70:71]
v_pk_add_f32 v[74:75], v[74:75], s[70:71]
v_pk_add_f32 v[76:77], v[76:77], s[70:71]
v_pk_add_f32 v[78:79], v[78:79], s[70:71]
v_mfma_f32_32x32x16_bf16 v[48:63], a[24:27], a[120:123], v[48:63]
ds_read_b128 a[120:123], v4 offset:43008
v_rcp_f32_e64 v64, v64
v_cvt_pk_bf16_f32 v220, v88, v89
v_rcp_f32_e64 v65, v65
v_mfma_f32_32x32x16_bf16 v[48:63], a[28:31], a[124:127], v[48:63]
ds_read_b128 a[124:127], v4 offset:44032
v_rcp_f32_e64 v66, v66
v_cvt_pk_bf16_f32 v221, v90, v91
v_rcp_f32_e64 v67, v67
v_mfma_f32_32x32x16_bf16 v[48:63], a[32:35], a[128:131], v[48:63]
ds_read_b128 a[128:131], v4 offset:45056
v_rcp_f32_e64 v68, v68
v_cvt_pk_bf16_f32 v222, v92, v93
v_rcp_f32_e64 v69, v69
v_mfma_f32_32x32x16_bf16 v[48:63], a[36:39], a[132:135], v[48:63]
ds_read_b128 a[132:135], v4 offset:46080
v_rcp_f32_e64 v70, v70
v_cvt_pk_bf16_f32 v223, v94, v95
v_rcp_f32_e64 v71, v71
v_mfma_f32_32x32x16_bf16 v[48:63], a[40:43], a[136:139], v[48:63]
ds_read_b128 a[136:139], v4 offset:47104
v_rcp_f32 v72, v72
v_rcp_f32_e64 v73, v73
s_waitcnt lgkmcnt(5)
v_mfma_f32_32x32x16_bf16 v[48:63], a[44:47], a[140:143], v[48:63]
ds_read_b128 a[140:143], v4 offset:48128
v_rcp_f32 v74, v74
v_rcp_f32 v75, v75
v_rcp_f32 v76, v76
v_rcp_f32 v77, v77
v_rcp_f32 v78, v78
v_rcp_f32 v79, v79
v_pk_mul_f32 v[64:65], v[32:33], v[64:65]
v_pk_mul_f32 v[66:67], v[34:35], v[66:67]
v_pk_mul_f32 v[68:69], v[36:37], v[68:69]
v_pk_mul_f32 v[70:71], v[38:39], v[70:71]
v_pk_mul_f32 v[72:73], v[40:41], v[72:73]
v_pk_mul_f32 v[74:75], v[42:43], v[74:75]
v_pk_mul_f32 v[76:77], v[44:45], v[76:77]
v_pk_mul_f32 v[78:79], v[46:47], v[78:79]
v_pk_fma_f32 v[16:17], v[64:65], v[64:65], v[16:17]
v_pk_fma_f32 v[18:19], v[66:67], v[66:67], v[18:19]
v_pk_fma_f32 v[20:21], v[68:69], v[68:69], v[20:21]
v_pk_fma_f32 v[22:23], v[70:71], v[70:71], v[22:23]
v_pk_fma_f32 v[24:25], v[72:73], v[72:73], v[24:25]
v_pk_fma_f32 v[26:27], v[74:75], v[74:75], v[26:27]
v_pk_fma_f32 v[28:29], v[76:77], v[76:77], v[28:29]
v_pk_fma_f32 v[30:31], v[78:79], v[78:79], v[30:31]
v_pk_fma_f32 v[80:81], v[48:49], v[48:49], s[68:69]
v_pk_fma_f32 v[82:83], v[50:51], v[50:51], s[68:69]
v_pk_fma_f32 v[84:85], v[52:53], v[52:53], s[68:69]
v_pk_fma_f32 v[86:87], v[54:55], v[54:55], s[68:69]
v_pk_fma_f32 v[88:89], v[56:57], v[56:57], s[68:69]
v_pk_fma_f32 v[90:91], v[58:59], v[58:59], s[68:69]
v_pk_fma_f32 v[92:93], v[60:61], v[60:61], s[68:69]
v_pk_fma_f32 v[94:95], v[62:63], v[62:63], s[68:69]
v_pk_mul_f32 v[80:81], v[48:49], v[80:81] neg_lo:[1,0] neg_hi:[1,0]
v_pk_mul_f32 v[82:83], v[50:51], v[82:83] neg_lo:[1,0] neg_hi:[1,0]
v_pk_mul_f32 v[84:85], v[52:53], v[84:85] neg_lo:[1,0] neg_hi:[1,0]
v_pk_mul_f32 v[86:87], v[54:55], v[86:87] neg_lo:[1,0] neg_hi:[1,0]
v_pk_mul_f32 v[88:89], v[56:57], v[88:89] neg_lo:[1,0] neg_hi:[1,0]
v_pk_mul_f32 v[90:91], v[58:59], v[90:91] neg_lo:[1,0] neg_hi:[1,0]
v_pk_mul_f32 v[92:93], v[60:61], v[92:93] neg_lo:[1,0] neg_hi:[1,0]
v_pk_mul_f32 v[94:95], v[62:63], v[94:95] neg_lo:[1,0] neg_hi:[1,0]
v_mfma_f32_32x32x16_bf16 v[32:47], a[144:147], a[96:99], 0
v_exp_f32_e64 v80, v80
v_cvt_pk_bf16_f32 v64, v64, v65
v_exp_f32_e64 v81, v81
v_cvt_pk_bf16_f32 v65, v66, v67
v_mfma_f32_32x32x16_bf16 v[32:47], a[148:151], a[100:103], v[32:47]
v_exp_f32_e64 v82, v82
v_cvt_pk_bf16_f32 v66, v68, v69
v_exp_f32_e64 v83, v83
v_cvt_pk_bf16_f32 v67, v70, v71
v_mfma_f32_32x32x16_bf16 v[32:47], a[152:155], a[104:107], v[32:47]
v_exp_f32_e64 v84, v84
v_accvgpr_write_b32 a64, v64
v_exp_f32_e64 v85, v85
v_accvgpr_write_b32 a65, v65
v_mfma_f32_32x32x16_bf16 v[32:47], a[156:159], a[108:111], v[32:47]
v_exp_f32 v86, v86
v_exp_f32 v87, v87
v_exp_f32_e64 v88, v88
v_mfma_f32_32x32x16_bf16 v[32:47], a[160:163], a[112:115], v[32:47]
v_exp_f32_e64 v89, v89
v_accvgpr_write_b32 a66, v66
v_exp_f32 v90, v90
s_waitcnt lgkmcnt(0)
v_mfma_f32_32x32x16_bf16 v[32:47], a[164:167], a[116:119], v[32:47]
v_exp_f32_e64 v91, v91
v_accvgpr_write_b32 a67, v67
v_exp_f32 v92, v92
v_exp_f32 v93, v93
v_exp_f32 v94, v94
v_exp_f32 v95, v95
v_pk_add_f32 v[80:81], v[80:81], s[70:71]
v_pk_add_f32 v[82:83], v[82:83], s[70:71]
v_pk_add_f32 v[84:85], v[84:85], s[70:71]
v_pk_add_f32 v[86:87], v[86:87], s[70:71]
v_pk_add_f32 v[88:89], v[88:89], s[70:71]
v_pk_add_f32 v[90:91], v[90:91], s[70:71]
v_pk_add_f32 v[92:93], v[92:93], s[70:71]
v_pk_add_f32 v[94:95], v[94:95], s[70:71]
v_mfma_f32_32x32x16_bf16 v[32:47], a[168:171], a[120:123], v[32:47]
v_rcp_f32_e64 v80, v80
v_cvt_pk_bf16_f32 v68, v72, v73
v_rcp_f32_e64 v81, v81
v_cvt_pk_bf16_f32 v69, v74, v75
v_mfma_f32_32x32x16_bf16 v[32:47], a[172:175], a[124:127], v[32:47]
v_rcp_f32_e64 v82, v82
v_cvt_pk_bf16_f32 v70, v76, v77
v_rcp_f32_e64 v83, v83
v_cvt_pk_bf16_f32 v71, v78, v79
v_mfma_f32_32x32x16_bf16 v[32:47], a[176:179], a[128:131], v[32:47]
v_rcp_f32_e64 v84, v84
v_accvgpr_write_b32 a68, v68
v_rcp_f32_e64 v85, v85
v_accvgpr_write_b32 a69, v69
v_mfma_f32_32x32x16_bf16 v[32:47], a[180:183], a[132:135], v[32:47]
v_rcp_f32 v86, v86
v_rcp_f32 v87, v87
v_rcp_f32_e64 v88, v88
v_mfma_f32_32x32x16_bf16 v[32:47], a[184:187], a[136:139], v[32:47]
v_rcp_f32_e64 v89, v89
v_accvgpr_write_b32 a70, v70
v_rcp_f32_e64 v90, v90
v_mfma_f32_32x32x16_bf16 v[32:47], a[188:191], a[140:143], v[32:47]
v_rcp_f32_e64 v91, v91
v_accvgpr_write_b32 a71, v71
v_rcp_f32 v92, v92
v_rcp_f32 v93, v93
v_rcp_f32 v94, v94
v_rcp_f32 v95, v95
v_pk_mul_f32 v[80:81], v[48:49], v[80:81]
v_pk_mul_f32 v[82:83], v[50:51], v[82:83]
v_pk_mul_f32 v[84:85], v[52:53], v[84:85]
v_pk_mul_f32 v[86:87], v[54:55], v[86:87]
v_pk_mul_f32 v[88:89], v[56:57], v[88:89]
v_pk_mul_f32 v[90:91], v[58:59], v[90:91]
v_pk_mul_f32 v[92:93], v[60:61], v[92:93]
v_pk_mul_f32 v[94:95], v[62:63], v[94:95]
v_pk_fma_f32 v[240:241], v[80:81], v[80:81], v[240:241]
v_pk_fma_f32 v[242:243], v[82:83], v[82:83], v[242:243]
v_pk_fma_f32 v[244:245], v[84:85], v[84:85], v[244:245]
v_pk_fma_f32 v[246:247], v[86:87], v[86:87], v[246:247]
v_pk_fma_f32 v[248:249], v[88:89], v[88:89], v[248:249]
v_pk_fma_f32 v[250:251], v[90:91], v[90:91], v[250:251]
v_pk_fma_f32 v[252:253], v[92:93], v[92:93], v[252:253]
v_pk_fma_f32 v[254:255], v[94:95], v[94:95], v[254:255]
v_pk_fma_f32 v[64:65], v[32:33], v[32:33], s[68:69]
v_pk_fma_f32 v[66:67], v[34:35], v[34:35], s[68:69]
v_pk_fma_f32 v[68:69], v[36:37], v[36:37], s[68:69]
v_pk_fma_f32 v[70:71], v[38:39], v[38:39], s[68:69]
v_pk_fma_f32 v[72:73], v[40:41], v[40:41], s[68:69]
v_pk_fma_f32 v[74:75], v[42:43], v[42:43], s[68:69]
v_pk_fma_f32 v[76:77], v[44:45], v[44:45], s[68:69]
v_pk_fma_f32 v[78:79], v[46:47], v[46:47], s[68:69]
v_pk_mul_f32 v[64:65], v[32:33], v[64:65] neg_lo:[1,0] neg_hi:[1,0]
v_pk_mul_f32 v[66:67], v[34:35], v[66:67] neg_lo:[1,0] neg_hi:[1,0]
v_pk_mul_f32 v[68:69], v[36:37], v[68:69] neg_lo:[1,0] neg_hi:[1,0]
v_pk_mul_f32 v[70:71], v[38:39], v[70:71] neg_lo:[1,0] neg_hi:[1,0]
v_pk_mul_f32 v[72:73], v[40:41], v[72:73] neg_lo:[1,0] neg_hi:[1,0]
v_pk_mul_f32 v[74:75], v[42:43], v[74:75] neg_lo:[1,0] neg_hi:[1,0]
v_pk_mul_f32 v[76:77], v[44:45], v[76:77] neg_lo:[1,0] neg_hi:[1,0]
v_pk_mul_f32 v[78:79], v[46:47], v[78:79] neg_lo:[1,0] neg_hi:[1,0]
v_mfma_f32_32x32x16_bf16 v[48:63], a[0:3], a[96:99], 0
ds_read_b128 a[96:99], v1 offset:0
v_exp_f32_e64 v64, v64
v_cvt_pk_bf16_f32 v224, v80, v81
v_exp_f32_e64 v65, v65
v_mfma_f32_32x32x16_bf16 v[48:63], a[4:7], a[100:103], v[48:63]
ds_read_b128 a[100:103], v1 offset:1024
v_exp_f32_e64 v66, v66
v_cvt_pk_bf16_f32 v225, v82, v83
v_exp_f32_e64 v67, v67
v_mfma_f32_32x32x16_bf16 v[48:63], a[8:11], a[104:107], v[48:63]
ds_read_b128 a[104:107], v1 offset:2048
v_exp_f32_e64 v68, v68
v_cvt_pk_bf16_f32 v226, v84, v85
v_exp_f32_e64 v69, v69
v_mfma_f32_32x32x16_bf16 v[48:63], a[12:15], a[108:111], v[48:63]
ds_read_b128 a[108:111], v1 offset:3072
v_exp_f32_e64 v70, v70
v_cvt_pk_bf16_f32 v227, v86, v87
v_exp_f32_e64 v71, v71
v_mfma_f32_32x32x16_bf16 v[48:63], a[16:19], a[112:115], v[48:63]
ds_read_b128 a[112:115], v1 offset:4096
v_exp_f32 v72, v72
v_exp_f32 v73, v73
v_mfma_f32_32x32x16_bf16 v[48:63], a[20:23], a[116:119], v[48:63]
ds_read_b128 a[116:119], v1 offset:5120
v_exp_f32 v74, v74
v_exp_f32 v75, v75
v_exp_f32 v76, v76
v_exp_f32 v77, v77
v_exp_f32 v78, v78
v_exp_f32 v79, v79
v_pk_add_f32 v[64:65], v[64:65], s[70:71]
v_pk_add_f32 v[66:67], v[66:67], s[70:71]
v_pk_add_f32 v[68:69], v[68:69], s[70:71]
v_pk_add_f32 v[70:71], v[70:71], s[70:71]
v_pk_add_f32 v[72:73], v[72:73], s[70:71]
v_pk_add_f32 v[74:75], v[74:75], s[70:71]
v_pk_add_f32 v[76:77], v[76:77], s[70:71]
v_pk_add_f32 v[78:79], v[78:79], s[70:71]
v_mfma_f32_32x32x16_bf16 v[48:63], a[24:27], a[120:123], v[48:63]
ds_read_b128 a[120:123], v1 offset:6144
v_rcp_f32_e64 v64, v64
v_cvt_pk_bf16_f32 v228, v88, v89
v_rcp_f32_e64 v65, v65
v_mfma_f32_32x32x16_bf16 v[48:63], a[28:31], a[124:127], v[48:63]
ds_read_b128 a[124:127], v1 offset:7168
v_rcp_f32_e64 v66, v66
v_cvt_pk_bf16_f32 v229, v90, v91
v_rcp_f32_e64 v67, v67
v_mfma_f32_32x32x16_bf16 v[48:63], a[32:35], a[128:131], v[48:63]
ds_read_b128 a[128:131], v1 offset:8192
v_rcp_f32_e64 v68, v68
v_cvt_pk_bf16_f32 v230, v92, v93
v_rcp_f32_e64 v69, v69
v_mfma_f32_32x32x16_bf16 v[48:63], a[36:39], a[132:135], v[48:63]
ds_read_b128 a[132:135], v1 offset:9216
v_rcp_f32_e64 v70, v70
v_cvt_pk_bf16_f32 v231, v94, v95
v_rcp_f32_e64 v71, v71
v_mfma_f32_32x32x16_bf16 v[48:63], a[40:43], a[136:139], v[48:63]
ds_read_b128 a[136:139], v1 offset:10240
v_rcp_f32 v72, v72
v_rcp_f32_e64 v73, v73
s_waitcnt lgkmcnt(5)
v_mfma_f32_32x32x16_bf16 v[48:63], a[44:47], a[140:143], v[48:63]
ds_read_b128 a[140:143], v1 offset:11264
v_rcp_f32 v74, v74
v_rcp_f32 v75, v75
v_rcp_f32 v76, v76
v_rcp_f32 v77, v77
v_rcp_f32 v78, v78
v_rcp_f32 v79, v79
v_pk_mul_f32 v[64:65], v[32:33], v[64:65]
v_pk_mul_f32 v[66:67], v[34:35], v[66:67]
v_pk_mul_f32 v[68:69], v[36:37], v[68:69]
v_pk_mul_f32 v[70:71], v[38:39], v[70:71]
v_pk_mul_f32 v[72:73], v[40:41], v[72:73]
v_pk_mul_f32 v[74:75], v[42:43], v[74:75]
v_pk_mul_f32 v[76:77], v[44:45], v[76:77]
v_pk_mul_f32 v[78:79], v[46:47], v[78:79]
v_pk_fma_f32 v[16:17], v[64:65], v[64:65], v[16:17]
v_pk_fma_f32 v[18:19], v[66:67], v[66:67], v[18:19]
v_pk_fma_f32 v[20:21], v[68:69], v[68:69], v[20:21]
v_pk_fma_f32 v[22:23], v[70:71], v[70:71], v[22:23]
v_pk_fma_f32 v[24:25], v[72:73], v[72:73], v[24:25]
v_pk_fma_f32 v[26:27], v[74:75], v[74:75], v[26:27]
v_pk_fma_f32 v[28:29], v[76:77], v[76:77], v[28:29]
v_pk_fma_f32 v[30:31], v[78:79], v[78:79], v[30:31]
v_pk_fma_f32 v[80:81], v[48:49], v[48:49], s[68:69]
v_pk_fma_f32 v[82:83], v[50:51], v[50:51], s[68:69]
v_pk_fma_f32 v[84:85], v[52:53], v[52:53], s[68:69]
v_pk_fma_f32 v[86:87], v[54:55], v[54:55], s[68:69]
v_pk_fma_f32 v[88:89], v[56:57], v[56:57], s[68:69]
v_pk_fma_f32 v[90:91], v[58:59], v[58:59], s[68:69]
v_pk_fma_f32 v[92:93], v[60:61], v[60:61], s[68:69]
v_pk_fma_f32 v[94:95], v[62:63], v[62:63], s[68:69]
v_pk_mul_f32 v[80:81], v[48:49], v[80:81] neg_lo:[1,0] neg_hi:[1,0]
v_pk_mul_f32 v[82:83], v[50:51], v[82:83] neg_lo:[1,0] neg_hi:[1,0]
v_pk_mul_f32 v[84:85], v[52:53], v[84:85] neg_lo:[1,0] neg_hi:[1,0]
v_pk_mul_f32 v[86:87], v[54:55], v[86:87] neg_lo:[1,0] neg_hi:[1,0]
v_pk_mul_f32 v[88:89], v[56:57], v[88:89] neg_lo:[1,0] neg_hi:[1,0]
v_pk_mul_f32 v[90:91], v[58:59], v[90:91] neg_lo:[1,0] neg_hi:[1,0]
v_pk_mul_f32 v[92:93], v[60:61], v[92:93] neg_lo:[1,0] neg_hi:[1,0]
v_pk_mul_f32 v[94:95], v[62:63], v[94:95] neg_lo:[1,0] neg_hi:[1,0]
v_mfma_f32_32x32x16_bf16 v[32:47], a[144:147], a[96:99], 0
v_exp_f32_e64 v80, v80
v_cvt_pk_bf16_f32 v64, v64, v65
v_exp_f32_e64 v81, v81
v_cvt_pk_bf16_f32 v65, v66, v67
v_mfma_f32_32x32x16_bf16 v[32:47], a[148:151], a[100:103], v[32:47]
v_exp_f32_e64 v82, v82
v_cvt_pk_bf16_f32 v66, v68, v69
v_exp_f32_e64 v83, v83
v_cvt_pk_bf16_f32 v67, v70, v71
v_mfma_f32_32x32x16_bf16 v[32:47], a[152:155], a[104:107], v[32:47]
v_exp_f32_e64 v84, v84
v_accvgpr_write_b32 a72, v64
v_exp_f32_e64 v85, v85
v_accvgpr_write_b32 a73, v65
v_mfma_f32_32x32x16_bf16 v[32:47], a[156:159], a[108:111], v[32:47]
v_exp_f32 v86, v86
v_exp_f32 v87, v87
v_exp_f32_e64 v88, v88
v_mfma_f32_32x32x16_bf16 v[32:47], a[160:163], a[112:115], v[32:47]
v_exp_f32_e64 v89, v89
v_accvgpr_write_b32 a74, v66
v_exp_f32 v90, v90
s_waitcnt lgkmcnt(0)
v_mfma_f32_32x32x16_bf16 v[32:47], a[164:167], a[116:119], v[32:47]
v_exp_f32_e64 v91, v91
v_accvgpr_write_b32 a75, v67
v_exp_f32 v92, v92
v_exp_f32 v93, v93
v_exp_f32 v94, v94
v_exp_f32 v95, v95
v_pk_add_f32 v[80:81], v[80:81], s[70:71]
v_pk_add_f32 v[82:83], v[82:83], s[70:71]
v_pk_add_f32 v[84:85], v[84:85], s[70:71]
v_pk_add_f32 v[86:87], v[86:87], s[70:71]
v_pk_add_f32 v[88:89], v[88:89], s[70:71]
v_pk_add_f32 v[90:91], v[90:91], s[70:71]
v_pk_add_f32 v[92:93], v[92:93], s[70:71]
v_pk_add_f32 v[94:95], v[94:95], s[70:71]
v_mfma_f32_32x32x16_bf16 v[32:47], a[168:171], a[120:123], v[32:47]
v_rcp_f32_e64 v80, v80
v_cvt_pk_bf16_f32 v68, v72, v73
v_rcp_f32_e64 v81, v81
v_cvt_pk_bf16_f32 v69, v74, v75
v_mfma_f32_32x32x16_bf16 v[32:47], a[172:175], a[124:127], v[32:47]
v_rcp_f32_e64 v82, v82
v_cvt_pk_bf16_f32 v70, v76, v77
v_rcp_f32_e64 v83, v83
v_cvt_pk_bf16_f32 v71, v78, v79
v_mfma_f32_32x32x16_bf16 v[32:47], a[176:179], a[128:131], v[32:47]
v_rcp_f32_e64 v84, v84
v_accvgpr_write_b32 a76, v68
v_rcp_f32_e64 v85, v85
v_accvgpr_write_b32 a77, v69
v_mfma_f32_32x32x16_bf16 v[32:47], a[180:183], a[132:135], v[32:47]
v_rcp_f32 v86, v86
v_rcp_f32 v87, v87
v_rcp_f32_e64 v88, v88
v_mfma_f32_32x32x16_bf16 v[32:47], a[184:187], a[136:139], v[32:47]
v_rcp_f32_e64 v89, v89
v_accvgpr_write_b32 a78, v70
v_rcp_f32_e64 v90, v90
v_mfma_f32_32x32x16_bf16 v[32:47], a[188:191], a[140:143], v[32:47]
buffer_load_dword v12, off, s[36:39], 0 offset:128 sc1
v_rcp_f32_e64 v91, v91
v_accvgpr_write_b32 a79, v71
v_rcp_f32 v92, v92
v_rcp_f32 v93, v93
v_rcp_f32 v94, v94
v_rcp_f32 v95, v95
v_pk_mul_f32 v[80:81], v[48:49], v[80:81]
v_pk_mul_f32 v[82:83], v[50:51], v[82:83]
v_pk_mul_f32 v[84:85], v[52:53], v[84:85]
v_pk_mul_f32 v[86:87], v[54:55], v[86:87]
v_pk_mul_f32 v[88:89], v[56:57], v[88:89]
v_pk_mul_f32 v[90:91], v[58:59], v[90:91]
v_pk_mul_f32 v[92:93], v[60:61], v[92:93]
v_pk_mul_f32 v[94:95], v[62:63], v[94:95]
v_pk_fma_f32 v[240:241], v[80:81], v[80:81], v[240:241]
v_pk_fma_f32 v[242:243], v[82:83], v[82:83], v[242:243]
v_pk_fma_f32 v[244:245], v[84:85], v[84:85], v[244:245]
v_pk_fma_f32 v[246:247], v[86:87], v[86:87], v[246:247]
v_pk_fma_f32 v[248:249], v[88:89], v[88:89], v[248:249]
v_pk_fma_f32 v[250:251], v[90:91], v[90:91], v[250:251]
v_pk_fma_f32 v[252:253], v[92:93], v[92:93], v[252:253]
v_pk_fma_f32 v[254:255], v[94:95], v[94:95], v[254:255]
v_pk_fma_f32 v[64:65], v[32:33], v[32:33], s[68:69]
v_pk_fma_f32 v[66:67], v[34:35], v[34:35], s[68:69]
v_pk_fma_f32 v[68:69], v[36:37], v[36:37], s[68:69]
v_pk_fma_f32 v[70:71], v[38:39], v[38:39], s[68:69]
v_pk_fma_f32 v[72:73], v[40:41], v[40:41], s[68:69]
v_pk_fma_f32 v[74:75], v[42:43], v[42:43], s[68:69]
v_pk_fma_f32 v[76:77], v[44:45], v[44:45], s[68:69]
v_pk_fma_f32 v[78:79], v[46:47], v[46:47], s[68:69]
v_pk_mul_f32 v[64:65], v[32:33], v[64:65] neg_lo:[1,0] neg_hi:[1,0]
v_pk_mul_f32 v[66:67], v[34:35], v[66:67] neg_lo:[1,0] neg_hi:[1,0]
v_pk_mul_f32 v[68:69], v[36:37], v[68:69] neg_lo:[1,0] neg_hi:[1,0]
v_pk_mul_f32 v[70:71], v[38:39], v[70:71] neg_lo:[1,0] neg_hi:[1,0]
v_pk_mul_f32 v[72:73], v[40:41], v[72:73] neg_lo:[1,0] neg_hi:[1,0]
v_pk_mul_f32 v[74:75], v[42:43], v[74:75] neg_lo:[1,0] neg_hi:[1,0]
v_pk_mul_f32 v[76:77], v[44:45], v[76:77] neg_lo:[1,0] neg_hi:[1,0]
v_pk_mul_f32 v[78:79], v[46:47], v[78:79] neg_lo:[1,0] neg_hi:[1,0]
v_mfma_f32_32x32x16_bf16 v[48:63], a[0:3], a[96:99], 0
ds_read_b128 a[96:99], v1 offset:12288
v_exp_f32_e64 v64, v64
v_cvt_pk_bf16_f32 v232, v80, v81
v_exp_f32_e64 v65, v65
v_mfma_f32_32x32x16_bf16 v[48:63], a[4:7], a[100:103], v[48:63]
ds_read_b128 a[100:103], v1 offset:13312
v_exp_f32_e64 v66, v66
v_cvt_pk_bf16_f32 v233, v82, v83
v_exp_f32_e64 v67, v67
v_mfma_f32_32x32x16_bf16 v[48:63], a[8:11], a[104:107], v[48:63]
ds_read_b128 a[104:107], v1 offset:14336
v_exp_f32_e64 v68, v68
v_cvt_pk_bf16_f32 v234, v84, v85
v_exp_f32_e64 v69, v69
v_mfma_f32_32x32x16_bf16 v[48:63], a[12:15], a[108:111], v[48:63]
ds_read_b128 a[108:111], v1 offset:15360
v_exp_f32_e64 v70, v70
v_cvt_pk_bf16_f32 v235, v86, v87
v_exp_f32_e64 v71, v71
v_mfma_f32_32x32x16_bf16 v[48:63], a[16:19], a[112:115], v[48:63]
ds_read_b128 a[112:115], v1 offset:16384
v_exp_f32 v72, v72
v_exp_f32 v73, v73
v_mfma_f32_32x32x16_bf16 v[48:63], a[20:23], a[116:119], v[48:63]
ds_read_b128 a[116:119], v1 offset:17408
v_exp_f32 v74, v74
v_exp_f32 v75, v75
v_exp_f32 v76, v76
v_exp_f32 v77, v77
v_exp_f32 v78, v78
v_exp_f32 v79, v79
v_pk_add_f32 v[64:65], v[64:65], s[70:71]
v_pk_add_f32 v[66:67], v[66:67], s[70:71]
v_pk_add_f32 v[68:69], v[68:69], s[70:71]
v_pk_add_f32 v[70:71], v[70:71], s[70:71]
v_pk_add_f32 v[72:73], v[72:73], s[70:71]
v_pk_add_f32 v[74:75], v[74:75], s[70:71]
v_pk_add_f32 v[76:77], v[76:77], s[70:71]
v_pk_add_f32 v[78:79], v[78:79], s[70:71]
v_mfma_f32_32x32x16_bf16 v[48:63], a[24:27], a[120:123], v[48:63]
ds_read_b128 a[120:123], v1 offset:18432
v_rcp_f32_e64 v64, v64
v_cvt_pk_bf16_f32 v236, v88, v89
v_rcp_f32_e64 v65, v65
v_mfma_f32_32x32x16_bf16 v[48:63], a[28:31], a[124:127], v[48:63]
ds_read_b128 a[124:127], v1 offset:19456
v_rcp_f32_e64 v66, v66
v_cvt_pk_bf16_f32 v237, v90, v91
v_rcp_f32_e64 v67, v67
v_mfma_f32_32x32x16_bf16 v[48:63], a[32:35], a[128:131], v[48:63]
ds_read_b128 a[128:131], v1 offset:20480
v_rcp_f32_e64 v68, v68
v_cvt_pk_bf16_f32 v238, v92, v93
v_rcp_f32_e64 v69, v69
v_mfma_f32_32x32x16_bf16 v[48:63], a[36:39], a[132:135], v[48:63]
ds_read_b128 a[132:135], v1 offset:21504
v_rcp_f32_e64 v70, v70
v_cvt_pk_bf16_f32 v239, v94, v95
v_rcp_f32_e64 v71, v71
v_mfma_f32_32x32x16_bf16 v[48:63], a[40:43], a[136:139], v[48:63]
ds_read_b128 a[136:139], v1 offset:22528
v_rcp_f32 v72, v72
v_rcp_f32_e64 v73, v73
s_waitcnt lgkmcnt(5)
v_mfma_f32_32x32x16_bf16 v[48:63], a[44:47], a[140:143], v[48:63]
ds_read_b128 a[140:143], v1 offset:23552
v_rcp_f32 v74, v74
v_rcp_f32 v75, v75
v_rcp_f32 v76, v76
v_rcp_f32 v77, v77
v_rcp_f32 v78, v78
v_rcp_f32 v79, v79
v_pk_mul_f32 v[64:65], v[32:33], v[64:65]
v_pk_mul_f32 v[66:67], v[34:35], v[66:67]
v_pk_mul_f32 v[68:69], v[36:37], v[68:69]
v_pk_mul_f32 v[70:71], v[38:39], v[70:71]
v_pk_mul_f32 v[72:73], v[40:41], v[72:73]
v_pk_mul_f32 v[74:75], v[42:43], v[74:75]
v_pk_mul_f32 v[76:77], v[44:45], v[76:77]
v_pk_mul_f32 v[78:79], v[46:47], v[78:79]
v_pk_fma_f32 v[16:17], v[64:65], v[64:65], v[16:17]
v_pk_fma_f32 v[18:19], v[66:67], v[66:67], v[18:19]
v_pk_fma_f32 v[20:21], v[68:69], v[68:69], v[20:21]
v_pk_fma_f32 v[22:23], v[70:71], v[70:71], v[22:23]
v_pk_fma_f32 v[24:25], v[72:73], v[72:73], v[24:25]
v_pk_fma_f32 v[26:27], v[74:75], v[74:75], v[26:27]
v_pk_fma_f32 v[28:29], v[76:77], v[76:77], v[28:29]
v_pk_fma_f32 v[30:31], v[78:79], v[78:79], v[30:31]
v_pk_fma_f32 v[80:81], v[48:49], v[48:49], s[68:69]
v_pk_fma_f32 v[82:83], v[50:51], v[50:51], s[68:69]
v_pk_fma_f32 v[84:85], v[52:53], v[52:53], s[68:69]
v_pk_fma_f32 v[86:87], v[54:55], v[54:55], s[68:69]
v_pk_fma_f32 v[88:89], v[56:57], v[56:57], s[68:69]
v_pk_fma_f32 v[90:91], v[58:59], v[58:59], s[68:69]
v_pk_fma_f32 v[92:93], v[60:61], v[60:61], s[68:69]
v_pk_fma_f32 v[94:95], v[62:63], v[62:63], s[68:69]
v_pk_mul_f32 v[80:81], v[48:49], v[80:81] neg_lo:[1,0] neg_hi:[1,0]
v_pk_mul_f32 v[82:83], v[50:51], v[82:83] neg_lo:[1,0] neg_hi:[1,0]
v_pk_mul_f32 v[84:85], v[52:53], v[84:85] neg_lo:[1,0] neg_hi:[1,0]
v_pk_mul_f32 v[86:87], v[54:55], v[86:87] neg_lo:[1,0] neg_hi:[1,0]
v_pk_mul_f32 v[88:89], v[56:57], v[88:89] neg_lo:[1,0] neg_hi:[1,0]
v_pk_mul_f32 v[90:91], v[58:59], v[90:91] neg_lo:[1,0] neg_hi:[1,0]
v_pk_mul_f32 v[92:93], v[60:61], v[92:93] neg_lo:[1,0] neg_hi:[1,0]
v_pk_mul_f32 v[94:95], v[62:63], v[94:95] neg_lo:[1,0] neg_hi:[1,0]
v_mfma_f32_32x32x16_bf16 v[32:47], a[144:147], a[96:99], 0
v_exp_f32_e64 v80, v80
v_cvt_pk_bf16_f32 v64, v64, v65
v_exp_f32_e64 v81, v81
v_cvt_pk_bf16_f32 v65, v66, v67
v_mfma_f32_32x32x16_bf16 v[32:47], a[148:151], a[100:103], v[32:47]
v_exp_f32_e64 v82, v82
v_cvt_pk_bf16_f32 v66, v68, v69
v_exp_f32_e64 v83, v83
v_cvt_pk_bf16_f32 v67, v70, v71
v_mfma_f32_32x32x16_bf16 v[32:47], a[152:155], a[104:107], v[32:47]
v_exp_f32_e64 v84, v84
v_accvgpr_write_b32 a80, v64
v_exp_f32_e64 v85, v85
v_accvgpr_write_b32 a81, v65
v_mfma_f32_32x32x16_bf16 v[32:47], a[156:159], a[108:111], v[32:47]
v_exp_f32 v86, v86
v_exp_f32 v87, v87
v_exp_f32_e64 v88, v88
v_mfma_f32_32x32x16_bf16 v[32:47], a[160:163], a[112:115], v[32:47]
v_exp_f32_e64 v89, v89
v_accvgpr_write_b32 a82, v66
v_exp_f32 v90, v90
s_waitcnt lgkmcnt(0)
v_mfma_f32_32x32x16_bf16 v[32:47], a[164:167], a[116:119], v[32:47]
v_exp_f32_e64 v91, v91
v_accvgpr_write_b32 a83, v67
v_exp_f32 v92, v92
v_exp_f32 v93, v93
v_exp_f32 v94, v94
v_exp_f32 v95, v95
v_pk_add_f32 v[80:81], v[80:81], s[70:71]
v_pk_add_f32 v[82:83], v[82:83], s[70:71]
v_pk_add_f32 v[84:85], v[84:85], s[70:71]
v_pk_add_f32 v[86:87], v[86:87], s[70:71]
v_pk_add_f32 v[88:89], v[88:89], s[70:71]
v_pk_add_f32 v[90:91], v[90:91], s[70:71]
v_pk_add_f32 v[92:93], v[92:93], s[70:71]
v_pk_add_f32 v[94:95], v[94:95], s[70:71]
v_mfma_f32_32x32x16_bf16 v[32:47], a[168:171], a[120:123], v[32:47]
v_rcp_f32_e64 v80, v80
v_cvt_pk_bf16_f32 v68, v72, v73
v_rcp_f32_e64 v81, v81
v_cvt_pk_bf16_f32 v69, v74, v75
v_mfma_f32_32x32x16_bf16 v[32:47], a[172:175], a[124:127], v[32:47]
v_rcp_f32_e64 v82, v82
v_cvt_pk_bf16_f32 v70, v76, v77
v_rcp_f32_e64 v83, v83
v_cvt_pk_bf16_f32 v71, v78, v79
v_mfma_f32_32x32x16_bf16 v[32:47], a[176:179], a[128:131], v[32:47]
v_rcp_f32_e64 v84, v84
v_accvgpr_write_b32 a84, v68
v_rcp_f32_e64 v85, v85
v_accvgpr_write_b32 a85, v69
v_mfma_f32_32x32x16_bf16 v[32:47], a[180:183], a[132:135], v[32:47]
v_rcp_f32 v86, v86
v_rcp_f32 v87, v87
v_rcp_f32_e64 v88, v88
v_mfma_f32_32x32x16_bf16 v[32:47], a[184:187], a[136:139], v[32:47]
v_rcp_f32_e64 v89, v89
v_accvgpr_write_b32 a86, v70
v_rcp_f32_e64 v90, v90
v_mfma_f32_32x32x16_bf16 v[32:47], a[188:191], a[140:143], v[32:47]
v_rcp_f32_e64 v91, v91
v_accvgpr_write_b32 a87, v71
v_rcp_f32 v92, v92
v_rcp_f32 v93, v93
v_rcp_f32 v94, v94
v_rcp_f32 v95, v95
v_pk_mul_f32 v[80:81], v[48:49], v[80:81]
v_pk_mul_f32 v[82:83], v[50:51], v[82:83]
v_pk_mul_f32 v[84:85], v[52:53], v[84:85]
v_pk_mul_f32 v[86:87], v[54:55], v[86:87]
v_pk_mul_f32 v[88:89], v[56:57], v[88:89]
v_pk_mul_f32 v[90:91], v[58:59], v[90:91]
v_pk_mul_f32 v[92:93], v[60:61], v[92:93]
v_pk_mul_f32 v[94:95], v[62:63], v[94:95]
v_pk_fma_f32 v[240:241], v[80:81], v[80:81], v[240:241]
v_pk_fma_f32 v[242:243], v[82:83], v[82:83], v[242:243]
v_pk_fma_f32 v[244:245], v[84:85], v[84:85], v[244:245]
v_pk_fma_f32 v[246:247], v[86:87], v[86:87], v[246:247]
v_pk_fma_f32 v[248:249], v[88:89], v[88:89], v[248:249]
v_pk_fma_f32 v[250:251], v[90:91], v[90:91], v[250:251]
v_pk_fma_f32 v[252:253], v[92:93], v[92:93], v[252:253]
v_pk_fma_f32 v[254:255], v[94:95], v[94:95], v[254:255]
v_pk_fma_f32 v[64:65], v[32:33], v[32:33], s[68:69]
v_pk_fma_f32 v[66:67], v[34:35], v[34:35], s[68:69]
v_pk_fma_f32 v[68:69], v[36:37], v[36:37], s[68:69]
v_pk_fma_f32 v[70:71], v[38:39], v[38:39], s[68:69]
v_pk_fma_f32 v[72:73], v[40:41], v[40:41], s[68:69]
v_pk_fma_f32 v[74:75], v[42:43], v[42:43], s[68:69]
v_pk_fma_f32 v[76:77], v[44:45], v[44:45], s[68:69]
v_pk_fma_f32 v[78:79], v[46:47], v[46:47], s[68:69]
v_pk_mul_f32 v[64:65], v[32:33], v[64:65] neg_lo:[1,0] neg_hi:[1,0]
v_pk_mul_f32 v[66:67], v[34:35], v[66:67] neg_lo:[1,0] neg_hi:[1,0]
v_pk_mul_f32 v[68:69], v[36:37], v[68:69] neg_lo:[1,0] neg_hi:[1,0]
v_pk_mul_f32 v[70:71], v[38:39], v[70:71] neg_lo:[1,0] neg_hi:[1,0]
v_pk_mul_f32 v[72:73], v[40:41], v[72:73] neg_lo:[1,0] neg_hi:[1,0]
v_pk_mul_f32 v[74:75], v[42:43], v[74:75] neg_lo:[1,0] neg_hi:[1,0]
v_pk_mul_f32 v[76:77], v[44:45], v[76:77] neg_lo:[1,0] neg_hi:[1,0]
v_pk_mul_f32 v[78:79], v[46:47], v[78:79] neg_lo:[1,0] neg_hi:[1,0]
v_mfma_f32_32x32x16_bf16 v[48:63], a[0:3], a[96:99], 0
ds_read_b128 a[96:99], v1 offset:24576
v_exp_f32_e64 v64, v64
v_cvt_pk_bf16_f32 v80, v80, v81
v_exp_f32_e64 v65, v65
v_mfma_f32_32x32x16_bf16 v[48:63], a[4:7], a[100:103], v[48:63]
ds_read_b128 a[100:103], v1 offset:25600
v_exp_f32_e64 v66, v66
v_cvt_pk_bf16_f32 v81, v82, v83
v_exp_f32_e64 v67, v67
v_mfma_f32_32x32x16_bf16 v[48:63], a[8:11], a[104:107], v[48:63]
ds_read_b128 a[104:107], v1 offset:26624
v_exp_f32_e64 v68, v68
v_cvt_pk_bf16_f32 v82, v84, v85
v_exp_f32_e64 v69, v69
v_mfma_f32_32x32x16_bf16 v[48:63], a[12:15], a[108:111], v[48:63]
ds_read_b128 a[108:111], v1 offset:27648
v_exp_f32_e64 v70, v70
v_cvt_pk_bf16_f32 v83, v86, v87
v_exp_f32_e64 v71, v71
v_mfma_f32_32x32x16_bf16 v[48:63], a[16:19], a[112:115], v[48:63]
ds_read_b128 a[112:115], v1 offset:28672
v_exp_f32_e64 v72, v72
v_accvgpr_write_b32 a248, v80
v_accvgpr_write_b32 a249, v81
v_mfma_f32_32x32x16_bf16 v[48:63], a[20:23], a[116:119], v[48:63]
ds_read_b128 a[116:119], v1 offset:29696
v_exp_f32_e64 v73, v73
v_accvgpr_write_b32 a250, v82
v_exp_f32_e64 v74, v74
v_accvgpr_write_b32 a251, v83
v_exp_f32 v75, v75
v_exp_f32 v76, v76
v_exp_f32 v77, v77
v_exp_f32 v78, v78
v_exp_f32_e64 v79, v79
v_pk_add_f32 v[64:65], v[64:65], s[70:71]
v_pk_add_f32 v[66:67], v[66:67], s[70:71]
v_pk_add_f32 v[68:69], v[68:69], s[70:71]
v_pk_add_f32 v[70:71], v[70:71], s[70:71]
v_pk_add_f32 v[72:73], v[72:73], s[70:71]
v_pk_add_f32 v[74:75], v[74:75], s[70:71]
v_pk_add_f32 v[76:77], v[76:77], s[70:71]
v_pk_add_f32 v[78:79], v[78:79], s[70:71]
v_mfma_f32_32x32x16_bf16 v[48:63], a[24:27], a[120:123], v[48:63]
ds_read_b128 a[120:123], v1 offset:30720
v_rcp_f32_e64 v64, v64
v_cvt_pk_bf16_f32 v84, v88, v89
v_rcp_f32_e64 v65, v65
v_cvt_pk_bf16_f32 v85, v90, v91
v_mfma_f32_32x32x16_bf16 v[48:63], a[28:31], a[124:127], v[48:63]
ds_read_b128 a[124:127], v1 offset:31744
v_rcp_f32_e64 v66, v66
v_cvt_pk_bf16_f32 v86, v92, v93
v_rcp_f32_e64 v67, v67
v_cvt_pk_bf16_f32 v87, v94, v95
v_mfma_f32_32x32x16_bf16 v[48:63], a[32:35], a[128:131], v[48:63]
ds_read_b128 a[128:131], v1 offset:32768
v_rcp_f32_e64 v68, v68
v_accvgpr_write_b32 a252, v84
v_rcp_f32_e64 v69, v69
v_accvgpr_write_b32 a253, v85
v_mfma_f32_32x32x16_bf16 v[48:63], a[36:39], a[132:135], v[48:63]
ds_read_b128 a[132:135], v1 offset:33792
v_rcp_f32_e64 v70, v70
v_accvgpr_write_b32 a254, v86
v_rcp_f32_e64 v71, v71
v_accvgpr_write_b32 a255, v87
v_mfma_f32_32x32x16_bf16 v[48:63], a[40:43], a[136:139], v[48:63]
ds_read_b128 a[136:139], v1 offset:34816
v_rcp_f32_e64 v72, v72
v_cmp_gt_u32_e64 s[96:97], 32, v0
v_rcp_f32 v73, v73
s_waitcnt lgkmcnt(5)
v_mfma_f32_32x32x16_bf16 v[48:63], a[44:47], a[140:143], v[48:63]
ds_read_b128 a[140:143], v1 offset:35840
v_rcp_f32 v74, v74
v_mov_b32 v3, v1
v_rcp_f32 v75, v75
v_and_b32 v2, 15, v0
v_rcp_f32 v76, v76
v_lshlrev_b32 v2, 7, v2
v_rcp_f32 v77, v77
s_and_b32 s101, s2, 15
v_rcp_f32 v78, v78
s_lshl_b32 s101, s101, 7
v_rcp_f32_e64 v79, v79
s_add_u32 s101, s101, 623744
v_pk_mul_f32 v[64:65], v[32:33], v[64:65]
v_pk_mul_f32 v[66:67], v[34:35], v[66:67]
v_pk_mul_f32 v[68:69], v[36:37], v[68:69]
v_pk_mul_f32 v[70:71], v[38:39], v[70:71]
v_pk_mul_f32 v[72:73], v[40:41], v[72:73]
v_pk_mul_f32 v[74:75], v[42:43], v[74:75]
v_pk_mul_f32 v[76:77], v[44:45], v[76:77]
v_pk_mul_f32 v[78:79], v[46:47], v[78:79]
v_pk_fma_f32 v[16:17], v[64:65], v[64:65], v[16:17]
v_pk_fma_f32 v[18:19], v[66:67], v[66:67], v[18:19]
v_pk_fma_f32 v[20:21], v[68:69], v[68:69], v[20:21]
v_pk_fma_f32 v[22:23], v[70:71], v[70:71], v[22:23]
v_pk_fma_f32 v[24:25], v[72:73], v[72:73], v[24:25]
v_pk_fma_f32 v[26:27], v[74:75], v[74:75], v[26:27]
v_pk_fma_f32 v[28:29], v[76:77], v[76:77], v[28:29]
v_pk_fma_f32 v[30:31], v[78:79], v[78:79], v[30:31]
v_pk_fma_f32 v[80:81], v[48:49], v[48:49], s[68:69]
v_pk_fma_f32 v[82:83], v[50:51], v[50:51], s[68:69]
v_pk_fma_f32 v[84:85], v[52:53], v[52:53], s[68:69]
v_pk_fma_f32 v[86:87], v[54:55], v[54:55], s[68:69]
v_pk_fma_f32 v[88:89], v[56:57], v[56:57], s[68:69]
v_pk_fma_f32 v[90:91], v[58:59], v[58:59], s[68:69]
v_pk_fma_f32 v[92:93], v[60:61], v[60:61], s[68:69]
v_pk_fma_f32 v[94:95], v[62:63], v[62:63], s[68:69]
v_pk_mul_f32 v[80:81], v[48:49], v[80:81] neg_lo:[1,0] neg_hi:[1,0]
v_pk_mul_f32 v[82:83], v[50:51], v[82:83] neg_lo:[1,0] neg_hi:[1,0]
v_pk_mul_f32 v[84:85], v[52:53], v[84:85] neg_lo:[1,0] neg_hi:[1,0]
v_pk_mul_f32 v[86:87], v[54:55], v[86:87] neg_lo:[1,0] neg_hi:[1,0]
v_pk_mul_f32 v[88:89], v[56:57], v[88:89] neg_lo:[1,0] neg_hi:[1,0]
v_pk_mul_f32 v[90:91], v[58:59], v[90:91] neg_lo:[1,0] neg_hi:[1,0]
v_pk_mul_f32 v[92:93], v[60:61], v[92:93] neg_lo:[1,0] neg_hi:[1,0]
v_pk_mul_f32 v[94:95], v[62:63], v[94:95] neg_lo:[1,0] neg_hi:[1,0]
v_mov_b32 v7, 1
s_waitcnt vmcnt(0)
s_barrier
s_mov_b64 exec, 1
buffer_atomic_add v7, off, s[32:35], s95 sc0 sc1
s_mov_b64 exec, -1
v_readfirstlane_b32 s50, v12
s_nop 0
s_cmp_lt_u32 s50, 6
s_cbranch_scc1 L_c2_cold
L_c2_done:
v_mfma_f32_32x32x16_bf16 v[32:47], a[144:147], a[96:99], 0
v_exp_f32 v80, v80
v_cvt_pk_bf16_f32 v64, v64, v65
v_exp_f32_e64 v81, v81
v_cvt_pk_bf16_f32 v65, v66, v67
v_mfma_f32_32x32x16_bf16 v[32:47], a[148:151], a[100:103], v[32:47]
v_exp_f32_e64 v82, v82
v_cvt_pk_bf16_f32 v66, v68, v69
v_exp_f32_e64 v83, v83
v_cvt_pk_bf16_f32 v67, v70, v71
v_mfma_f32_32x32x16_bf16 v[32:47], a[152:155], a[104:107], v[32:47]
v_exp_f32_e64 v84, v84
v_accvgpr_write_b32 a88, v64
v_exp_f32_e64 v85, v85
v_accvgpr_write_b32 a89, v65
v_mfma_f32_32x32x16_bf16 v[32:47], a[156:159], a[108:111], v[32:47]
v_exp_f32 v86, v86
v_exp_f32 v87, v87
v_exp_f32_e64 v88, v88
v_mfma_f32_32x32x16_bf16 v[32:47], a[160:163], a[112:115], v[32:47]
v_exp_f32_e64 v89, v89
v_accvgpr_write_b32 a90, v66
v_exp_f32 v90, v90
s_waitcnt lgkmcnt(0)
v_mfma_f32_32x32x16_bf16 v[32:47], a[164:167], a[116:119], v[32:47]
v_exp_f32_e64 v91, v91
v_accvgpr_write_b32 a91, v67
v_exp_f32 v92, v92
v_exp_f32 v93, v93
v_exp_f32 v94, v94
v_exp_f32 v95, v95
v_pk_add_f32 v[80:81], v[80:81], s[70:71]
v_pk_add_f32 v[82:83], v[82:83], s[70:71]
v_pk_add_f32 v[84:85], v[84:85], s[70:71]
v_pk_add_f32 v[86:87], v[86:87], s[70:71]
v_pk_add_f32 v[88:89], v[88:89], s[70:71]
v_pk_add_f32 v[90:91], v[90:91], s[70:71]
v_pk_add_f32 v[92:93], v[92:93], s[70:71]
v_pk_add_f32 v[94:95], v[94:95], s[70:71]
v_mfma_f32_32x32x16_bf16 v[32:47], a[168:171], a[120:123], v[32:47]
v_rcp_f32_e64 v80, v80
v_cvt_pk_bf16_f32 v68, v72, v73
v_rcp_f32_e64 v81, v81
v_cvt_pk_bf16_f32 v69, v74, v75
v_mfma_f32_32x32x16_bf16 v[32:47], a[172:175], a[124:127], v[32:47]
v_rcp_f32_e64 v82, v82
v_cvt_pk_bf16_f32 v70, v76, v77
v_rcp_f32_e64 v83, v83
v_cvt_pk_bf16_f32 v71, v78, v79
v_mfma_f32_32x32x16_bf16 v[32:47], a[176:179], a[128:131], v[32:47]
v_rcp_f32_e64 v84, v84
v_accvgpr_write_b32 a92, v68
v_rcp_f32_e64 v85, v85
v_accvgpr_write_b32 a93, v69
v_mfma_f32_32x32x16_bf16 v[32:47], a[180:183], a[132:135], v[32:47]
v_rcp_f32 v86, v86
v_rcp_f32 v87, v87
v_rcp_f32_e64 v88, v88
v_mfma_f32_32x32x16_bf16 v[32:47], a[184:187], a[136:139], v[32:47]
v_rcp_f32_e64 v89, v89
v_accvgpr_write_b32 a94, v70
v_rcp_f32_e64 v90, v90
v_mfma_f32_32x32x16_bf16 v[32:47], a[188:191], a[140:143], v[32:47]
v_rcp_f32_e64 v91, v91
v_accvgpr_write_b32 a95, v71
v_rcp_f32 v92, v92
v_rcp_f32 v93, v93
v_rcp_f32 v94, v94
v_rcp_f32 v95, v95
v_pk_mul_f32 v[80:81], v[48:49], v[80:81]
v_pk_mul_f32 v[82:83], v[50:51], v[82:83]
v_pk_mul_f32 v[84:85], v[52:53], v[84:85]
v_pk_mul_f32 v[86:87], v[54:55], v[86:87]
v_pk_mul_f32 v[88:89], v[56:57], v[88:89]
v_pk_mul_f32 v[90:91], v[58:59], v[90:91]
v_pk_mul_f32 v[92:93], v[60:61], v[92:93]
v_pk_mul_f32 v[94:95], v[62:63], v[94:95]
v_pk_fma_f32 v[240:241], v[80:81], v[80:81], v[240:241]
v_pk_fma_f32 v[242:243], v[82:83], v[82:83], v[242:243]
v_pk_fma_f32 v[244:245], v[84:85], v[84:85], v[244:245]
v_pk_fma_f32 v[246:247], v[86:87], v[86:87], v[246:247]
v_pk_fma_f32 v[248:249], v[88:89], v[88:89], v[248:249]
v_pk_fma_f32 v[250:251], v[90:91], v[90:91], v[250:251]
v_pk_fma_f32 v[252:253], v[92:93], v[92:93], v[252:253]
v_pk_fma_f32 v[254:255], v[94:95], v[94:95], v[254:255]
v_pk_fma_f32 v[64:65], v[32:33], v[32:33], s[68:69]
v_pk_fma_f32 v[66:67], v[34:35], v[34:35], s[68:69]
v_pk_fma_f32 v[68:69], v[36:37], v[36:37], s[68:69]
v_pk_fma_f32 v[70:71], v[38:39], v[38:39], s[68:69]
v_pk_fma_f32 v[72:73], v[40:41], v[40:41], s[68:69]
v_pk_fma_f32 v[74:75], v[42:43], v[42:43], s[68:69]
v_pk_fma_f32 v[76:77], v[44:45], v[44:45], s[68:69]
v_pk_fma_f32 v[78:79], v[46:47], v[46:47], s[68:69]
v_pk_mul_f32 v[64:65], v[32:33], v[64:65] neg_lo:[1,0] neg_hi:[1,0]
v_pk_mul_f32 v[66:67], v[34:35], v[66:67] neg_lo:[1,0] neg_hi:[1,0]
v_pk_mul_f32 v[68:69], v[36:37], v[68:69] neg_lo:[1,0] neg_hi:[1,0]
v_pk_mul_f32 v[70:71], v[38:39], v[70:71] neg_lo:[1,0] neg_hi:[1,0]
v_pk_mul_f32 v[72:73], v[40:41], v[72:73] neg_lo:[1,0] neg_hi:[1,0]
v_pk_mul_f32 v[74:75], v[42:43], v[74:75] neg_lo:[1,0] neg_hi:[1,0]
v_pk_mul_f32 v[76:77], v[44:45], v[76:77] neg_lo:[1,0] neg_hi:[1,0]
v_pk_mul_f32 v[78:79], v[46:47], v[78:79] neg_lo:[1,0] neg_hi:[1,0]
v_mfma_f32_32x32x16_bf16 v[48:63], a[0:3], a[96:99], 0
v_exp_f32_e64 v64, v64
v_cvt_pk_bf16_f32 v80, v80, v81
v_exp_f32_e64 v65, v65
v_cvt_pk_bf16_f32 v81, v82, v83
v_mfma_f32_32x32x16_bf16 v[48:63], a[4:7], a[100:103], v[48:63]
v_exp_f32_e64 v66, v66
v_cvt_pk_bf16_f32 v82, v84, v85
v_exp_f32_e64 v67, v67
v_cvt_pk_bf16_f32 v83, v86, v87
v_mfma_f32_32x32x16_bf16 v[48:63], a[8:11], a[104:107], v[48:63]
v_exp_f32_e64 v68, v68
v_accvgpr_write_b32 a152, v80
v_exp_f32_e64 v69, v69
v_accvgpr_write_b32 a153, v81
v_mfma_f32_32x32x16_bf16 v[48:63], a[12:15], a[108:111], v[48:63]
v_exp_f32 v70, v70
v_exp_f32 v71, v71
v_exp_f32_e64 v72, v72
v_mfma_f32_32x32x16_bf16 v[48:63], a[16:19], a[112:115], v[48:63]
v_exp_f32_e64 v73, v73
v_accvgpr_write_b32 a154, v82
v_exp_f32_e64 v74, v74
v_mfma_f32_32x32x16_bf16 v[48:63], a[20:23], a[116:119], v[48:63]
v_exp_f32_e64 v75, v75
v_accvgpr_write_b32 a155, v83
v_exp_f32 v76, v76
v_exp_f32 v77, v77
v_exp_f32 v78, v78
v_exp_f32 v79, v79
v_pk_add_f32 v[64:65], v[64:65], s[70:71]
v_pk_add_f32 v[66:67], v[66:67], s[70:71]
v_pk_add_f32 v[68:69], v[68:69], s[70:71]
v_pk_add_f32 v[70:71], v[70:71], s[70:71]
v_pk_add_f32 v[72:73], v[72:73], s[70:71]
v_pk_add_f32 v[74:75], v[74:75], s[70:71]
v_pk_add_f32 v[76:77], v[76:77], s[70:71]
v_pk_add_f32 v[78:79], v[78:79], s[70:71]
v_mfma_f32_32x32x16_bf16 v[48:63], a[24:27], a[120:123], v[48:63]
v_rcp_f32_e64 v64, v64
v_cvt_pk_bf16_f32 v84, v88, v89
v_rcp_f32_e64 v65, v65
v_cvt_pk_bf16_f32 v85, v90, v91
v_mfma_f32_32x32x16_bf16 v[48:63], a[28:31], a[124:127], v[48:63]
v_rcp_f32_e64 v66, v66
v_cvt_pk_bf16_f32 v86, v92, v93
v_rcp_f32_e64 v67, v67
v_cvt_pk_bf16_f32 v87, v94, v95
v_mfma_f32_32x32x16_bf16 v[48:63], a[32:35], a[128:131], v[48:63]
v_rcp_f32_e64 v68, v68
v_accvgpr_write_b32 a156, v84
v_rcp_f32_e64 v69, v69
v_accvgpr_write_b32 a157, v85
v_mfma_f32_32x32x16_bf16 v[48:63], a[36:39], a[132:135], v[48:63]
v_rcp_f32 v70, v70
v_rcp_f32 v71, v71
v_rcp_f32_e64 v72, v72
v_mfma_f32_32x32x16_bf16 v[48:63], a[40:43], a[136:139], v[48:63]
v_rcp_f32_e64 v73, v73
v_accvgpr_write_b32 a158, v86
v_rcp_f32_e64 v74, v74
v_mfma_f32_32x32x16_bf16 v[48:63], a[44:47], a[140:143], v[48:63]
v_rcp_f32_e64 v75, v75
v_accvgpr_write_b32 a159, v87
v_rcp_f32 v76, v76
v_rcp_f32 v77, v77
v_rcp_f32 v78, v78
v_rcp_f32 v79, v79
v_pk_mul_f32 v[64:65], v[32:33], v[64:65]
v_pk_mul_f32 v[66:67], v[34:35], v[66:67]
v_pk_mul_f32 v[68:69], v[36:37], v[68:69]
v_pk_mul_f32 v[70:71], v[38:39], v[70:71]
v_pk_mul_f32 v[72:73], v[40:41], v[72:73]
v_pk_mul_f32 v[74:75], v[42:43], v[74:75]
v_pk_mul_f32 v[76:77], v[44:45], v[76:77]
v_pk_mul_f32 v[78:79], v[46:47], v[78:79]
v_pk_fma_f32 v[16:17], v[64:65], v[64:65], v[16:17]
v_pk_fma_f32 v[18:19], v[66:67], v[66:67], v[18:19]
v_pk_fma_f32 v[20:21], v[68:69], v[68:69], v[20:21]
v_pk_fma_f32 v[22:23], v[70:71], v[70:71], v[22:23]
v_pk_fma_f32 v[24:25], v[72:73], v[72:73], v[24:25]
v_pk_fma_f32 v[26:27], v[74:75], v[74:75], v[26:27]
v_pk_fma_f32 v[28:29], v[76:77], v[76:77], v[28:29]
v_pk_fma_f32 v[30:31], v[78:79], v[78:79], v[30:31]
v_pk_fma_f32 v[80:81], v[48:49], v[48:49], s[68:69]
v_pk_fma_f32 v[82:83], v[50:51], v[50:51], s[68:69]
v_pk_fma_f32 v[84:85], v[52:53], v[52:53], s[68:69]
v_pk_fma_f32 v[86:87], v[54:55], v[54:55], s[68:69]
v_pk_fma_f32 v[88:89], v[56:57], v[56:57], s[68:69]
v_pk_fma_f32 v[90:91], v[58:59], v[58:59], s[68:69]
v_pk_fma_f32 v[92:93], v[60:61], v[60:61], s[68:69]
v_pk_fma_f32 v[94:95], v[62:63], v[62:63], s[68:69]
v_pk_mul_f32 v[80:81], v[48:49], v[80:81] neg_lo:[1,0] neg_hi:[1,0]
v_pk_mul_f32 v[82:83], v[50:51], v[82:83] neg_lo:[1,0] neg_hi:[1,0]
v_pk_mul_f32 v[84:85], v[52:53], v[84:85] neg_lo:[1,0] neg_hi:[1,0]
v_pk_mul_f32 v[86:87], v[54:55], v[86:87] neg_lo:[1,0] neg_hi:[1,0]
v_pk_mul_f32 v[88:89], v[56:57], v[88:89] neg_lo:[1,0] neg_hi:[1,0]
v_pk_mul_f32 v[90:91], v[58:59], v[90:91] neg_lo:[1,0] neg_hi:[1,0]
v_pk_mul_f32 v[92:93], v[60:61], v[92:93] neg_lo:[1,0] neg_hi:[1,0]
v_pk_mul_f32 v[94:95], v[62:63], v[94:95] neg_lo:[1,0] neg_hi:[1,0]
v_exp_f32_e64 v80, v80
buffer_load_dword v12, off, s[32:35], s101 sc1
v_exp_f32_e64 v81, v81
v_cvt_pk_bf16_f32 v64, v64, v65
v_exp_f32_e64 v82, v82
v_cvt_pk_bf16_f32 v65, v66, v67
v_cvt_pk_bf16_f32 v66, v68, v69
v_exp_f32_e64 v83, v83
v_cvt_pk_bf16_f32 v67, v70, v71
v_exp_f32_e64 v84, v84
v_accvgpr_write_b32 a144, v64
v_accvgpr_write_b32 a145, v65
v_exp_f32_e64 v85, v85
v_accvgpr_write_b32 a146, v66
v_exp_f32_e64 v86, v86
v_accvgpr_write_b32 a147, v67
v_cvt_pk_bf16_f32 v68, v72, v73
v_exp_f32_e64 v87, v87
v_cvt_pk_bf16_f32 v69, v74, v75
v_exp_f32_e64 v88, v88
v_cvt_pk_bf16_f32 v70, v76, v77
v_exp_f32_e64 v89, v89
v_cvt_pk_bf16_f32 v71, v78, v79
v_exp_f32_e64 v90, v90
v_accvgpr_write_b32 a148, v68
v_accvgpr_write_b32 a149, v69
v_accvgpr_write_b32 a150, v70
v_accvgpr_write_b32 a151, v71
v_exp_f32_e64 v91, v91
s_mov_b32 s67, 294912
buffer_load_dwordx4 v[32:35], v9, s[32:35], s67 offen offset:0 sc1
buffer_load_dwordx4 v[36:39], v9, s[32:35], s67 offen offset:1024 sc1
buffer_load_dwordx4 v[40:43], v10, s[32:35], s67 offen offset:0 sc1
buffer_load_dwordx4 v[44:47], v10, s[32:35], s67 offen offset:1024 sc1
v_exp_f32_e64 v92, v92
v_add_f32_dpp v16, v16, v16 row_ror:8 row_mask:0xf bank_mask:0x3
v_add_f32_dpp v17, v17, v17 row_ror:8 row_mask:0xf bank_mask:0x3
v_add_f32_dpp v18, v18, v18 row_ror:8 row_mask:0xf bank_mask:0x3
v_add_f32_dpp v19, v19, v19 row_ror:8 row_mask:0xf bank_mask:0x3
v_exp_f32_e64 v93, v93
v_add_f32_dpp v24, v24, v24 row_ror:8 row_mask:0xf bank_mask:0x3
v_add_f32_dpp v25, v25, v25 row_ror:8 row_mask:0xf bank_mask:0x3
v_add_f32_dpp v26, v26, v26 row_ror:8 row_mask:0xf bank_mask:0x3
v_add_f32_dpp v27, v27, v27 row_ror:8 row_mask:0xf bank_mask:0x3
v_exp_f32_e64 v94, v94
v_add_f32_dpp v16, v20, v20 row_ror:8 row_mask:0xf bank_mask:0xc
v_add_f32_dpp v17, v21, v21 row_ror:8 row_mask:0xf bank_mask:0xc
v_add_f32_dpp v18, v22, v22 row_ror:8 row_mask:0xf bank_mask:0xc
v_add_f32_dpp v19, v23, v23 row_ror:8 row_mask:0xf bank_mask:0xc
v_exp_f32_e64 v95, v95
v_add_f32_dpp v24, v28, v28 row_ror:8 row_mask:0xf bank_mask:0xc
v_add_f32_dpp v25, v29, v29 row_ror:8 row_mask:0xf bank_mask:0xc
v_add_f32_dpp v26, v30, v30 row_ror:8 row_mask:0xf bank_mask:0xc
v_add_f32_dpp v27, v31, v31 row_ror:8 row_mask:0xf bank_mask:0xc
v_pk_add_f32 v[80:81], v[80:81], s[70:71]
v_pk_add_f32 v[82:83], v[82:83], s[70:71]
v_pk_add_f32 v[84:85], v[84:85], s[70:71]
v_pk_add_f32 v[86:87], v[86:87], s[70:71]
v_pk_add_f32 v[88:89], v[88:89], s[70:71]
v_pk_add_f32 v[90:91], v[90:91], s[70:71]
v_pk_add_f32 v[92:93], v[92:93], s[70:71]
v_pk_add_f32 v[94:95], v[94:95], s[70:71]
v_rcp_f32_e64 v80, v80
buffer_load_dwordx4 v[64:67], v9, s[32:35], s67 offen offset:2048 sc1
buffer_load_dwordx4 v[68:71], v9, s[32:35], s67 offen offset:3072 sc1
v_rcp_f32_e64 v81, v81
buffer_load_dwordx4 v[72:75], v10, s[32:35], s67 offen offset:2048 sc1
v_rcp_f32_e64 v82, v82
buffer_load_dwordx4 v[76:79], v10, s[32:35], s67 offen offset:3072 sc1
v_add_f32_dpp v16, v16, v16 row_shl:4 row_mask:0xf bank_mask:0x5
v_rcp_f32_e64 v83, v83
v_add_f32_dpp v17, v17, v17 row_shl:4 row_mask:0xf bank_mask:0x5
v_rcp_f32_e64 v84, v84
v_add_f32_dpp v24, v24, v24 row_shl:4 row_mask:0xf bank_mask:0x5
v_add_f32_dpp v25, v25, v25 row_shl:4 row_mask:0xf bank_mask:0x5
v_rcp_f32_e64 v85, v85
v_add_f32_dpp v16, v18, v18 row_shr:4 row_mask:0xf bank_mask:0xa
v_rcp_f32_e64 v86, v86
v_add_f32_dpp v17, v19, v19 row_shr:4 row_mask:0xf bank_mask:0xa
v_add_f32_dpp v24, v26, v26 row_shr:4 row_mask:0xf bank_mask:0xa
v_rcp_f32_e64 v87, v87
v_add_f32_dpp v25, v27, v27 row_shr:4 row_mask:0xf bank_mask:0xa
v_rcp_f32 v88, v88
v_permlane16_swap_b32 v16, v24
v_permlane16_swap_b32 v17, v25
v_rcp_f32 v89, v89
v_add_f32 v16, v16, v24
v_add_f32 v17, v17, v25
v_rcp_f32_e64 v90, v90
v_add_f32_dpp v16, v16, v16 quad_perm:[1,0,3,2] row_mask:0xf bank_mask:0xf
v_add_f32_dpp v17, v17, v17 quad_perm:[1,0,3,2] row_mask:0xf bank_mask:0xf
v_rcp_f32_e64 v91, v91
v_cndmask_b32_e64 v16, v16, v17, s[72:73]
v_rcp_f32 v92, v92
s_nop 0
v_add_f32_dpp v13, v16, v16 quad_perm:[2,3,0,1] row_mask:0xf bank_mask:0xf
v_rcp_f32_e64 v93, v93
v_cndmask_b32_e64 v13, v13, 1.0, s[92:93]
v_rcp_f32_e64 v94, v94
buffer_atomic_add_f32 v13, v15, s[32:35], s66 offen sc1
v_rcp_f32_e64 v95, v95
s_add_u32 s66, s66, 256
s_waitcnt vmcnt(10)
v_readfirstlane_b32 s50, v7
s_nop 0
s_cmp_eq_u32 s50, 223
s_cselect_b32 s61, 1, 0
s_cbranch_scc0 L_nlast
s_mov_b32 s50, 623744
v_mov_b32 v7, 1
s_mov_b64 exec, 65535
buffer_store_dword v7, v2, s[32:35], s50 offen sc1
s_mov_b64 exec, -1
L_nlast:
s_nop 0
v_pk_mul_f32 v[80:81], v[48:49], v[80:81]
v_pk_mul_f32 v[82:83], v[50:51], v[82:83]
v_pk_mul_f32 v[84:85], v[52:53], v[84:85]
v_pk_mul_f32 v[86:87], v[54:55], v[86:87]
v_pk_mul_f32 v[88:89], v[56:57], v[88:89]
v_pk_mul_f32 v[90:91], v[58:59], v[90:91]
v_pk_mul_f32 v[92:93], v[60:61], v[92:93]
v_pk_mul_f32 v[94:95], v[62:63], v[94:95]
v_pk_fma_f32 v[240:241], v[80:81], v[80:81], v[240:241]
v_pk_fma_f32 v[242:243], v[82:83], v[82:83], v[242:243]
v_pk_fma_f32 v[244:245], v[84:85], v[84:85], v[244:245]
v_pk_fma_f32 v[246:247], v[86:87], v[86:87], v[246:247]
v_pk_fma_f32 v[248:249], v[88:89], v[88:89], v[248:249]
v_pk_fma_f32 v[250:251], v[90:91], v[90:91], v[250:251]
v_pk_fma_f32 v[252:253], v[92:93], v[92:93], v[252:253]
v_pk_fma_f32 v[254:255], v[94:95], v[94:95], v[254:255]
v_add_f32_dpp v240, v240, v240 row_ror:8 row_mask:0xf bank_mask:0x3
v_add_f32_dpp v241, v241, v241 row_ror:8 row_mask:0xf bank_mask:0x3
v_add_f32_dpp v242, v242, v242 row_ror:8 row_mask:0xf bank_mask:0x3
v_add_f32_dpp v243, v243, v243 row_ror:8 row_mask:0xf bank_mask:0x3
v_add_f32_dpp v248, v248, v248 row_ror:8 row_mask:0xf bank_mask:0x3
v_add_f32_dpp v249, v249, v249 row_ror:8 row_mask:0xf bank_mask:0x3
v_add_f32_dpp v250, v250, v250 row_ror:8 row_mask:0xf bank_mask:0x3
v_add_f32_dpp v251, v251, v251 row_ror:8 row_mask:0xf bank_mask:0x3
v_add_f32_dpp v240, v244, v244 row_ror:8 row_mask:0xf bank_mask:0xc
v_add_f32_dpp v241, v245, v245 row_ror:8 row_mask:0xf bank_mask:0xc
v_add_f32_dpp v242, v246, v246 row_ror:8 row_mask:0xf bank_mask:0xc
v_add_f32_dpp v243, v247, v247 row_ror:8 row_mask:0xf bank_mask:0xc
v_add_f32_dpp v248, v252, v252 row_ror:8 row_mask:0xf bank_mask:0xc
v_add_f32_dpp v249, v253, v253 row_ror:8 row_mask:0xf bank_mask:0xc
v_add_f32_dpp v250, v254, v254 row_ror:8 row_mask:0xf bank_mask:0xc
v_add_f32_dpp v251, v255, v255 row_ror:8 row_mask:0xf bank_mask:0xc
s_waitcnt vmcnt(9)
v_readfirstlane_b32 s50, v12
s_nop 0
s_or_b32 s61, s61, s50
s_cbranch_scc0 LM_pre_cold
LM_pre:
s_nop 0
v_add_f32_dpp v240, v240, v240 row_shl:4 row_mask:0xf bank_mask:0x5
v_add_f32_dpp v241, v241, v241 row_shl:4 row_mask:0xf bank_mask:0x5
v_add_f32_dpp v248, v248, v248 row_shl:4 row_mask:0xf bank_mask:0x5
v_add_f32_dpp v249, v249, v249 row_shl:4 row_mask:0xf bank_mask:0x5
v_add_f32_dpp v240, v242, v242 row_shr:4 row_mask:0xf bank_mask:0xa
v_add_f32_dpp v241, v243, v243 row_shr:4 row_mask:0xf bank_mask:0xa
v_add_f32_dpp v248, v250, v250 row_shr:4 row_mask:0xf bank_mask:0xa
v_add_f32_dpp v249, v251, v251 row_shr:4 row_mask:0xf bank_mask:0xa
s_nop 0
v_permlane16_swap_b32 v240, v248
v_permlane16_swap_b32 v241, v249
v_add_f32 v240, v240, v248
v_add_f32 v241, v241, v249
s_nop 0
v_add_f32_dpp v240, v240, v240 quad_perm:[1,0,3,2] row_mask:0xf bank_mask:0xf
v_add_f32_dpp v241, v241, v241 quad_perm:[1,0,3,2] row_mask:0xf bank_mask:0xf
v_cndmask_b32_e64 v240, v240, v241, s[72:73]
s_nop 1
s_nop 0
v_add_f32_dpp v13, v240, v240 quad_perm:[2,3,0,1] row_mask:0xf bank_mask:0xf
v_cndmask_b32_e64 v13, v13, 1.0, s[92:93]
buffer_atomic_add_f32 v13, v15, s[32:35], s66 offen sc1
s_mul_i32 s50, s3, 192
ds_write_b128 v6, v[96:99] offset:0
v_lshl_add_u32 v242, v0, 2, 2
v_lshlrev_b32 v243, 1, v0
v_add_u32 v243, 64, v243
v_min_u32 v242, v242, v243
v_add_u32 v242, s50, v242
v_cmp_gt_u32_e64 s[98:99], 64, v0
v_lshl_add_u32 v243, v242, 1, -4
buffer_load_dwordx2 v[240:241], v243, s[44:47], 0 offen
v_accvgpr_write_b32 a136, v192
ds_write_b128 v6, v[100:103] offset:512
v_accvgpr_write_b32 a137, v193
v_accvgpr_write_b32 a138, v194
v_accvgpr_write_b32 a139, v195
v_accvgpr_write_b32 a140, v196
v_accvgpr_write_b32 a141, v197
v_accvgpr_write_b32 a142, v198
v_accvgpr_write_b32 a143, v199
v_and_b32_e64 v246, 48, v0
buffer_load_dwordx4 v[192:195], v246, s[32:35], s63 offen offset:0 sc1
v_lshrrev_b32_e64 v244, 1, v242
ds_write_b128 v6, v[104:107] offset:2048
v_xor_b32 v244, v244, v242
v_and_b32 v244, 4, v244
buffer_load_dwordx4 v[196:199], v246, s[32:35], s63 offen offset:64 sc1
v_mul_u32_u24 v244, 3, v244
v_xor_b32 v242, v242, v244
v_lshlrev_b32_e64 v242, 2, v242
buffer_load_dwordx4 v[248:251], v246, s[32:35], s64 offen offset:0 sc1
v_add_u32 v242, 151552, v242
v_mov_b32 v244, 155648
ds_write_b128 v6, v[108:111] offset:2560
v_add_u32_e64 v245, -8, v242
buffer_load_dwordx4 v[252:255], v246, s[32:35], s64 offen offset:64 sc1
v_cndmask_b32_e64 v242, v244, v242, s[98:99]
v_cndmask_b32_e64 v243, v244, v245, s[96:97]
s_cmp_lg_u32 s61, 0
s_cbranch_scc0 LM_post
s_lshl_b32 s100, s3, 10
s_nop 0
s_add_u32 s100, s100, 590848
buffer_load_dwordx4 v[48:51], v3, s[32:35], s100 offen sc1
s_add_u32 s100, s100, 4096
buffer_load_dwordx4 v[52:55], v3, s[32:35], s100 offen sc1
s_add_u32 s100, s100, 4096
buffer_load_dwordx4 v[56:59], v3, s[32:35], s100 offen sc1
s_add_u32 s100, s100, 4096
buffer_load_dwordx4 v[60:63], v3, s[32:35], s100 offen sc1
LM_post:
v_cvt_pk_bf16_f32 v80, v80, v81
v_cvt_pk_bf16_f32 v81, v82, v83
v_cvt_pk_bf16_f32 v82, v84, v85
v_cvt_pk_bf16_f32 v83, v86, v87
v_cvt_pk_bf16_f32 v84, v88, v89
v_cvt_pk_bf16_f32 v85, v90, v91
ds_write_b128 v6, v[112:115] offset:4096
v_cvt_pk_bf16_f32 v86, v92, v93
v_cvt_pk_bf16_f32 v87, v94, v95
v_accvgpr_write_b32 a184, v80
v_accvgpr_write_b32 a185, v81
v_accvgpr_write_b32 a186, v82
v_accvgpr_write_b32 a187, v83
v_accvgpr_write_b32 a188, v84
v_accvgpr_write_b32 a189, v85
v_accvgpr_write_b32 a190, v86
ds_write_b128 v6, v[116:119] offset:4608
v_accvgpr_write_b32 a191, v87
v_accvgpr_write_b32 a96, v152
v_accvgpr_write_b32 a97, v153
v_accvgpr_write_b32 a98, v154
v_accvgpr_write_b32 a99, v155
v_accvgpr_write_b32 a100, v156
v_accvgpr_write_b32 a101, v157
v_accvgpr_write_b32 a102, v158
v_accvgpr_write_b32 a103, v159
v_accvgpr_write_b32 a104, v160
ds_write_b128 v6, v[120:123] offset:6144
v_accvgpr_write_b32 a105, v161
v_accvgpr_write_b32 a106, v162
v_accvgpr_write_b32 a107, v163
v_accvgpr_write_b32 a108, v164
v_accvgpr_write_b32 a109, v165
v_accvgpr_write_b32 a110, v166
v_accvgpr_write_b32 a111, v167
v_accvgpr_write_b32 a112, v168
v_accvgpr_write_b32 a113, v169
ds_write_b128 v6, v[124:127] offset:6656
v_accvgpr_write_b32 a114, v170
v_accvgpr_write_b32 a115, v171
v_accvgpr_write_b32 a116, v172
v_accvgpr_write_b32 a117, v173
v_accvgpr_write_b32 a118, v174
v_accvgpr_write_b32 a119, v175
v_accvgpr_write_b32 a120, v176
v_accvgpr_write_b32 a121, v177
v_accvgpr_write_b32 a122, v178
v_accvgpr_write_b32 a123, v179
ds_write_b128 v6, v[128:131] offset:8192
v_accvgpr_write_b32 a124, v180
v_accvgpr_write_b32 a125, v181
v_accvgpr_write_b32 a126, v182
v_accvgpr_write_b32 a127, v183
v_accvgpr_write_b32 a128, v184
v_accvgpr_write_b32 a129, v185
v_accvgpr_write_b32 a130, v186
v_accvgpr_write_b32 a131, v187
v_accvgpr_write_b32 a132, v188
ds_write_b128 v6, v[132:135] offset:8704
v_accvgpr_write_b32 a133, v189
v_accvgpr_write_b32 a134, v190
v_accvgpr_write_b32 a135, v191
v_accvgpr_write_b32 a32, v200
v_accvgpr_write_b32 a33, v201
v_accvgpr_write_b32 a34, v202
v_accvgpr_write_b32 a35, v203
v_accvgpr_write_b32 a36, v204
v_accvgpr_write_b32 a37, v205
v_accvgpr_write_b32 a38, v206
ds_write_b128 v6, v[136:139] offset:10240
v_accvgpr_write_b32 a39, v207
v_accvgpr_write_b32 a40, v208
v_accvgpr_write_b32 a41, v209
s_cmp_eq_u32 s61, 0
s_cbranch_scc1 LM_c1_cold
LM_c1_done:
v_accvgpr_write_b32 a42, v210
v_accvgpr_write_b32 a43, v211
v_accvgpr_write_b32 a44, v212
v_accvgpr_write_b32 a45, v213
v_accvgpr_write_b32 a46, v214
v_accvgpr_write_b32 a47, v215
ds_write_b128 v6, v[140:143] offset:10752
v_accvgpr_write_b32 a160, v216
v_accvgpr_write_b32 a161, v217
v_accvgpr_write_b32 a162, v218
v_accvgpr_write_b32 a163, v219
v_accvgpr_write_b32 a164, v220
v_accvgpr_write_b32 a165, v221
v_accvgpr_write_b32 a166, v222
v_accvgpr_write_b32 a167, v223
v_accvgpr_write_b32 a168, v224
v_accvgpr_write_b32 a169, v225
ds_write_b128 v6, v[144:147] offset:12288
v_accvgpr_write_b32 a170, v226
v_accvgpr_write_b32 a171, v227
v_accvgpr_write_b32 a172, v228
v_accvgpr_write_b32 a173, v229
v_accvgpr_write_b32 a174, v230
v_accvgpr_write_b32 a175, v231
v_accvgpr_write_b32 a176, v232
v_accvgpr_write_b32 a177, v233
v_accvgpr_write_b32 a178, v234
ds_write_b128 v6, v[148:151] offset:12800
v_accvgpr_write_b32 a179, v235
v_accvgpr_write_b32 a180, v236
v_accvgpr_write_b32 a181, v237
v_accvgpr_write_b32 a182, v238
v_accvgpr_write_b32 a183, v239
v_add_u32 v4, s65, v1
v_add_u32 v7, s94, v1
v_add_u32 v13, 57344, v4
v_add_u32 v15, 57344, v7
s_waitcnt vmcnt(14)
v_lshlrev_b32 v152, 16, v32
ds_read_b128 a[0:3], v4 offset:0
v_and_b32 v153, s79, v32
v_lshlrev_b32 v154, 16, v33
v_and_b32 v155, s79, v33
v_lshlrev_b32 v156, 16, v34
ds_read_b128 a[4:7], v7 offset:7168
v_and_b32 v157, s79, v34
v_lshlrev_b32 v158, 16, v35
v_and_b32 v159, s79, v35
s_waitcnt vmcnt(13)
v_lshlrev_b32_e64 v160, 16, v36
ds_read_b128 a[8:11], v4 offset:1024
v_and_b32 v161, s79, v36
v_lshlrev_b32 v162, 16, v37
v_and_b32 v163, s79, v37
v_lshlrev_b32 v164, 16, v38
ds_read_b128 a[12:15], v7 offset:8192
v_and_b32 v165, s79, v38
v_lshlrev_b32 v166, 16, v39
v_and_b32 v167, s79, v39
s_waitcnt vmcnt(12)
v_lshlrev_b32_e64 v168, 16, v40
ds_read_b128 a[16:19], v4 offset:2048
v_and_b32 v169, s79, v40
v_lshlrev_b32 v170, 16, v41
v_and_b32 v171, s79, v41
v_lshlrev_b32 v172, 16, v42
ds_read_b128 a[20:23], v7 offset:9216
v_and_b32 v173, s79, v42
v_lshlrev_b32 v174, 16, v43
v_and_b32 v175, s79, v43
s_waitcnt vmcnt(11)
v_lshlrev_b32_e64 v176, 16, v44
ds_read_b128 a[24:27], v4 offset:3072
v_and_b32 v177, s79, v44
v_lshlrev_b32 v178, 16, v45
v_and_b32 v179, s79, v45
v_lshlrev_b32 v180, 16, v46
ds_read_b128 a[28:31], v7 offset:10240
v_and_b32 v181, s79, v46
v_lshlrev_b32 v182, 16, v47
v_and_b32 v183, s79, v47
s_cmp_eq_u32 s61, 0
s_cbranch_scc1 LM_c2_cold
LM_c2_done:
s_waitcnt vmcnt(4)
v_lshlrev_b32_e64 v88, 16, v240
v_and_b32 v89, 0xffff0000, v240
v_lshlrev_b32_e64 v90, 16, v241
v_and_b32 v91, 0xffff0000, v241
s_waitcnt vmcnt(0)
s_nop 0
v_pk_add_f32 v[48:49], v[48:49], v[52:53]
v_pk_add_f32 v[50:51], v[50:51], v[54:55]
v_pk_add_f32 v[56:57], v[56:57], v[60:61]
v_pk_add_f32 v[58:59], v[58:59], v[62:63]
v_pk_add_f32 v[48:49], v[48:49], v[56:57]
v_pk_add_f32 v[50:51], v[50:51], v[58:59]
v_cmp_eq_f32 vcc, 0x43600000, v48
s_nop 0
s_cmp_eq_u32 vcc_hi, -1
s_cbranch_scc0 LM_scold
LM_sok:
s_nop 0
v_mov_b32 v52, 0x358637bd
v_fmamk_f32 v48, v48, 0x4091afa4, v52
v_fmamk_f32 v49, v49, 0x4091afa4, v52
v_fmamk_f32 v50, v50, 0x4091afa4, v52
v_fmamk_f32 v51, v51, 0x4091afa4, v52
v_sqrt_f32 v48, v48
v_sqrt_f32 v49, v49
v_sqrt_f32 v50, v50
v_sqrt_f32_e64 v51, v51
s_lshl_b32 s100, s3, 2
s_add_u32 s100, s100, 154624
v_add_f32 v52, v48, v49
v_add_f32 v53, v50, v51
v_cndmask_b32_e64 v52, 0, v52, s[96:97]
v_cndmask_b32_e64 v53, 0, v53, s[98:99]
v_add_f32 v52, v52, v53
v_mul_f32 v48, v48, v88
v_mul_f32_e64 v49, v49, v89
v_add_f32_dpp v52, v52, v52 row_ror:8 row_mask:0xf bank_mask:0xf
v_mul_f32 v50, v50, v90
v_mul_f32 v51, v51, v91
v_add_f32_dpp v52, v52, v52 row_ror:4 row_mask:0xf bank_mask:0xf
ds_write_b64 v243, v[48:49]
ds_write_b64 v242, v[50:51]
v_add_f32_dpp v52, v52, v52 row_ror:2 row_mask:0xf bank_mask:0xf
v_mov_b32_e64 v54, s100
v_mov_b32 v55, 154624
v_add_f32_dpp v52, v52, v52 row_ror:1 row_mask:0xf bank_mask:0xf
v_mov_b32 v53, v52
s_nop 1
v_permlane32_swap_b32 v52, v53
v_add_f32 v52, v52, v53
v_mov_b32 v53, v52
s_nop 1
v_permlane16_swap_b32 v52, v53
v_add_f32 v52, v52, v53
ds_write_b32 v54, v52
v_mov_b32 v52, 0x34fb9d56
v_mov_b32 v53, 0x40088e99
s_waitcnt lgkmcnt(0)
s_barrier
ds_read_b128 v[88:91], v55
ds_read_b128 v[80:83], v8 offset:0
ds_read_b128 v[84:87], v8 offset:16
ds_read_b128 v[56:59], v8 offset:768
ds_read_b128 v[60:63], v8 offset:784
s_waitcnt lgkmcnt(4)
v_add_f32 v88, v88, v89
v_add_f32 v90, v90, v91
v_add_f32 v88, v88, v90
v_fmac_f32 v52, 0x3a1ff8e5, v88
v_rcp_f32 v52, v52
s_nop 0
v_pk_fma_f32 v[48:49], v[48:49], v[52:53], v[52:53] op_sel:[0,0,1] op_sel_hi:[1,0,1]
v_pk_fma_f32 v[50:51], v[50:51], v[52:53], v[52:53] op_sel:[0,0,1] op_sel_hi:[1,0,1]
ds_write_b64 v243, v[48:49] offset:5120
ds_write_b64 v242, v[50:51] offset:5120
s_waitcnt lgkmcnt(5)
v_pk_fma_f32 v[80:81], v[80:81], v[52:53], v[52:53] op_sel:[0,0,1] op_sel_hi:[1,0,1]
v_pk_fma_f32 v[82:83], v[82:83], v[52:53], v[52:53] op_sel:[0,0,1] op_sel_hi:[1,0,1]
s_waitcnt lgkmcnt(4)
v_pk_fma_f32 v[84:85], v[84:85], v[52:53], v[52:53] op_sel:[0,0,1] op_sel_hi:[1,0,1]
v_pk_fma_f32 v[86:87], v[86:87], v[52:53], v[52:53] op_sel:[0,0,1] op_sel_hi:[1,0,1]
v_pk_mul_f32 v[152:153], v[152:153], v[80:81]
v_pk_mul_f32 v[154:155], v[154:155], v[82:83]
v_pk_mul_f32 v[156:157], v[156:157], v[84:85]
v_pk_mul_f32 v[158:159], v[158:159], v[86:87]
v_pk_mul_f32 v[160:161], v[160:161], v[80:81]
v_pk_mul_f32 v[162:163], v[162:163], v[82:83]
v_pk_mul_f32 v[164:165], v[164:165], v[84:85]
v_pk_mul_f32 v[166:167], v[166:167], v[86:87]
v_pk_mul_f32 v[168:169], v[168:169], v[80:81]
v_pk_mul_f32 v[170:171], v[170:171], v[82:83]
v_pk_mul_f32 v[172:173], v[172:173], v[84:85]
v_pk_mul_f32 v[174:175], v[174:175], v[86:87]
v_pk_mul_f32 v[176:177], v[176:177], v[80:81]
v_pk_mul_f32 v[178:179], v[178:179], v[82:83]
v_pk_mul_f32 v[180:181], v[180:181], v[84:85]
v_pk_mul_f32 v[182:183], v[182:183], v[86:87]
s_waitcnt lgkmcnt(3)
v_pk_fma_f32 v[56:57], v[56:57], v[52:53], v[52:53] op_sel:[0,0,1] op_sel_hi:[1,0,1]
v_pk_fma_f32 v[58:59], v[58:59], v[52:53], v[52:53] op_sel:[0,0,1] op_sel_hi:[1,0,1]
s_waitcnt lgkmcnt(2)
v_pk_fma_f32 v[60:61], v[60:61], v[52:53], v[52:53] op_sel:[0,0,1] op_sel_hi:[1,0,1]
v_pk_fma_f32 v[62:63], v[62:63], v[52:53], v[52:53] op_sel:[0,0,1] op_sel_hi:[1,0,1]
v_cvt_pk_bf16_f32 v32, v152, v153
v_cvt_pk_bf16_f32 v33, v154, v155
v_cvt_pk_bf16_f32 v34, v156, v157
v_cvt_pk_bf16_f32 v35, v158, v159
v_cvt_pk_bf16_f32 v36, v160, v161
v_cvt_pk_bf16_f32 v37, v162, v163
v_cvt_pk_bf16_f32 v38, v164, v165
v_cvt_pk_bf16_f32 v39, v166, v167
v_cvt_pk_bf16_f32 v40, v168, v169
v_cvt_pk_bf16_f32 v41, v170, v171
v_cvt_pk_bf16_f32 v42, v172, v173
v_cvt_pk_bf16_f32 v43, v174, v175
v_cvt_pk_bf16_f32 v44, v176, v177
v_cvt_pk_bf16_f32 v45, v178, v179
v_cvt_pk_bf16_f32 v46, v180, v181
v_cvt_pk_bf16_f32 v47, v182, v183
s_waitcnt lgkmcnt(0)
s_barrier
v_mfma_f32_16x16x32_bf16 v[88:91], v[32:35], a[0:3], v[192:195]
v_lshlrev_b32 v48, 16, v64
v_lshlrev_b32 v49, 16, v65
v_lshlrev_b32_e64 v50, 16, v66
v_mfma_f32_16x16x32_bf16 v[92:95], v[36:39], a[0:3], v[196:199]
s_mov_b32 s67, 299008
buffer_load_dwordx4 v[16:19], v9, s[32:35], s67 offen offset:0 sc1
v_mfma_f32_16x16x32_bf16 v[200:203], v[40:43], a[0:3], v[248:251]
ds_read_b128 v[80:83], v8 offset:6656
v_lshlrev_b32 v51, 16, v67
v_and_b32 v64, s79, v64
v_mfma_f32_16x16x32_bf16 v[204:207], v[44:47], a[0:3], v[252:255]
ds_read_b128 a[0:3], v4 offset:4096
v_and_b32_e64 v65, s79, v65
v_mfma_f32_16x16x32_bf16 v[144:147], v[32:35], a[4:7], v[192:195]
buffer_load_dwordx4 v[20:23], v9, s[32:35], s67 offen offset:1024 sc1
v_and_b32_e64 v66, s79, v66
v_mfma_f32_16x16x32_bf16 v[148:151], v[36:39], a[4:7], v[196:199]
ds_read_b128 a[4:7], v7 offset:11264
v_and_b32 v67, s79, v67
v_mul_f32 v48, v56, v48
v_mfma_f32_16x16x32_bf16 v[96:99], v[32:35], a[8:11], v[192:195]
v_mul_f32 v64, v57, v64
v_mul_f32 v49, v58, v49
v_mfma_f32_16x16x32_bf16 v[100:103], v[36:39], a[8:11], v[196:199]
buffer_load_dwordx4 v[24:27], v10, s[32:35], s67 offen offset:0 sc1
v_mul_f32_e64 v65, v59, v65
v_mfma_f32_16x16x32_bf16 v[208:211], v[40:43], a[8:11], v[248:251]
ds_read_b128 v[84:87], v8 offset:6672
v_mul_f32_e64 v50, v60, v50
v_mfma_f32_16x16x32_bf16 v[212:215], v[44:47], a[8:11], v[252:255]
ds_read_b128 a[8:11], v4 offset:5120
v_mul_f32_e64 v66, v61, v66
v_mfma_f32_16x16x32_bf16 v[152:155], v[32:35], a[12:15], v[192:195]
buffer_load_dwordx4 v[28:31], v10, s[32:35], s67 offen offset:1024 sc1
v_mul_f32_e64 v51, v62, v51
v_mfma_f32_16x16x32_bf16 v[156:159], v[36:39], a[12:15], v[196:199]
ds_read_b128 a[12:15], v7 offset:12288
v_mul_f32_e64 v67, v63, v67
v_mfma_f32_16x16x32_bf16 v[104:107], v[32:35], a[16:19], v[192:195]
v_cvt_pk_bf16_f32 v64, v48, v64
v_cvt_pk_bf16_f32 v65, v49, v65
v_cvt_pk_bf16_f32 v66, v50, v66
v_mfma_f32_16x16x32_bf16 v[108:111], v[36:39], a[16:19], v[196:199]
v_cvt_pk_bf16_f32 v67, v51, v67
v_lshlrev_b32_e64 v52, 16, v68
v_mfma_f32_16x16x32_bf16 v[216:219], v[40:43], a[16:19], v[248:251]
v_lshlrev_b32 v53, 16, v69
v_lshlrev_b32 v54, 16, v70
v_lshlrev_b32_e64 v55, 16, v71
v_mfma_f32_16x16x32_bf16 v[220:223], v[44:47], a[16:19], v[252:255]
ds_read_b128 a[16:19], v4 offset:6144
v_and_b32 v68, s79, v68
v_and_b32 v69, s79, v69
v_mfma_f32_16x16x32_bf16 v[160:163], v[32:35], a[20:23], v[192:195]
v_and_b32 v70, s79, v70
v_and_b32 v71, s79, v71
v_mfma_f32_16x16x32_bf16 v[164:167], v[36:39], a[20:23], v[196:199]
ds_read_b128 a[20:23], v7 offset:13312
v_mul_f32 v52, v56, v52
s_waitcnt lgkmcnt(6)
v_mfma_f32_16x16x32_bf16 v[112:115], v[32:35], a[24:27], v[192:195]
v_mul_f32 v68, v57, v68
v_mul_f32 v53, v58, v53
v_mfma_f32_16x16x32_bf16 v[116:119], v[36:39], a[24:27], v[196:199]
v_mul_f32 v69, v59, v69
v_mul_f32 v54, v60, v54
v_mul_f32_e64 v70, v61, v70
v_mfma_f32_16x16x32_bf16 v[224:227], v[40:43], a[24:27], v[248:251]
v_mul_f32 v55, v62, v55
v_mul_f32 v71, v63, v71
v_mfma_f32_16x16x32_bf16 v[228:231], v[44:47], a[24:27], v[252:255]
ds_read_b128 a[24:27], v4 offset:14336
v_cvt_pk_bf16_f32 v68, v52, v68
v_cvt_pk_bf16_f32 v69, v53, v69
v_mfma_f32_16x16x32_bf16 v[168:171], v[32:35], a[28:31], v[192:195]
v_cvt_pk_bf16_f32 v70, v54, v70
v_cvt_pk_bf16_f32 v71, v55, v71
v_mfma_f32_16x16x32_bf16 v[172:175], v[36:39], a[28:31], v[196:199]
ds_read_b128 a[28:31], v7 offset:21504
v_lshlrev_b32_e64 v48, 16, v72
v_mfma_f32_16x16x32_bf16 v[120:123], v[32:35], a[0:3], v[192:195]
v_lshlrev_b32 v49, 16, v73
v_lshlrev_b32 v50, 16, v74
v_lshlrev_b32_e64 v51, 16, v75
v_mfma_f32_16x16x32_bf16 v[124:127], v[36:39], a[0:3], v[196:199]
v_and_b32 v72, s79, v72
v_and_b32 v73, s79, v73
v_mfma_f32_16x16x32_bf16 v[232:235], v[40:43], a[0:3], v[248:251]
v_and_b32 v74, s79, v74
v_and_b32 v75, s79, v75
v_mul_f32_e64 v48, v56, v48
v_mfma_f32_16x16x32_bf16 v[236:239], v[44:47], a[0:3], v[252:255]
ds_read_b128 a[0:3], v4 offset:15360
v_mul_f32 v72, v57, v72
s_waitcnt lgkmcnt(5)
v_mfma_f32_16x16x32_bf16 v[176:179], v[32:35], a[4:7], v[192:195]
v_mul_f32 v49, v58, v49
v_mul_f32 v73, v59, v73
v_mfma_f32_16x16x32_bf16 v[180:183], v[36:39], a[4:7], v[196:199]
ds_read_b128 a[4:7], v7 offset:22528
v_mul_f32 v50, v60, v50
v_mul_f32 v74, v61, v74
v_mfma_f32_16x16x32_bf16 v[128:131], v[32:35], a[8:11], v[192:195]
v_mul_f32 v51, v62, v51
v_mul_f32 v75, v63, v75
v_mfma_f32_16x16x32_bf16 v[132:135], v[36:39], a[8:11], v[196:199]
v_cvt_pk_bf16_f32 v72, v48, v72
v_cvt_pk_bf16_f32 v73, v49, v73
v_cvt_pk_bf16_f32 v74, v50, v74
v_mfma_f32_16x16x32_bf16 v[240:243], v[40:43], a[8:11], v[248:251]
v_cvt_pk_bf16_f32 v75, v51, v75
v_lshlrev_b32 v52, 16, v76
v_lshlrev_b32 v53, 16, v77
v_mfma_f32_16x16x32_bf16 v[244:247], v[44:47], a[8:11], v[252:255]
ds_read_b128 a[8:11], v4 offset:16384
v_lshlrev_b32_e64 v54, 16, v78
v_mfma_f32_16x16x32_bf16 v[184:187], v[32:35], a[12:15], v[192:195]
v_lshlrev_b32 v55, 16, v79
v_and_b32 v76, s79, v76
v_and_b32_e64 v77, s79, v77
v_mfma_f32_16x16x32_bf16 v[188:191], v[36:39], a[12:15], v[196:199]
ds_read_b128 a[12:15], v7 offset:23552
s_waitcnt lgkmcnt(5)
v_mfma_f32_16x16x32_bf16 v[136:139], v[32:35], a[16:19], v[192:195]
v_and_b32 v78, s79, v78
v_and_b32 v79, s79, v79
v_mul_f32 v52, v56, v52
v_mfma_f32_16x16x32_bf16 v[140:143], v[36:39], a[16:19], v[196:199]
v_mul_f32 v76, v57, v76
v_mul_f32 v53, v58, v53
v_mul_f32_e64 v77, v59, v77
v_mfma_f32_16x16x32_bf16 v[248:251], v[40:43], a[16:19], v[248:251]
v_mul_f32 v54, v60, v54
v_mul_f32 v78, v61, v78
v_mfma_f32_16x16x32_bf16 v[252:255], v[44:47], a[16:19], v[252:255]
ds_read_b128 a[16:19], v4 offset:17408
v_mul_f32 v55, v62, v55
v_mul_f32 v79, v63, v79
v_mfma_f32_16x16x32_bf16 v[192:195], v[32:35], a[20:23], v[192:195]
v_cvt_pk_bf16_f32 v76, v52, v76
v_cvt_pk_bf16_f32 v77, v53, v77
v_mfma_f32_16x16x32_bf16 v[196:199], v[36:39], a[20:23], v[196:199]
ds_read_b128 a[20:23], v7 offset:24576
v_cvt_pk_bf16_f32 v78, v54, v78
v_cvt_pk_bf16_f32 v79, v55, v79
s_waitcnt vmcnt(2)
v_mfma_f32_16x16x32_bf16 v[88:91], v[64:67], a[24:27], v[88:91]
v_lshlrev_b32 v48, 16, v16
v_lshlrev_b32 v49, 16, v17
v_lshlrev_b32 v50, 16, v18
v_mfma_f32_16x16x32_bf16 v[92:95], v[68:71], a[24:27], v[92:95]
buffer_load_dwordx4 v[32:35], v9, s[32:35], s67 offen offset:2048 sc1
v_mfma_f32_16x16x32_bf16 v[200:203], v[72:75], a[24:27], v[200:203]
ds_read_b128 v[56:59], v8 offset:7424
v_lshlrev_b32 v51, 16, v19
v_and_b32 v16, s79, v16
v_mfma_f32_16x16x32_bf16 v[204:207], v[76:79], a[24:27], v[204:207]
ds_read_b128 a[24:27], v4 offset:18432
s_waitcnt lgkmcnt(6)
v_mfma_f32_16x16x32_bf16 v[144:147], v[64:67], a[28:31], v[144:147]
buffer_load_dwordx4 v[36:39], v9, s[32:35], s67 offen offset:3072 sc1
v_and_b32 v17, s79, v17
v_mfma_f32_16x16x32_bf16 v[148:151], v[68:71], a[28:31], v[148:151]
ds_read_b128 a[28:31], v7 offset:25600
v_and_b32 v18, s79, v18
v_and_b32 v19, s79, v19
v_mfma_f32_16x16x32_bf16 v[96:99], v[64:67], a[0:3], v[96:99]
v_mul_f32 v48, v80, v48
v_mul_f32 v16, v81, v16
v_mfma_f32_16x16x32_bf16 v[100:103], v[68:71], a[0:3], v[100:103]
buffer_load_dwordx4 v[40:43], v10, s[32:35], s67 offen offset:2048 sc1
v_mul_f32_e64 v49, v82, v49
v_mfma_f32_16x16x32_bf16 v[208:211], v[72:75], a[0:3], v[208:211]
ds_read_b128 v[60:63], v8 offset:7440
v_mul_f32 v17, v83, v17
v_mul_f32 v50, v84, v50
v_mfma_f32_16x16x32_bf16 v[212:215], v[76:79], a[0:3], v[212:215]
ds_read_b128 a[0:3], v4 offset:19456
v_mul_f32_e64 v18, v85, v18
v_mfma_f32_16x16x32_bf16 v[152:155], v[64:67], a[4:7], v[152:155]
buffer_load_dwordx4 v[44:47], v10, s[32:35], s67 offen offset:3072 sc1
v_mul_f32_e64 v51, v86, v51
v_mfma_f32_16x16x32_bf16 v[156:159], v[68:71], a[4:7], v[156:159]
ds_read_b128 a[4:7], v7 offset:26624
s_waitcnt lgkmcnt(7)
v_mfma_f32_16x16x32_bf16 v[104:107], v[64:67], a[8:11], v[104:107]
v_mul_f32 v19, v87, v19
v_cvt_pk_bf16_f32 v16, v48, v16
v_cvt_pk_bf16_f32 v17, v49, v17
v_mfma_f32_16x16x32_bf16 v[108:111], v[68:71], a[8:11], v[108:111]
v_cvt_pk_bf16_f32 v18, v50, v18
v_cvt_pk_bf16_f32 v19, v51, v19
v_lshlrev_b32_e64 v52, 16, v20
v_mfma_f32_16x16x32_bf16 v[216:219], v[72:75], a[8:11], v[216:219]
v_lshlrev_b32 v53, 16, v21
v_lshlrev_b32 v54, 16, v22
v_mfma_f32_16x16x32_bf16 v[220:223], v[76:79], a[8:11], v[220:223]
ds_read_b128 a[8:11], v4 offset:20480
v_lshlrev_b32 v55, 16, v23
v_and_b32 v20, s79, v20
v_mfma_f32_16x16x32_bf16 v[160:163], v[64:67], a[12:15], v[160:163]
v_and_b32 v21, s79, v21
v_and_b32 v22, s79, v22
v_and_b32_e64 v23, s79, v23
v_mfma_f32_16x16x32_bf16 v[164:167], v[68:71], a[12:15], v[164:167]
ds_read_b128 a[12:15], v7 offset:27648
v_mul_f32_e64 v52, v80, v52
v_mfma_f32_16x16x32_bf16 v[112:115], v[64:67], a[16:19], v[112:115]
v_mul_f32 v20, v81, v20
v_mul_f32 v53, v82, v53
v_mul_f32_e64 v21, v83, v21
v_mfma_f32_16x16x32_bf16 v[116:119], v[68:71], a[16:19], v[116:119]
v_mul_f32 v54, v84, v54
v_mul_f32 v22, v85, v22
v_mfma_f32_16x16x32_bf16 v[224:227], v[72:75], a[16:19], v[224:227]
v_mul_f32 v55, v86, v55
v_mul_f32 v23, v87, v23
v_cvt_pk_bf16_f32 v20, v52, v20
v_mfma_f32_16x16x32_bf16 v[228:231], v[76:79], a[16:19], v[228:231]
ds_read_b128 a[16:19], v4 offset:28672
v_cvt_pk_bf16_f32 v21, v53, v21
s_waitcnt lgkmcnt(6)
s_nop 0
v_mfma_f32_16x16x32_bf16 v[168:171], v[64:67], a[20:23], v[168:171]
v_cvt_pk_bf16_f32 v22, v54, v22
v_cvt_pk_bf16_f32 v23, v55, v23
v_mfma_f32_16x16x32_bf16 v[172:175], v[68:71], a[20:23], v[172:175]
ds_read_b128 a[20:23], v7 offset:35840
s_waitcnt vmcnt(4)
v_lshlrev_b32 v48, 16, v24
v_mfma_f32_16x16x32_bf16 v[120:123], v[64:67], a[24:27], v[120:123]
v_lshlrev_b32 v49, 16, v25
v_lshlrev_b32 v50, 16, v26
v_mfma_f32_16x16x32_bf16 v[124:127], v[68:71], a[24:27], v[124:127]
v_lshlrev_b32 v51, 16, v27
v_and_b32 v24, s79, v24
v_and_b32_e64 v25, s79, v25
v_mfma_f32_16x16x32_bf16 v[232:235], v[72:75], a[24:27], v[232:235]
v_and_b32 v26, s79, v26
v_and_b32 v27, s79, v27
v_mul_f32_e64 v48, v80, v48
v_mfma_f32_16x16x32_bf16 v[236:239], v[76:79], a[24:27], v[236:239]
ds_read_b128 a[24:27], v4 offset:29696
v_mul_f32_e64 v24, v81, v24
v_mfma_f32_16x16x32_bf16 v[176:179], v[64:67], a[28:31], v[176:179]
v_mul_f32 v49, v82, v49
v_mul_f32 v25, v83, v25
v_mul_f32_e64 v50, v84, v50
v_mfma_f32_16x16x32_bf16 v[180:183], v[68:71], a[28:31], v[180:183]
ds_read_b128 a[28:31], v7 offset:36864
v_mul_f32 v26, v85, v26
s_waitcnt lgkmcnt(5)
v_mfma_f32_16x16x32_bf16 v[128:131], v[64:67], a[0:3], v[128:131]
v_mul_f32 v51, v86, v51
v_mul_f32 v27, v87, v27
v_mfma_f32_16x16x32_bf16 v[132:135], v[68:71], a[0:3], v[132:135]
v_cvt_pk_bf16_f32 v24, v48, v24
v_cvt_pk_bf16_f32 v25, v49, v25
v_cvt_pk_bf16_f32 v26, v50, v26
v_mfma_f32_16x16x32_bf16 v[240:243], v[72:75], a[0:3], v[240:243]
v_cvt_pk_bf16_f32 v27, v51, v27
v_lshlrev_b32_e64 v52, 16, v28
v_mfma_f32_16x16x32_bf16 v[244:247], v[76:79], a[0:3], v[244:247]
ds_read_b128 a[0:3], v4 offset:30720
v_lshlrev_b32 v53, 16, v29
v_lshlrev_b32 v54, 16, v30
v_mfma_f32_16x16x32_bf16 v[184:187], v[64:67], a[4:7], v[184:187]
v_lshlrev_b32 v55, 16, v31
v_and_b32 v28, s79, v28
v_and_b32_e64 v29, s79, v29
v_mfma_f32_16x16x32_bf16 v[188:191], v[68:71], a[4:7], v[188:191]
ds_read_b128 a[4:7], v7 offset:37888
v_and_b32_e64 v30, s79, v30
v_mfma_f32_16x16x32_bf16 v[136:139], v[64:67], a[8:11], v[136:139]
v_and_b32 v31, s79, v31
v_mul_f32 v52, v80, v52
v_mul_f32_e64 v28, v81, v28
v_mfma_f32_16x16x32_bf16 v[140:143], v[68:71], a[8:11], v[140:143]
v_mul_f32 v53, v82, v53
v_mul_f32 v29, v83, v29
v_mul_f32_e64 v54, v84, v54
v_mfma_f32_16x16x32_bf16 v[248:251], v[72:75], a[8:11], v[248:251]
v_mul_f32 v30, v85, v30
v_mul_f32 v55, v86, v55
v_mfma_f32_16x16x32_bf16 v[252:255], v[76:79], a[8:11], v[252:255]
ds_read_b128 a[8:11], v4 offset:31744
v_mul_f32 v31, v87, v31
s_waitcnt lgkmcnt(5)
v_mfma_f32_16x16x32_bf16 v[192:195], v[64:67], a[12:15], v[192:195]
v_cvt_pk_bf16_f32 v28, v52, v28
v_cvt_pk_bf16_f32 v29, v53, v29
v_mfma_f32_16x16x32_bf16 v[196:199], v[68:71], a[12:15], v[196:199]
ds_read_b128 a[12:15], v7 offset:38912
v_cvt_pk_bf16_f32 v30, v54, v30
v_cvt_pk_bf16_f32 v31, v55, v31
s_waitcnt vmcnt(2)
v_mfma_f32_16x16x32_bf16 v[88:91], v[16:19], a[16:19], v[88:91]
v_lshlrev_b32 v48, 16, v32
v_lshlrev_b32 v49, 16, v33
v_lshlrev_b32 v50, 16, v34
v_mfma_f32_16x16x32_bf16 v[92:95], v[20:23], a[16:19], v[92:95]
v_lshlrev_b32 v51, 16, v35
v_and_b32 v32, s79, v32
v_mfma_f32_16x16x32_bf16 v[200:203], v[24:27], a[16:19], v[200:203]
v_and_b32 v33, s79, v33
v_and_b32 v34, s79, v34
v_and_b32_e64 v35, s79, v35
v_mfma_f32_16x16x32_bf16 v[204:207], v[28:31], a[16:19], v[204:207]
ds_read_b128 a[16:19], v4 offset:32768
v_mul_f32_e64 v48, v56, v48
v_mfma_f32_16x16x32_bf16 v[144:147], v[16:19], a[20:23], v[144:147]
s_mov_b32 s67, 663552
buffer_load_dwordx4 v[64:67], v9, s[32:35], s67 offen offset:0 sc1
v_mul_f32_e64 v32, v57, v32
v_mfma_f32_16x16x32_bf16 v[148:151], v[20:23], a[20:23], v[148:151]
ds_read_b128 a[20:23], v7 offset:39936
s_waitcnt lgkmcnt(5)
v_mfma_f32_16x16x32_bf16 v[96:99], v[16:19], a[24:27], v[96:99]
v_mul_f32 v49, v58, v49
v_mul_f32 v33, v59, v33
v_mul_f32 v50, v60, v50
v_mfma_f32_16x16x32_bf16 v[100:103], v[20:23], a[24:27], v[100:103]
v_mul_f32 v34, v61, v34
v_mul_f32 v51, v62, v51
v_mul_f32_e64 v35, v63, v35
v_mfma_f32_16x16x32_bf16 v[208:211], v[24:27], a[24:27], v[208:211]
v_cvt_pk_bf16_f32 v32, v48, v32
v_cvt_pk_bf16_f32 v33, v49, v33
v_mfma_f32_16x16x32_bf16 v[212:215], v[28:31], a[24:27], v[212:215]
ds_read_b128 a[24:27], v4 offset:33792
v_cvt_pk_bf16_f32 v34, v50, v34
v_cvt_pk_bf16_f32 v35, v51, v35
v_mfma_f32_16x16x32_bf16 v[152:155], v[16:19], a[28:31], v[152:155]
v_lshlrev_b32 v52, 16, v36
v_lshlrev_b32 v53, 16, v37
v_mfma_f32_16x16x32_bf16 v[156:159], v[20:23], a[28:31], v[156:159]
ds_read_b128 a[28:31], v7 offset:40960
v_lshlrev_b32 v54, 16, v38
v_lshlrev_b32 v55, 16, v39
v_mfma_f32_16x16x32_bf16 v[104:107], v[16:19], a[0:3], v[104:107]
v_and_b32 v36, s79, v36
v_and_b32 v37, s79, v37
v_mfma_f32_16x16x32_bf16 v[108:111], v[20:23], a[0:3], v[108:111]
v_and_b32 v38, s79, v38
v_and_b32 v39, s79, v39
v_mul_f32_e64 v52, v56, v52
v_mfma_f32_16x16x32_bf16 v[216:219], v[24:27], a[0:3], v[216:219]
buffer_load_dwordx4 v[68:71], v9, s[32:35], s67 offen offset:1024 sc1
v_mul_f32_e64 v36, v57, v36
v_mfma_f32_16x16x32_bf16 v[220:223], v[28:31], a[0:3], v[220:223]
ds_read_b128 a[0:3], v4 offset:34816
s_waitcnt lgkmcnt(5)
v_mfma_f32_16x16x32_bf16 v[160:163], v[16:19], a[4:7], v[160:163]
v_mul_f32 v53, v58, v53
v_mul_f32 v37, v59, v37
v_mul_f32 v54, v60, v54
v_mfma_f32_16x16x32_bf16 v[164:167], v[20:23], a[4:7], v[164:167]
ds_read_b128 a[4:7], v7 offset:41984
v_mul_f32_e64 v38, v61, v38
v_mfma_f32_16x16x32_bf16 v[112:115], v[16:19], a[8:11], v[112:115]
v_mul_f32 v55, v62, v55
v_mul_f32 v39, v63, v39
v_cvt_pk_bf16_f32 v36, v52, v36
v_mfma_f32_16x16x32_bf16 v[116:119], v[20:23], a[8:11], v[116:119]
v_cvt_pk_bf16_f32 v37, v53, v37
v_cvt_pk_bf16_f32 v38, v54, v38
v_mfma_f32_16x16x32_bf16 v[224:227], v[24:27], a[8:11], v[224:227]
v_cvt_pk_bf16_f32 v39, v55, v39
s_waitcnt vmcnt(2)
v_lshlrev_b32 v48, 16, v40
v_mfma_f32_16x16x32_bf16 v[228:231], v[28:31], a[8:11], v[228:231]
ds_read_b128 a[8:11], v4 offset:43008
v_lshlrev_b32 v49, 16, v41
v_lshlrev_b32 v50, 16, v42
v_mfma_f32_16x16x32_bf16 v[168:171], v[16:19], a[12:15], v[168:171]
v_lshlrev_b32 v51, 16, v43
v_and_b32 v40, s79, v40
v_mfma_f32_16x16x32_bf16 v[172:175], v[20:23], a[12:15], v[172:175]
ds_read_b128 a[12:15], v7 offset:50176
v_and_b32 v41, s79, v41
s_waitcnt lgkmcnt(5)
v_mfma_f32_16x16x32_bf16 v[120:123], v[16:19], a[16:19], v[120:123]
v_and_b32 v42, s79, v42
v_and_b32 v43, s79, v43
v_mfma_f32_16x16x32_bf16 v[124:127], v[20:23], a[16:19], v[124:127]
v_mul_f32 v48, v56, v48
v_mul_f32 v40, v57, v40
v_mul_f32_e64 v49, v58, v49
v_mfma_f32_16x16x32_bf16 v[232:235], v[24:27], a[16:19], v[232:235]
buffer_load_dwordx4 v[72:75], v10, s[32:35], s67 offen offset:0 sc1
v_mfma_f32_16x16x32_bf16 v[236:239], v[28:31], a[16:19], v[236:239]
ds_read_b128 a[16:19], v4 offset:44032
v_mul_f32 v41, v59, v41
v_mul_f32 v50, v60, v50
v_mfma_f32_16x16x32_bf16 v[176:179], v[16:19], a[20:23], v[176:179]
v_mul_f32 v42, v61, v42
v_mul_f32 v51, v62, v51
v_mul_f32_e64 v43, v63, v43
v_mfma_f32_16x16x32_bf16 v[180:183], v[20:23], a[20:23], v[180:183]
ds_read_b128 a[20:23], v7 offset:51200
v_cvt_pk_bf16_f32 v40, v48, v40
v_mfma_f32_16x16x32_bf16 v[128:131], v[16:19], a[24:27], v[128:131]
v_cvt_pk_bf16_f32 v41, v49, v41
v_cvt_pk_bf16_f32 v42, v50, v42
v_cvt_pk_bf16_f32 v43, v51, v43
v_mfma_f32_16x16x32_bf16 v[132:135], v[20:23], a[24:27], v[132:135]
v_lshlrev_b32 v52, 16, v44
v_lshlrev_b32 v53, 16, v45
v_mfma_f32_16x16x32_bf16 v[240:243], v[24:27], a[24:27], v[240:243]
v_lshlrev_b32 v54, 16, v46
v_lshlrev_b32 v55, 16, v47
v_and_b32_e64 v44, s79, v44
v_mfma_f32_16x16x32_bf16 v[244:247], v[28:31], a[24:27], v[244:247]
ds_read_b128 a[24:27], v4 offset:45056
s_waitcnt lgkmcnt(5)
v_mfma_f32_16x16x32_bf16 v[184:187], v[16:19], a[28:31], v[184:187]
v_and_b32 v45, s79, v45
v_and_b32 v46, s79, v46
v_and_b32 v47, s79, v47
v_mfma_f32_16x16x32_bf16 v[188:191], v[20:23], a[28:31], v[188:191]
ds_read_b128 a[28:31], v7 offset:52224
v_mul_f32 v52, v56, v52
v_mul_f32 v44, v57, v44
v_mfma_f32_16x16x32_bf16 v[136:139], v[16:19], a[0:3], v[136:139]
buffer_load_dwordx4 v[76:79], v10, s[32:35], s67 offen offset:1024 sc1
v_mfma_f32_16x16x32_bf16 v[140:143], v[20:23], a[0:3], v[140:143]
v_mul_f32 v53, v58, v53
v_mul_f32 v45, v59, v45
v_mul_f32_e64 v54, v60, v54
v_mfma_f32_16x16x32_bf16 v[248:251], v[24:27], a[0:3], v[248:251]
v_mul_f32 v46, v61, v46
v_mul_f32 v55, v62, v55
v_mfma_f32_16x16x32_bf16 v[252:255], v[28:31], a[0:3], v[252:255]
ds_read_b128 a[0:3], v4 offset:46080
v_mul_f32_e64 v47, v63, v47
v_cvt_pk_bf16_f32 v44, v52, v44
v_mfma_f32_16x16x32_bf16 v[192:195], v[16:19], a[4:7], v[192:195]
v_cvt_pk_bf16_f32 v45, v53, v45
v_cvt_pk_bf16_f32 v46, v54, v46
v_mfma_f32_16x16x32_bf16 v[196:199], v[20:23], a[4:7], v[196:199]
ds_read_b128 a[4:7], v7 offset:53248
v_cvt_pk_bf16_f32 v47, v55, v47
s_waitcnt lgkmcnt(5)
v_mfma_f32_16x16x32_bf16 v[88:91], v[32:35], a[8:11], v[88:91]
v_and_b32 v56, 1, v0
v_lshlrev_b32_e64 v56, 4, v56
v_mfma_f32_16x16x32_bf16 v[92:95], v[36:39], a[8:11], v[92:95]
s_movk_i32 s50, 0x3f80
s_nop 0
v_mfma_f32_16x16x32_bf16 v[200:203], v[40:43], a[8:11], v[200:203]
buffer_load_dwordx4 v[16:19], v9, s[32:35], s67 offen offset:2048 sc1
v_mfma_f32_16x16x32_bf16 v[204:207], v[44:47], a[8:11], v[204:207]
ds_read_b128 a[8:11], v4 offset:47104
v_lshlrev_b32_e64 v56, v56, s50
v_mfma_f32_16x16x32_bf16 v[144:147], v[32:35], a[12:15], v[144:147]
v_bfe_u32 v57, v0, 4, 1
v_mfma_f32_16x16x32_bf16 v[148:151], v[36:39], a[12:15], v[148:151]
ds_read_b128 a[12:15], v7 offset:54272
v_mul_u32_u24_e64 v57, 3, v57
v_mfma_f32_16x16x32_bf16 v[96:99], v[32:35], a[16:19], v[96:99]
v_lshrrev_b32 v58, 5, v0
v_xor_b32 v57, v57, v58
v_mfma_f32_16x16x32_bf16 v[100:103], v[36:39], a[16:19], v[100:103]
v_bfe_u32 v59, v0, 2, 2
v_mfma_f32_16x16x32_bf16 v[208:211], v[40:43], a[16:19], v[208:211]
buffer_load_dwordx4 v[20:23], v9, s[32:35], s67 offen offset:3072 sc1
v_mfma_f32_16x16x32_bf16 v[212:215], v[44:47], a[16:19], v[212:215]
ds_read_b128 a[16:19], v4 offset:48128
s_waitcnt lgkmcnt(5)
v_mfma_f32_16x16x32_bf16 v[152:155], v[32:35], a[20:23], v[152:155]
v_xor_b32 v80, v57, v59
v_xor_b32_e64 v81, v58, v59
v_mfma_f32_16x16x32_bf16 v[156:159], v[36:39], a[20:23], v[156:159]
ds_read_b128 a[20:23], v7 offset:55296
v_mfma_f32_16x16x32_bf16 v[104:107], v[32:35], a[24:27], v[104:107]
v_and_b32_e64 v59, 15, v0
v_lshl_add_u32 v59, v59, 6, s62
v_mfma_f32_16x16x32_bf16 v[108:111], v[36:39], a[24:27], v[108:111]
v_lshl_add_u32 v80, v80, 4, v59
v_mfma_f32_16x16x32_bf16 v[216:219], v[40:43], a[24:27], v[216:219]
buffer_load_dwordx4 v[24:27], v10, s[32:35], s67 offen offset:2048 sc1
v_mfma_f32_16x16x32_bf16 v[220:223], v[44:47], a[24:27], v[220:223]
ds_read_b128 a[24:27], v4 offset:49152
v_lshl_add_u32 v81, v81, 4, v59
v_mfma_f32_16x16x32_bf16 v[160:163], v[32:35], a[28:31], v[160:163]
v_bfe_u32 v59, v0, 4, 1
v_lshl_add_u32 v81, v59, 3, v81
v_mfma_f32_16x16x32_bf16 v[164:167], v[36:39], a[28:31], v[164:167]
ds_read_b128 a[28:31], v7 offset:56320
s_waitcnt lgkmcnt(5)
v_mfma_f32_16x16x32_bf16 v[112:115], v[32:35], a[0:3], v[112:115]
v_xor_b32 v82, 32, v81
v_mfma_f32_16x16x32_bf16 v[116:119], v[36:39], a[0:3], v[116:119]
v_add_u32_e64 v83, s62, v1
v_bfe_u32 v58, v0, 3, 1
v_mfma_f32_16x16x32_bf16 v[224:227], v[40:43], a[0:3], v[224:227]
buffer_load_dwordx4 v[28:31], v10, s[32:35], s67 offen offset:3072 sc1
v_mfma_f32_16x16x32_bf16 v[228:231], v[44:47], a[0:3], v[228:231]
v_mfma_f32_16x16x32_bf16 v[168:171], v[32:35], a[4:7], v[168:171]
v_xor_b32_e64 v57, v57, v58
v_bfe_u32 v58, v0, 1, 2
v_mfma_f32_16x16x32_bf16 v[172:175], v[36:39], a[4:7], v[172:175]
v_lshl_add_u32 v57, v57, 2, v58
v_mfma_f32_16x16x32_bf16 v[120:123], v[32:35], a[8:11], v[120:123]
v_mfma_f32_16x16x32_bf16 v[124:127], v[36:39], a[8:11], v[124:127]
v_cmp_eq_u32 vcc, 0, v57
s_nop 1
v_cndmask_b32_e64 v48, 0, v56, vcc
v_mfma_f32_16x16x32_bf16 v[232:235], v[40:43], a[8:11], v[232:235]
s_add_u32 m0, s62, 0
s_nop 0
buffer_load_dwordx4 v11, s[24:27], s4 offen lds
v_mfma_f32_16x16x32_bf16 v[236:239], v[44:47], a[8:11], v[236:239]
s_waitcnt lgkmcnt(0)
s_barrier
ds_read_b128 a[0:3], v13 offset:0
ds_read_b128 a[4:7], v15 offset:7168
ds_read_b128 a[8:11], v13 offset:1024
v_mfma_f32_16x16x32_bf16 v[176:179], v[32:35], a[12:15], v[176:179]
v_cmp_eq_u32 vcc, 1, v57
s_nop 1
v_cndmask_b32_e64 v49, 0, v56, vcc
v_mfma_f32_16x16x32_bf16 v[180:183], v[36:39], a[12:15], v[180:183]
ds_read_b128 a[12:15], v15 offset:8192
v_mfma_f32_16x16x32_bf16 v[128:131], v[32:35], a[16:19], v[128:131]
v_cmp_eq_u32 vcc, 2, v57
s_nop 1
v_cndmask_b32_e64 v50, 0, v56, vcc
v_mfma_f32_16x16x32_bf16 v[132:135], v[36:39], a[16:19], v[132:135]
v_cmp_eq_u32 vcc, 3, v57
s_nop 1
v_cndmask_b32_e64 v51, 0, v56, vcc
v_mfma_f32_16x16x32_bf16 v[240:243], v[40:43], a[16:19], v[240:243]
s_add_u32 m0, s62, 1024
s_nop 0
s_nop 0
buffer_load_dwordx4 v11, s[24:27], s18 offen lds
v_mfma_f32_16x16x32_bf16 v[244:247], v[44:47], a[16:19], v[244:247]
ds_read_b128 a[16:19], v13 offset:2048
v_mfma_f32_16x16x32_bf16 v[184:187], v[32:35], a[20:23], v[184:187]
v_cmp_eq_u32 vcc, 8, v57
s_nop 1
v_cndmask_b32_e64 v52, 0, v56, vcc
v_mfma_f32_16x16x32_bf16 v[188:191], v[36:39], a[20:23], v[188:191]
ds_read_b128 a[20:23], v15 offset:9216
s_waitcnt lgkmcnt(5)
v_mfma_f32_16x16x32_bf16 v[136:139], v[32:35], a[24:27], v[136:139]
v_cmp_eq_u32 vcc, 9, v57
s_nop 1
v_cndmask_b32 v53, 0, v56, vcc
v_mfma_f32_16x16x32_bf16 v[140:143], v[36:39], a[24:27], v[140:143]
v_mfma_f32_16x16x32_bf16 v[248:251], v[40:43], a[24:27], v[248:251]
s_add_u32 m0, s62, 2048
s_nop 0
s_nop 0
buffer_load_dwordx4 v11, s[24:27], s11 offen lds
v_mfma_f32_16x16x32_bf16 v[252:255], v[44:47], a[24:27], v[252:255]
ds_read_b128 a[24:27], v13 offset:3072
v_mfma_f32_16x16x32_bf16 v[192:195], v[32:35], a[28:31], v[192:195]
v_cmp_eq_u32 vcc, 10, v57
s_nop 1
v_cndmask_b32_e64 v54, 0, v56, vcc
v_mfma_f32_16x16x32_bf16 v[196:199], v[36:39], a[28:31], v[196:199]
ds_read_b128 a[28:31], v15 offset:10240
v_cmp_eq_u32 vcc, 11, v57
s_nop 1
v_cndmask_b32 v55, 0, v56, vcc
s_waitcnt vmcnt(7)
v_max3_u32 v12, v64, v68, v72
v_max_u32 v12, v12, v76
v_cmp_eq_u32_e64 vcc, -1, v12
s_cbranch_vccnz L_wc4
L_w4:
v_mfma_f32_16x16x32_bf16 v[88:91], v[64:67], a[0:3], v[88:91]
v_mfma_f32_16x16x32_bf16 v[92:95], v[68:71], a[0:3], v[92:95]
v_mfma_f32_16x16x32_bf16 v[200:203], v[72:75], a[0:3], v[200:203]
ds_write_b64 v5, a[192:193] offset:0
v_mfma_f32_16x16x32_bf16 v[204:207], v[76:79], a[0:3], v[204:207]
ds_read_b128 a[0:3], v13 offset:4096
s_waitcnt lgkmcnt(6)
s_nop 0
v_mfma_f32_16x16x32_bf16 v[144:147], v[64:67], a[4:7], v[144:147]
s_mov_b32 s67, 667648
buffer_load_dwordx4 v[32:35], v9, s[32:35], s67 offen offset:0 sc1
v_mfma_f32_16x16x32_bf16 v[148:151], v[68:71], a[4:7], v[148:151]
ds_read_b128 a[4:7], v15 offset:11264
v_mfma_f32_16x16x32_bf16 v[96:99], v[64:67], a[8:11], v[96:99]
v_mfma_f32_16x16x32_bf16 v[100:103], v[68:71], a[8:11], v[100:103]
v_mfma_f32_16x16x32_bf16 v[208:211], v[72:75], a[8:11], v[208:211]
buffer_load_dwordx4 v[36:39], v9, s[32:35], s67 offen offset:1024 sc1
v_mfma_f32_16x16x32_bf16 v[212:215], v[76:79], a[8:11], v[212:215]
ds_read_b128 a[8:11], v13 offset:5120
v_mfma_f32_16x16x32_bf16 v[152:155], v[64:67], a[12:15], v[152:155]
ds_write_b64 v5, a[194:195] offset:8
v_mfma_f32_16x16x32_bf16 v[156:159], v[68:71], a[12:15], v[156:159]
ds_read_b128 a[12:15], v15 offset:12288
s_waitcnt lgkmcnt(7)
s_nop 0
v_mfma_f32_16x16x32_bf16 v[104:107], v[64:67], a[16:19], v[104:107]
v_mfma_f32_16x16x32_bf16 v[108:111], v[68:71], a[16:19], v[108:111]
v_mfma_f32_16x16x32_bf16 v[216:219], v[72:75], a[16:19], v[216:219]
buffer_load_dwordx4 v[40:43], v10, s[32:35], s67 offen offset:0 sc1
v_mfma_f32_16x16x32_bf16 v[220:223], v[76:79], a[16:19], v[220:223]
ds_read_b128 a[16:19], v13 offset:6144
v_mfma_f32_16x16x32_bf16 v[160:163], v[64:67], a[20:23], v[160:163]
ds_write_b64 v5, a[196:197] offset:512
v_mfma_f32_16x16x32_bf16 v[164:167], v[68:71], a[20:23], v[164:167]
ds_read_b128 a[20:23], v15 offset:13312
v_mfma_f32_16x16x32_bf16 v[112:115], v[64:67], a[24:27], v[112:115]
v_mfma_f32_16x16x32_bf16 v[116:119], v[68:71], a[24:27], v[116:119]
v_mfma_f32_16x16x32_bf16 v[224:227], v[72:75], a[24:27], v[224:227]
buffer_load_dwordx4 v[44:47], v10, s[32:35], s67 offen offset:1024 sc1
v_mfma_f32_16x16x32_bf16 v[228:231], v[76:79], a[24:27], v[228:231]
ds_read_b128 a[24:27], v13 offset:14336
s_waitcnt lgkmcnt(7)
s_nop 0
v_mfma_f32_16x16x32_bf16 v[168:171], v[64:67], a[28:31], v[168:171]
v_mfma_f32_16x16x32_bf16 v[172:175], v[68:71], a[28:31], v[172:175]
ds_read_b128 a[28:31], v15 offset:21504
v_mfma_f32_16x16x32_bf16 v[120:123], v[64:67], a[0:3], v[120:123]
ds_write_b64 v5, a[198:199] offset:520
v_mfma_f32_16x16x32_bf16 v[124:127], v[68:71], a[0:3], v[124:127]
v_mfma_f32_16x16x32_bf16 v[232:235], v[72:75], a[0:3], v[232:235]
s_add_u32 m0, s62, 3072
s_nop 0
s_nop 0
buffer_load_dwordx4 v11, s[24:27], s5 offen lds
v_mfma_f32_16x16x32_bf16 v[236:239], v[76:79], a[0:3], v[236:239]
ds_read_b128 a[0:3], v13 offset:15360
v_mfma_f32_16x16x32_bf16 v[176:179], v[64:67], a[4:7], v[176:179]
v_mfma_f32_16x16x32_bf16 v[180:183], v[68:71], a[4:7], v[180:183]
ds_read_b128 a[4:7], v15 offset:22528
s_waitcnt lgkmcnt(7)
s_nop 0
v_mfma_f32_16x16x32_bf16 v[128:131], v[64:67], a[8:11], v[128:131]
v_mfma_f32_16x16x32_bf16 v[132:135], v[68:71], a[8:11], v[132:135]
ds_write_b64 v5, a[200:201] offset:2048
v_mfma_f32_16x16x32_bf16 v[240:243], v[72:75], a[8:11], v[240:243]
s_add_u32 m0, s62, 4096
s_nop 0
s_nop 0
buffer_load_dwordx4 v11, s[24:27], s19 offen lds
v_mfma_f32_16x16x32_bf16 v[244:247], v[76:79], a[8:11], v[244:247]
ds_read_b128 a[8:11], v13 offset:16384
v_mfma_f32_16x16x32_bf16 v[184:187], v[64:67], a[12:15], v[184:187]
v_mfma_f32_16x16x32_bf16 v[188:191], v[68:71], a[12:15], v[188:191]
ds_read_b128 a[12:15], v15 offset:23552
v_mfma_f32_16x16x32_bf16 v[136:139], v[64:67], a[16:19], v[136:139]
s_waitcnt vmcnt(8)
s_nop 0
ds_read_b128 v[56:59], v80 offset:0
v_mfma_f32_16x16x32_bf16 v[140:143], v[68:71], a[16:19], v[140:143]
v_mfma_f32_16x16x32_bf16 v[248:251], v[72:75], a[16:19], v[248:251]
ds_write_b64 v5, a[202:203] offset:2056
v_mfma_f32_16x16x32_bf16 v[252:255], v[76:79], a[16:19], v[252:255]
ds_read_b128 a[16:19], v13 offset:17408
s_waitcnt lgkmcnt(9)
v_mfma_f32_16x16x32_bf16 v[192:195], v[64:67], a[20:23], v[192:195]
s_add_u32 m0, s62, 5120
s_nop 0
buffer_load_dwordx4 v11, s[24:27], s12 offen lds
v_mfma_f32_16x16x32_bf16 v[196:199], v[68:71], a[20:23], v[196:199]
ds_read_b128 a[20:23], v15 offset:24576
v_max3_u32 v12, v16, v20, v24
v_max_u32 v12, v12, v28
v_cmp_eq_u32_e64 vcc, -1, v12
s_cbranch_vccnz L_wc5
L_w5:
v_mfma_f32_16x16x32_bf16 v[88:91], v[16:19], a[24:27], v[88:91]
v_mfma_f32_16x16x32_bf16 v[92:95], v[20:23], a[24:27], v[92:95]
v_mfma_f32_16x16x32_bf16 v[200:203], v[24:27], a[24:27], v[200:203]
buffer_load_dword v12, off, s[36:39], 0 offset:192 sc1
v_mfma_f32_16x16x32_bf16 v[204:207], v[28:31], a[24:27], v[204:207]
ds_read_b128 a[24:27], v13 offset:18432
v_mfma_f32_16x16x32_bf16 v[144:147], v[16:19], a[28:31], v[144:147]
ds_write_b64 v5, a[204:205] offset:2560
v_mfma_f32_16x16x32_bf16 v[148:151], v[20:23], a[28:31], v[148:151]
ds_read_b128 a[28:31], v15 offset:25600
s_waitcnt lgkmcnt(8)
v_mfma_f32_16x16x32_bf16 v[96:99], v[16:19], a[0:3], v[96:99]
s_waitcnt vmcnt(9)
ds_read_b128 v[60:63], v80 offset:1024
v_mfma_f32_16x16x32_bf16 v[100:103], v[20:23], a[0:3], v[100:103]
v_mfma_f32_16x16x32_bf16 v[208:211], v[24:27], a[0:3], v[208:211]
buffer_load_dwordx4 v[64:67], v9, s[32:35], s67 offen offset:2048 sc1
v_mfma_f32_16x16x32_bf16 v[212:215], v[28:31], a[0:3], v[212:215]
ds_read_b128 a[0:3], v13 offset:19456
s_waitcnt lgkmcnt(8)
s_nop 0
v_mfma_f32_16x16x32_bf16 v[88:91], v[48:51], v[56:59], v[88:91]
v_mfma_f32_16x16x32_bf16 v[92:95], v[52:55], v[56:59], v[92:95]
v_mfma_f32_16x16x32_bf16 v[152:155], v[16:19], a[4:7], v[152:155]
ds_write_b64 v5, a[206:207] offset:2568
v_mfma_f32_16x16x32_bf16 v[156:159], v[20:23], a[4:7], v[156:159]
ds_read_b128 a[4:7], v15 offset:26624
v_mfma_f32_16x16x32_bf16 v[104:107], v[16:19], a[8:11], v[104:107]
v_mfma_f32_16x16x32_bf16 v[108:111], v[20:23], a[8:11], v[108:111]
buffer_load_dwordx4 v[68:71], v9, s[32:35], s67 offen offset:3072 sc1
v_mfma_f32_16x16x32_bf16 v[216:219], v[24:27], a[8:11], v[216:219]
v_mfma_f32_16x16x32_bf16 v[220:223], v[28:31], a[8:11], v[220:223]
ds_read_b128 a[8:11], v13 offset:20480
s_waitcnt lgkmcnt(8)
s_nop 0
v_mfma_f32_16x16x32_bf16 v[160:163], v[16:19], a[12:15], v[160:163]
v_mfma_f32_16x16x32_bf16 v[164:167], v[20:23], a[12:15], v[164:167]
ds_read_b128 a[12:15], v15 offset:27648
v_mfma_f32_16x16x32_bf16 v[112:115], v[16:19], a[16:19], v[112:115]
ds_write_b64 v5, a[208:209] offset:4096
s_waitcnt vmcnt(10)
s_nop 0
ds_read_b128 v[84:87], v80 offset:2048
v_mfma_f32_16x16x32_bf16 v[116:119], v[20:23], a[16:19], v[116:119]
buffer_load_dwordx4 v[72:75], v10, s[32:35], s67 offen offset:2048 sc1
v_mfma_f32_16x16x32_bf16 v[224:227], v[24:27], a[16:19], v[224:227]
v_mfma_f32_16x16x32_bf16 v[228:231], v[28:31], a[16:19], v[228:231]
ds_read_b128 a[16:19], v13 offset:28672
s_waitcnt lgkmcnt(8)
s_nop 0
v_mfma_f32_16x16x32_bf16 v[200:203], v[48:51], v[60:63], v[200:203]
v_mfma_f32_16x16x32_bf16 v[204:207], v[52:55], v[60:63], v[204:207]
v_mfma_f32_16x16x32_bf16 v[168:171], v[16:19], a[20:23], v[168:171]
buffer_load_dwordx4 v[76:79], v10, s[32:35], s67 offen offset:3072 sc1
v_mfma_f32_16x16x32_bf16 v[172:175], v[20:23], a[20:23], v[172:175]
ds_read_b128 a[20:23], v15 offset:35840
s_waitcnt lgkmcnt(8)
s_nop 0
v_mfma_f32_16x16x32_bf16 v[120:123], v[16:19], a[24:27], v[120:123]
ds_write_b64 v5, a[210:211] offset:4104
v_mfma_f32_16x16x32_bf16 v[124:127], v[20:23], a[24:27], v[124:127]
v_mfma_f32_16x16x32_bf16 v[232:235], v[24:27], a[24:27], v[232:235]
v_mfma_f32_16x16x32_bf16 v[236:239], v[28:31], a[24:27], v[236:239]
ds_read_b128 a[24:27], v13 offset:29696
v_mfma_f32_16x16x32_bf16 v[176:179], v[16:19], a[28:31], v[176:179]
s_add_u32 m0, s62, 6144
s_nop 0
s_nop 0
buffer_load_dwordx4 v11, s[24:27], s6 offen lds
v_mfma_f32_16x16x32_bf16 v[180:183], v[20:23], a[28:31], v[180:183]
ds_read_b128 a[28:31], v15 offset:36864
v_mfma_f32_16x16x32_bf16 v[128:131], v[16:19], a[0:3], v[128:131]
v_mfma_f32_16x16x32_bf16 v[132:135], v[20:23], a[0:3], v[132:135]
v_mfma_f32_16x16x32_bf16 v[240:243], v[24:27], a[0:3], v[240:243]
ds_write_b64 v5, a[212:213] offset:4608
v_mfma_f32_16x16x32_bf16 v[244:247], v[28:31], a[0:3], v[244:247]
ds_read_b128 a[0:3], v13 offset:30720
s_waitcnt lgkmcnt(9)
s_waitcnt lgkmcnt(7)
v_mfma_f32_16x16x32_bf16 v[144:147], v[48:51], v[84:87], v[144:147]
v_mfma_f32_16x16x32_bf16 v[148:151], v[52:55], v[84:87], v[148:151]
s_add_u32 m0, s62, 7168
s_nop 0
buffer_load_dwordx4 v11, s[24:27], s20 offen lds
v_mfma_f32_16x16x32_bf16 v[184:187], v[16:19], a[4:7], v[184:187]
s_waitcnt vmcnt(9)
ds_read_b128 v[56:59], v80 offset:3072
v_mfma_f32_16x16x32_bf16 v[188:191], v[20:23], a[4:7], v[188:191]
ds_read_b128 a[4:7], v15 offset:37888
v_mfma_f32_16x16x32_bf16 v[136:139], v[16:19], a[8:11], v[136:139]
v_mfma_f32_16x16x32_bf16 v[140:143], v[20:23], a[8:11], v[140:143]
v_mfma_f32_16x16x32_bf16 v[248:251], v[24:27], a[8:11], v[248:251]
ds_write_b64 v5, a[214:215] offset:4616
v_mfma_f32_16x16x32_bf16 v[252:255], v[28:31], a[8:11], v[252:255]
ds_read_b128 a[8:11], v13 offset:31744
v_mfma_f32_16x16x32_bf16 v[192:195], v[16:19], a[12:15], v[192:195]
s_add_u32 m0, s62, 8192
s_nop 0
s_nop 0
buffer_load_dwordx4 v11, s[24:27], s13 offen lds
v_mfma_f32_16x16x32_bf16 v[196:199], v[20:23], a[12:15], v[196:199]
ds_read_b128 a[12:15], v15 offset:38912
s_waitcnt vmcnt(7)
v_readfirstlane_b32 s50, v12
s_nop 0
s_cmp_lt_u32 s50, 6
s_cbranch_scc1 L_c3_cold
L_c3_done:
v_max3_u32 v12, v32, v36, v40
v_max_u32 v12, v12, v44
v_cmp_eq_u32_e64 vcc, -1, v12
s_cbranch_vccnz L_wc6
L_w6:
s_waitcnt lgkmcnt(8)
v_mfma_f32_16x16x32_bf16 v[88:91], v[32:35], a[16:19], v[88:91]
v_mfma_f32_16x16x32_bf16 v[92:95], v[36:39], a[16:19], v[92:95]
v_mfma_f32_16x16x32_bf16 v[200:203], v[40:43], a[16:19], v[200:203]
s_mov_b32 s67, 671744
buffer_load_dwordx4 v[16:19], v9, s[32:35], s67 offen offset:0 sc1
v_mfma_f32_16x16x32_bf16 v[204:207], v[44:47], a[16:19], v[204:207]
ds_read_b128 a[16:19], v13 offset:32768
v_mfma_f32_16x16x32_bf16 v[144:147], v[32:35], a[20:23], v[144:147]
ds_write_b64 v5, a[216:217] offset:6144
v_mfma_f32_16x16x32_bf16 v[148:151], v[36:39], a[20:23], v[148:151]
ds_read_b128 a[20:23], v15 offset:39936
ds_read_b128 v[60:63], v80 offset:4096
v_mfma_f32_16x16x32_bf16 v[96:99], v[32:35], a[24:27], v[96:99]
buffer_load_dwordx4 v[20:23], v9, s[32:35], s67 offen offset:1024 sc1
v_mfma_f32_16x16x32_bf16 v[100:103], v[36:39], a[24:27], v[100:103]
v_mfma_f32_16x16x32_bf16 v[208:211], v[40:43], a[24:27], v[208:211]
v_mfma_f32_16x16x32_bf16 v[212:215], v[44:47], a[24:27], v[212:215]
ds_read_b128 a[24:27], v13 offset:33792
s_waitcnt lgkmcnt(8)
s_nop 0
v_mfma_f32_16x16x32_bf16 v[96:99], v[48:51], v[56:59], v[96:99]
buffer_load_dwordx4 v[24:27], v10, s[32:35], s67 offen offset:0 sc1
v_mfma_f32_16x16x32_bf16 v[100:103], v[52:55], v[56:59], v[100:103]
v_mfma_f32_16x16x32_bf16 v[152:155], v[32:35], a[28:31], v[152:155]
ds_write_b64 v5, a[218:219] offset:6152
v_mfma_f32_16x16x32_bf16 v[156:159], v[36:39], a[28:31], v[156:159]
ds_read_b128 a[28:31], v15 offset:40960
v_mfma_f32_16x16x32_bf16 v[104:107], v[32:35], a[0:3], v[104:107]
v_mfma_f32_16x16x32_bf16 v[108:111], v[36:39], a[0:3], v[108:111]
buffer_load_dwordx4 v[28:31], v10, s[32:35], s67 offen offset:1024 sc1
v_mfma_f32_16x16x32_bf16 v[216:219], v[40:43], a[0:3], v[216:219]
v_mfma_f32_16x16x32_bf16 v[220:223], v[44:47], a[0:3], v[220:223]
ds_read_b128 a[0:3], v13 offset:34816
v_mfma_f32_16x16x32_bf16 v[160:163], v[32:35], a[4:7], v[160:163]
s_add_u32 m0, s62, 0
s_nop 0
buffer_load_dwordx4 v11, s[24:27], s7 offen lds
v_mfma_f32_16x16x32_bf16 v[164:167], v[36:39], a[4:7], v[164:167]
ds_read_b128 a[4:7], v15 offset:41984
s_waitcnt lgkmcnt(8)
s_nop 0
v_mfma_f32_16x16x32_bf16 v[112:115], v[32:35], a[8:11], v[112:115]
ds_write_b64 v5, a[220:221] offset:6656
ds_read_b128 v[84:87], v80 offset:5120
v_mfma_f32_16x16x32_bf16 v[116:119], v[36:39], a[8:11], v[116:119]
v_mfma_f32_16x16x32_bf16 v[224:227], v[40:43], a[8:11], v[224:227]
v_mfma_f32_16x16x32_bf16 v[228:231], v[44:47], a[8:11], v[228:231]
ds_read_b128 a[8:11], v13 offset:43008
s_waitcnt lgkmcnt(8)
v_mfma_f32_16x16x32_bf16 v[208:211], v[48:51], v[60:63], v[208:211]
s_add_u32 m0, s62, 1024
s_nop 0
buffer_load_dwordx4 v11, s[24:27], s21 offen lds
v_mfma_f32_16x16x32_bf16 v[212:215], v[52:55], v[60:63], v[212:215]
v_mfma_f32_16x16x32_bf16 v[168:171], v[32:35], a[12:15], v[168:171]
v_mfma_f32_16x16x32_bf16 v[172:175], v[36:39], a[12:15], v[172:175]
ds_read_b128 a[12:15], v15 offset:50176
v_mfma_f32_16x16x32_bf16 v[120:123], v[32:35], a[16:19], v[120:123]
ds_write_b64 v5, a[222:223] offset:6664
v_mfma_f32_16x16x32_bf16 v[124:127], v[36:39], a[16:19], v[124:127]
s_add_u32 m0, s62, 2048
s_nop 0
s_nop 0
buffer_load_dwordx4 v11, s[24:27], s14 offen lds
v_mfma_f32_16x16x32_bf16 v[232:235], v[40:43], a[16:19], v[232:235]
v_mfma_f32_16x16x32_bf16 v[236:239], v[44:47], a[16:19], v[236:239]
ds_read_b128 a[16:19], v13 offset:44032
s_waitcnt lgkmcnt(8)
s_nop 0
v_mfma_f32_16x16x32_bf16 v[176:179], v[32:35], a[20:23], v[176:179]
s_mov_b32 s68, 688128
buffer_load_dwordx4 a[192:195], v9, s[32:35], s68 offen offset:0 sc1
v_mfma_f32_16x16x32_bf16 v[180:183], v[36:39], a[20:23], v[180:183]
ds_read_b128 a[20:23], v15 offset:51200
v_mfma_f32_16x16x32_bf16 v[128:131], v[32:35], a[24:27], v[128:131]
v_mfma_f32_16x16x32_bf16 v[132:135], v[36:39], a[24:27], v[132:135]
v_mfma_f32_16x16x32_bf16 v[240:243], v[40:43], a[24:27], v[240:243]
ds_write_b64 v5, a[224:225] offset:8192
v_mfma_f32_16x16x32_bf16 v[244:247], v[44:47], a[24:27], v[244:247]
ds_read_b128 a[24:27], v13 offset:45056
s_waitcnt lgkmcnt(7)
s_nop 0
v_mfma_f32_16x16x32_bf16 v[152:155], v[48:51], v[84:87], v[152:155]
buffer_load_dwordx4 a[196:199], v9, s[32:35], s68 offen offset:1024 sc1
v_mfma_f32_16x16x32_bf16 v[156:159], v[52:55], v[84:87], v[156:159]
v_mfma_f32_16x16x32_bf16 v[184:187], v[32:35], a[28:31], v[184:187]
buffer_load_dwordx4 a[200:203], v10, s[32:35], s68 offen offset:0 sc1
v_mfma_f32_16x16x32_bf16 v[188:191], v[36:39], a[28:31], v[188:191]
ds_read_b128 a[28:31], v15 offset:52224
s_waitcnt lgkmcnt(7)
s_nop 0
v_mfma_f32_16x16x32_bf16 v[136:139], v[32:35], a[0:3], v[136:139]
v_mfma_f32_16x16x32_bf16 v[140:143], v[36:39], a[0:3], v[140:143]
v_mfma_f32_16x16x32_bf16 v[248:251], v[40:43], a[0:3], v[248:251]
ds_write_b64 v5, a[226:227] offset:8200
v_mfma_f32_16x16x32_bf16 v[252:255], v[44:47], a[0:3], v[252:255]
ds_read_b128 a[0:3], v13 offset:46080
v_mfma_f32_16x16x32_bf16 v[192:195], v[32:35], a[4:7], v[192:195]
buffer_load_dwordx4 a[204:207], v10, s[32:35], s68 offen offset:1024 sc1
v_mfma_f32_16x16x32_bf16 v[196:199], v[36:39], a[4:7], v[196:199]
ds_read_b128 a[4:7], v15 offset:53248
s_waitcnt vmcnt(13)
ds_read_b128 v[56:59], v80 offset:6144
v_max3_u32 v12, v64, v68, v72
v_max_u32 v12, v12, v76
v_cmp_eq_u32 vcc, -1, v12
s_cbranch_vccnz L_wc7
L_w7:
v_mfma_f32_16x16x32_bf16 v[88:91], v[64:67], a[8:11], v[88:91]
buffer_load_dwordx4 v[32:35], v9, s[32:35], s67 offen offset:2048 sc1
v_mfma_f32_16x16x32_bf16 v[92:95], v[68:71], a[8:11], v[92:95]
ds_write_b64 v5, a[228:229] offset:8704
v_mfma_f32_16x16x32_bf16 v[200:203], v[72:75], a[8:11], v[200:203]
ds_write_b64 v5, a[230:231] offset:8712
v_mfma_f32_16x16x32_bf16 v[204:207], v[76:79], a[8:11], v[204:207]
ds_read_b128 a[8:11], v13 offset:47104
s_waitcnt lgkmcnt(10)
s_nop 0
v_mfma_f32_16x16x32_bf16 v[144:147], v[64:67], a[12:15], v[144:147]
ds_write_b64 v5, a[232:233] offset:10240
v_mfma_f32_16x16x32_bf16 v[148:151], v[68:71], a[12:15], v[148:151]
ds_read_b128 a[12:15], v15 offset:54272
s_waitcnt vmcnt(13)
s_nop 0
ds_read_b128 v[60:63], v80 offset:7168
v_mfma_f32_16x16x32_bf16 v[96:99], v[64:67], a[16:19], v[96:99]
buffer_load_dwordx4 v[36:39], v9, s[32:35], s67 offen offset:3072 sc1
v_mfma_f32_16x16x32_bf16 v[100:103], v[68:71], a[16:19], v[100:103]
ds_write_b64 v5, a[234:235] offset:10248
v_mfma_f32_16x16x32_bf16 v[208:211], v[72:75], a[16:19], v[208:211]
ds_write_b64 v5, a[236:237] offset:10752
v_mfma_f32_16x16x32_bf16 v[212:215], v[76:79], a[16:19], v[212:215]
ds_read_b128 a[16:19], v13 offset:48128
v_mfma_f32_16x16x32_bf16 v[152:155], v[64:67], a[20:23], v[152:155]
ds_write_b64 v5, a[238:239] offset:10760
v_mfma_f32_16x16x32_bf16 v[156:159], v[68:71], a[20:23], v[156:159]
ds_read_b128 a[20:23], v15 offset:55296
s_waitcnt lgkmcnt(13)
s_nop 0
v_mfma_f32_16x16x32_bf16 v[104:107], v[64:67], a[24:27], v[104:107]
buffer_load_dwordx4 v[40:43], v10, s[32:35], s67 offen offset:2048 sc1
v_mfma_f32_16x16x32_bf16 v[108:111], v[68:71], a[24:27], v[108:111]
ds_write_b64 v5, a[240:241] offset:12288
v_mfma_f32_16x16x32_bf16 v[216:219], v[72:75], a[24:27], v[216:219]
ds_write_b64 v5, a[242:243] offset:12296
v_mfma_f32_16x16x32_bf16 v[220:223], v[76:79], a[24:27], v[220:223]
ds_read_b128 a[24:27], v13 offset:49152
s_waitcnt lgkmcnt(14)
s_nop 0
v_mfma_f32_16x16x32_bf16 v[104:107], v[48:51], v[56:59], v[104:107]
buffer_load_dwordx4 v[44:47], v10, s[32:35], s67 offen offset:3072 sc1
v_mfma_f32_16x16x32_bf16 v[108:111], v[52:55], v[56:59], v[108:111]
ds_write_b64 v5, a[244:245] offset:12800
v_mfma_f32_16x16x32_bf16 v[160:163], v[64:67], a[28:31], v[160:163]
ds_write_b64 v5, a[246:247] offset:12808
s_waitcnt vmcnt(15)
s_nop 0
ds_read_b128 v[84:87], v80 offset:8192
v_mfma_f32_16x16x32_bf16 v[164:167], v[68:71], a[28:31], v[164:167]
ds_read_b128 a[28:31], v15 offset:56320
v_mfma_f32_16x16x32_bf16 v[112:115], v[64:67], a[0:3], v[112:115]
s_add_u32 m0, s62, 3072
s_nop 0
s_nop 0
buffer_load_dwordx4 v11, s[24:27], s8 offen lds
v_mfma_f32_16x16x32_bf16 v[116:119], v[68:71], a[0:3], v[116:119]
v_mfma_f32_16x16x32_bf16 v[224:227], v[72:75], a[0:3], v[224:227]
v_mfma_f32_16x16x32_bf16 v[228:231], v[76:79], a[0:3], v[228:231]
s_waitcnt lgkmcnt(13)
s_waitcnt lgkmcnt(12)
v_mfma_f32_16x16x32_bf16 v[216:219], v[48:51], v[60:63], v[216:219]
s_add_u32 m0, s62, 4096
s_nop 0
s_nop 0
buffer_load_dwordx4 v11, s[24:27], s58 offen lds
v_mfma_f32_16x16x32_bf16 v[220:223], v[52:55], v[60:63], v[220:223]
v_mfma_f32_16x16x32_bf16 v[168:171], v[64:67], a[4:7], v[168:171]
v_mfma_f32_16x16x32_bf16 v[172:175], v[68:71], a[4:7], v[172:175]
v_mfma_f32_16x16x32_bf16 v[120:123], v[64:67], a[8:11], v[120:123]
s_add_u32 m0, s62, 5120
s_nop 0
s_nop 0
buffer_load_dwordx4 v11, s[24:27], s15 offen lds
v_mfma_f32_16x16x32_bf16 v[124:127], v[68:71], a[8:11], v[124:127]
v_mfma_f32_16x16x32_bf16 v[232:235], v[72:75], a[8:11], v[232:235]
v_mfma_f32_16x16x32_bf16 v[236:239], v[76:79], a[8:11], v[236:239]
s_waitcnt lgkmcnt(0)
s_barrier
ds_read_b128 a[0:3], v4 offset:0
ds_read_b128 a[4:7], v7 offset:7168
ds_read_b128 a[8:11], v4 offset:1024
v_mfma_f32_16x16x32_bf16 v[176:179], v[64:67], a[12:15], v[176:179]
buffer_load_dwordx4 a[208:211], v9, s[32:35], s68 offen offset:2048 sc1
v_mfma_f32_16x16x32_bf16 v[180:183], v[68:71], a[12:15], v[180:183]
ds_read_b128 a[12:15], v7 offset:8192
v_mfma_f32_16x16x32_bf16 v[128:131], v[64:67], a[16:19], v[128:131]
v_mfma_f32_16x16x32_bf16 v[132:135], v[68:71], a[16:19], v[132:135]
v_mfma_f32_16x16x32_bf16 v[240:243], v[72:75], a[16:19], v[240:243]
buffer_load_dwordx4 a[212:215], v9, s[32:35], s68 offen offset:3072 sc1
v_mfma_f32_16x16x32_bf16 v[244:247], v[76:79], a[16:19], v[244:247]
ds_read_b128 a[16:19], v4 offset:2048
v_mfma_f32_16x16x32_bf16 v[160:163], v[48:51], v[84:87], v[160:163]
v_mfma_f32_16x16x32_bf16 v[164:167], v[52:55], v[84:87], v[164:167]
s_waitcnt vmcnt(15)
s_nop 0
ds_read_b128 v[56:59], v80 offset:0
v_mfma_f32_16x16x32_bf16 v[184:187], v[64:67], a[20:23], v[184:187]
buffer_load_dwordx4 a[216:219], v10, s[32:35], s68 offen offset:2048 sc1
v_mfma_f32_16x16x32_bf16 v[188:191], v[68:71], a[20:23], v[188:191]
ds_read_b128 a[20:23], v7 offset:9216
v_mfma_f32_16x16x32_bf16 v[136:139], v[64:67], a[24:27], v[136:139]
v_mfma_f32_16x16x32_bf16 v[140:143], v[68:71], a[24:27], v[140:143]
v_mfma_f32_16x16x32_bf16 v[248:251], v[72:75], a[24:27], v[248:251]
buffer_load_dwordx4 a[220:223], v10, s[32:35], s68 offen offset:3072 sc1
v_mfma_f32_16x16x32_bf16 v[252:255], v[76:79], a[24:27], v[252:255]
ds_read_b128 a[24:27], v4 offset:3072
s_waitcnt lgkmcnt(6)
s_nop 0
v_mfma_f32_16x16x32_bf16 v[192:195], v[64:67], a[28:31], v[192:195]
v_mfma_f32_16x16x32_bf16 v[196:199], v[68:71], a[28:31], v[196:199]
ds_read_b128 a[28:31], v7 offset:10240
v_mfma_f32_16x16x32_bf16 v[88:91], v[16:19], a[0:3], v[88:91]
v_mfma_f32_16x16x32_bf16 v[92:95], v[20:23], a[0:3], v[92:95]
s_mov_b32 s67, 675840
buffer_load_dwordx4 v[64:67], v9, s[32:35], s67 offen offset:0 sc1
v_mfma_f32_16x16x32_bf16 v[200:203], v[24:27], a[0:3], v[200:203]
ds_write_b64 v6, a[96:97] offset:0
v_mfma_f32_16x16x32_bf16 v[204:207], v[28:31], a[0:3], v[204:207]
ds_read_b128 a[0:3], v4 offset:4096
v_mfma_f32_16x16x32_bf16 v[144:147], v[16:19], a[4:7], v[144:147]
s_waitcnt vmcnt(17)
s_nop 0
ds_read_b128 v[60:63], v80 offset:1024
v_mfma_f32_16x16x32_bf16 v[148:151], v[20:23], a[4:7], v[148:151]
ds_read_b128 a[4:7], v7 offset:11264
s_waitcnt lgkmcnt(8)
s_nop 0
v_mfma_f32_16x16x32_bf16 v[96:99], v[16:19], a[8:11], v[96:99]
buffer_load_dwordx4 v[68:71], v9, s[32:35], s67 offen offset:1024 sc1
v_mfma_f32_16x16x32_bf16 v[100:103], v[20:23], a[8:11], v[100:103]
ds_write_b64 v6, a[98:99] offset:8
v_mfma_f32_16x16x32_bf16 v[208:211], v[24:27], a[8:11], v[208:211]
v_mfma_f32_16x16x32_bf16 v[212:215], v[28:31], a[8:11], v[212:215]
ds_read_b128 a[8:11], v4 offset:5120
s_waitcnt lgkmcnt(9)
s_nop 0
v_mfma_f32_16x16x32_bf16 v[112:115], v[48:51], v[56:59], v[112:115]
buffer_load_dwordx4 v[72:75], v10, s[32:35], s67 offen offset:0 sc1
v_mfma_f32_16x16x32_bf16 v[116:119], v[52:55], v[56:59], v[116:119]
v_mfma_f32_16x16x32_bf16 v[152:155], v[16:19], a[12:15], v[152:155]
ds_write_b64 v6, a[100:101] offset:512
v_mfma_f32_16x16x32_bf16 v[156:159], v[20:23], a[12:15], v[156:159]
ds_read_b128 a[12:15], v7 offset:12288
v_mfma_f32_16x16x32_bf16 v[104:107], v[16:19], a[16:19], v[104:107]
v_mfma_f32_16x16x32_bf16 v[108:111], v[20:23], a[16:19], v[108:111]
buffer_load_dwordx4 v[76:79], v10, s[32:35], s67 offen offset:1024 sc1
v_mfma_f32_16x16x32_bf16 v[216:219], v[24:27], a[16:19], v[216:219]
ds_write_b64 v6, a[102:103] offset:520
v_mfma_f32_16x16x32_bf16 v[220:223], v[28:31], a[16:19], v[220:223]
ds_read_b128 a[16:19], v4 offset:6144
s_waitcnt lgkmcnt(10)
v_mfma_f32_16x16x32_bf16 v[160:163], v[16:19], a[20:23], v[160:163]
s_add_u32 m0, s62, 6144
s_nop 0
buffer_load_dwordx4 v11, s[24:27], s9 offen lds
v_mfma_f32_16x16x32_bf16 v[164:167], v[20:23], a[20:23], v[164:167]
ds_read_b128 a[20:23], v7 offset:13312
v_mfma_f32_16x16x32_bf16 v[112:115], v[16:19], a[24:27], v[112:115]
s_waitcnt vmcnt(20)
s_nop 0
ds_read_b128 v[84:87], v80 offset:2048
v_mfma_f32_16x16x32_bf16 v[116:119], v[20:23], a[24:27], v[116:119]
ds_write_b64 v6, a[104:105] offset:2048
v_mfma_f32_16x16x32_bf16 v[224:227], v[24:27], a[24:27], v[224:227]
v_mfma_f32_16x16x32_bf16 v[228:231], v[28:31], a[24:27], v[228:231]
ds_read_b128 a[24:27], v4 offset:14336
s_waitcnt lgkmcnt(11)
v_mfma_f32_16x16x32_bf16 v[224:227], v[48:51], v[60:63], v[224:227]
s_add_u32 m0, s62, 7168
s_nop 0
buffer_load_dwordx4 v11, s[24:27], s59 offen lds
v_mfma_f32_16x16x32_bf16 v[228:231], v[52:55], v[60:63], v[228:231]
v_mfma_f32_16x16x32_bf16 v[168:171], v[16:19], a[28:31], v[168:171]
ds_write_b64 v6, a[106:107] offset:2056
v_mfma_f32_16x16x32_bf16 v[172:175], v[20:23], a[28:31], v[172:175]
ds_read_b128 a[28:31], v7 offset:21504
s_waitcnt lgkmcnt(10)
v_mfma_f32_16x16x32_bf16 v[120:123], v[16:19], a[0:3], v[120:123]
s_add_u32 m0, s62, 8192
s_nop 0
buffer_load_dwordx4 v11, s[24:27], s16 offen lds
v_mfma_f32_16x16x32_bf16 v[124:127], v[20:23], a[0:3], v[124:127]
v_mfma_f32_16x16x32_bf16 v[232:235], v[24:27], a[0:3], v[232:235]
ds_write_b64 v6, a[108:109] offset:2560
v_mfma_f32_16x16x32_bf16 v[236:239], v[28:31], a[0:3], v[236:239]
ds_read_b128 a[0:3], v4 offset:15360
v_mfma_f32_16x16x32_bf16 v[176:179], v[16:19], a[4:7], v[176:179]
s_mov_b32 s68, 692224
buffer_load_dwordx4 a[224:227], v9, s[32:35], s68 offen offset:0 sc1
v_mfma_f32_16x16x32_bf16 v[180:183], v[20:23], a[4:7], v[180:183]
ds_read_b128 a[4:7], v7 offset:22528
v_mfma_f32_16x16x32_bf16 v[128:131], v[16:19], a[8:11], v[128:131]
v_mfma_f32_16x16x32_bf16 v[132:135], v[20:23], a[8:11], v[132:135]
v_mfma_f32_16x16x32_bf16 v[240:243], v[24:27], a[8:11], v[240:243]
ds_write_b64 v6, a[110:111] offset:2568
v_mfma_f32_16x16x32_bf16 v[244:247], v[28:31], a[8:11], v[244:247]
ds_read_b128 a[8:11], v4 offset:16384
s_waitcnt lgkmcnt(10)
s_waitcnt lgkmcnt(9)
v_mfma_f32_16x16x32_bf16 v[168:171], v[48:51], v[84:87], v[168:171]
buffer_load_dwordx4 a[228:231], v9, s[32:35], s68 offen offset:1024 sc1
v_mfma_f32_16x16x32_bf16 v[172:175], v[52:55], v[84:87], v[172:175]
s_waitcnt vmcnt(15)
s_nop 0
ds_read_b128 v[56:59], v80 offset:3072
v_mfma_f32_16x16x32_bf16 v[184:187], v[16:19], a[12:15], v[184:187]
ds_write_b64 v6, a[112:113] offset:4096
v_mfma_f32_16x16x32_bf16 v[188:191], v[20:23], a[12:15], v[188:191]
ds_read_b128 a[12:15], v7 offset:23552
v_mfma_f32_16x16x32_bf16 v[136:139], v[16:19], a[16:19], v[136:139]
buffer_load_dwordx4 a[232:235], v10, s[32:35], s68 offen offset:0 sc1
v_mfma_f32_16x16x32_bf16 v[140:143], v[20:23], a[16:19], v[140:143]
v_mfma_f32_16x16x32_bf16 v[248:251], v[24:27], a[16:19], v[248:251]
ds_write_b64 v6, a[114:115] offset:4104
v_mfma_f32_16x16x32_bf16 v[252:255], v[28:31], a[16:19], v[252:255]
ds_read_b128 a[16:19], v4 offset:17408
v_mfma_f32_16x16x32_bf16 v[192:195], v[16:19], a[20:23], v[192:195]
buffer_load_dwordx4 a[236:239], v10, s[32:35], s68 offen offset:1024 sc1
v_mfma_f32_16x16x32_bf16 v[196:199], v[20:23], a[20:23], v[196:199]
ds_read_b128 a[20:23], v7 offset:24576
s_waitcnt lgkmcnt(9)
s_nop 0
v_mfma_f32_16x16x32_bf16 v[88:91], v[32:35], a[24:27], v[88:91]
v_mfma_f32_16x16x32_bf16 v[92:95], v[36:39], a[24:27], v[92:95]
buffer_load_dwordx4 v[16:19], v9, s[32:35], s67 offen offset:2048 sc1
v_mfma_f32_16x16x32_bf16 v[200:203], v[40:43], a[24:27], v[200:203]
ds_write_b64 v6, a[116:117] offset:4608
v_mfma_f32_16x16x32_bf16 v[204:207], v[44:47], a[24:27], v[204:207]
ds_read_b128 a[24:27], v4 offset:18432
v_mfma_f32_16x16x32_bf16 v[144:147], v[32:35], a[28:31], v[144:147]
v_mfma_f32_16x16x32_bf16 v[148:151], v[36:39], a[28:31], v[148:151]
ds_read_b128 a[28:31], v7 offset:25600
v_mfma_f32_16x16x32_bf16 v[96:99], v[32:35], a[0:3], v[96:99]
buffer_load_dwordx4 v[20:23], v9, s[32:35], s67 offen offset:3072 sc1
v_mfma_f32_16x16x32_bf16 v[100:103], v[36:39], a[0:3], v[100:103]
ds_write_b64 v6, a[118:119] offset:4616
v_mfma_f32_16x16x32_bf16 v[208:211], v[40:43], a[0:3], v[208:211]
v_mfma_f32_16x16x32_bf16 v[212:215], v[44:47], a[0:3], v[212:215]
ds_read_b128 a[0:3], v4 offset:19456
s_waitcnt lgkmcnt(8)
s_nop 0
v_mfma_f32_16x16x32_bf16 v[120:123], v[48:51], v[56:59], v[120:123]
buffer_load_dwordx4 v[24:27], v10, s[32:35], s67 offen offset:2048 sc1
v_mfma_f32_16x16x32_bf16 v[124:127], v[52:55], v[56:59], v[124:127]
s_waitcnt vmcnt(19)
s_nop 0
ds_read_b128 v[60:63], v80 offset:4096
v_mfma_f32_16x16x32_bf16 v[152:155], v[32:35], a[4:7], v[152:155]
ds_write_b64 v6, a[120:121] offset:6144
v_mfma_f32_16x16x32_bf16 v[156:159], v[36:39], a[4:7], v[156:159]
ds_read_b128 a[4:7], v7 offset:26624
v_mfma_f32_16x16x32_bf16 v[104:107], v[32:35], a[8:11], v[104:107]
v_mfma_f32_16x16x32_bf16 v[108:111], v[36:39], a[8:11], v[108:111]
buffer_load_dwordx4 v[28:31], v10, s[32:35], s67 offen offset:3072 sc1
v_mfma_f32_16x16x32_bf16 v[216:219], v[40:43], a[8:11], v[216:219]
ds_write_b64 v6, a[122:123] offset:6152
v_mfma_f32_16x16x32_bf16 v[220:223], v[44:47], a[8:11], v[220:223]
ds_read_b128 a[8:11], v4 offset:20480
v_mfma_f32_16x16x32_bf16 v[160:163], v[32:35], a[12:15], v[160:163]
s_add_u32 m0, s62, 0
s_nop 0
buffer_load_dwordx4 v11, s[24:27], s10 offen lds
v_mfma_f32_16x16x32_bf16 v[164:167], v[36:39], a[12:15], v[164:167]
ds_read_b128 a[12:15], v7 offset:27648
s_waitcnt lgkmcnt(9)
v_mfma_f32_16x16x32_bf16 v[112:115], v[32:35], a[16:19], v[112:115]
s_waitcnt vmcnt(20)
ds_read_b128 v[84:87], v80 offset:5120
v_mfma_f32_16x16x32_bf16 v[116:119], v[36:39], a[16:19], v[116:119]
ds_write_b64 v6, a[124:125] offset:6656
v_mfma_f32_16x16x32_bf16 v[224:227], v[40:43], a[16:19], v[224:227]
v_mfma_f32_16x16x32_bf16 v[228:231], v[44:47], a[16:19], v[228:231]
ds_read_b128 a[16:19], v4 offset:28672
v_mfma_f32_16x16x32_bf16 v[168:171], v[32:35], a[20:23], v[168:171]
s_add_u32 m0, s62, 1024
s_nop 0
s_nop 0
buffer_load_dwordx4 v11, s[24:27], s60 offen lds
v_mfma_f32_16x16x32_bf16 v[172:175], v[36:39], a[20:23], v[172:175]
ds_read_b128 a[20:23], v7 offset:35840
v_mfma_f32_16x16x32_bf16 v[120:123], v[32:35], a[24:27], v[120:123]
ds_write_b64 v6, a[126:127] offset:6664
v_mfma_f32_16x16x32_bf16 v[124:127], v[36:39], a[24:27], v[124:127]
v_mfma_f32_16x16x32_bf16 v[232:235], v[40:43], a[24:27], v[232:235]
s_add_u32 m0, s62, 2048
s_nop 0
s_nop 0
buffer_load_dwordx4 v11, s[24:27], s17 offen lds
v_mfma_f32_16x16x32_bf16 v[236:239], v[44:47], a[24:27], v[236:239]
ds_read_b128 a[24:27], v4 offset:29696
s_waitcnt lgkmcnt(9)
s_nop 0
v_mfma_f32_16x16x32_bf16 v[232:235], v[48:51], v[60:63], v[232:235]
v_mfma_f32_16x16x32_bf16 v[236:239], v[52:55], v[60:63], v[236:239]
ds_write_b64 v6, a[128:129] offset:8192
v_mfma_f32_16x16x32_bf16 v[176:179], v[32:35], a[28:31], v[176:179]
buffer_load_dwordx4 a[240:243], v9, s[32:35], s68 offen offset:2048 sc1
v_mfma_f32_16x16x32_bf16 v[180:183], v[36:39], a[28:31], v[180:183]
ds_read_b128 a[28:31], v7 offset:36864
v_mfma_f32_16x16x32_bf16 v[128:131], v[32:35], a[0:3], v[128:131]
v_mfma_f32_16x16x32_bf16 v[132:135], v[36:39], a[0:3], v[132:135]
v_mfma_f32_16x16x32_bf16 v[240:243], v[40:43], a[0:3], v[240:243]
ds_write_b64 v6, a[130:131] offset:8200
v_mfma_f32_16x16x32_bf16 v[244:247], v[44:47], a[0:3], v[244:247]
ds_read_b128 a[0:3], v4 offset:30720
s_waitcnt lgkmcnt(9)
s_nop 0
v_mfma_f32_16x16x32_bf16 v[176:179], v[48:51], v[84:87], v[176:179]
buffer_load_dwordx4 a[244:247], v9, s[32:35], s68 offen offset:3072 sc1
v_mfma_f32_16x16x32_bf16 v[180:183], v[52:55], v[84:87], v[180:183]
s_waitcnt vmcnt(15)
s_nop 0
ds_read_b128 v[56:59], v80 offset:6144
v_mfma_f32_16x16x32_bf16 v[184:187], v[32:35], a[4:7], v[184:187]
ds_write_b64 v6, a[132:133] offset:8704
v_mfma_f32_16x16x32_bf16 v[188:191], v[36:39], a[4:7], v[188:191]
ds_read_b128 a[4:7], v7 offset:37888
s_waitcnt lgkmcnt(10)
s_nop 0
v_mfma_f32_16x16x32_bf16 v[136:139], v[32:35], a[8:11], v[136:139]
buffer_load_dwordx4 a[96:99], v10, s[32:35], s68 offen offset:2048 sc1
v_mfma_f32_16x16x32_bf16 v[140:143], v[36:39], a[8:11], v[140:143]
v_mfma_f32_16x16x32_bf16 v[248:251], v[40:43], a[8:11], v[248:251]
ds_write_b64 v6, a[134:135] offset:8712
v_mfma_f32_16x16x32_bf16 v[252:255], v[44:47], a[8:11], v[252:255]
ds_read_b128 a[8:11], v4 offset:31744
v_mfma_f32_16x16x32_bf16 v[192:195], v[32:35], a[12:15], v[192:195]
buffer_load_dwordx4 a[100:103], v10, s[32:35], s68 offen offset:3072 sc1
v_mfma_f32_16x16x32_bf16 v[196:199], v[36:39], a[12:15], v[196:199]
ds_read_b128 a[12:15], v7 offset:38912
v_mfma_f32_16x16x32_bf16 v[88:91], v[64:67], a[16:19], v[88:91]
v_mfma_f32_16x16x32_bf16 v[92:95], v[68:71], a[16:19], v[92:95]
v_mfma_f32_16x16x32_bf16 v[200:203], v[72:75], a[16:19], v[200:203]
ds_write_b64 v6, a[136:137] offset:10240
v_mfma_f32_16x16x32_bf16 v[204:207], v[76:79], a[16:19], v[204:207]
ds_read_b128 a[16:19], v4 offset:32768
s_waitcnt lgkmcnt(10)
s_nop 0
v_mfma_f32_16x16x32_bf16 v[144:147], v[64:67], a[20:23], v[144:147]
s_mov_b32 s67, 679936
buffer_load_dwordx4 v[32:35], v9, s[32:35], s67 offen offset:0 sc1
v_mfma_f32_16x16x32_bf16 v[148:151], v[68:71], a[20:23], v[148:151]
ds_read_b128 a[20:23], v7 offset:39936
v_mfma_f32_16x16x32_bf16 v[96:99], v[64:67], a[24:27], v[96:99]
s_waitcnt vmcnt(17)
s_nop 0
ds_read_b128 v[60:63], v80 offset:7168
v_mfma_f32_16x16x32_bf16 v[100:103], v[68:71], a[24:27], v[100:103]
v_mfma_f32_16x16x32_bf16 v[208:211], v[72:75], a[24:27], v[208:211]
ds_write_b64 v6, a[138:139] offset:10248
v_mfma_f32_16x16x32_bf16 v[212:215], v[76:79], a[24:27], v[212:215]
ds_read_b128 a[24:27], v4 offset:33792
s_waitcnt lgkmcnt(11)
s_nop 0
v_mfma_f32_16x16x32_bf16 v[128:131], v[48:51], v[56:59], v[128:131]
buffer_load_dwordx4 v[36:39], v9, s[32:35], s67 offen offset:1024 sc1
v_mfma_f32_16x16x32_bf16 v[132:135], v[52:55], v[56:59], v[132:135]
v_mfma_f32_16x16x32_bf16 v[152:155], v[64:67], a[28:31], v[152:155]
v_mfma_f32_16x16x32_bf16 v[156:159], v[68:71], a[28:31], v[156:159]
ds_read_b128 a[28:31], v7 offset:40960
s_waitcnt lgkmcnt(8)
s_nop 0
v_mfma_f32_16x16x32_bf16 v[104:107], v[64:67], a[0:3], v[104:107]
buffer_load_dwordx4 v[40:43], v10, s[32:35], s67 offen offset:0 sc1
v_mfma_f32_16x16x32_bf16 v[108:111], v[68:71], a[0:3], v[108:111]
ds_write_b64 v6, a[140:141] offset:10752
v_mfma_f32_16x16x32_bf16 v[216:219], v[72:75], a[0:3], v[216:219]
v_mfma_f32_16x16x32_bf16 v[220:223], v[76:79], a[0:3], v[220:223]
ds_read_b128 a[0:3], v4 offset:34816
v_mfma_f32_16x16x32_bf16 v[160:163], v[64:67], a[4:7], v[160:163]
v_mfma_f32_16x16x32_bf16 v[164:167], v[68:71], a[4:7], v[164:167]
ds_read_b128 a[4:7], v7 offset:41984
v_mfma_f32_16x16x32_bf16 v[112:115], v[64:67], a[8:11], v[112:115]
buffer_load_dwordx4 v[44:47], v10, s[32:35], s67 offen offset:1024 sc1
v_mfma_f32_16x16x32_bf16 v[116:119], v[68:71], a[8:11], v[116:119]
ds_write_b64 v6, a[142:143] offset:10760
v_mfma_f32_16x16x32_bf16 v[224:227], v[72:75], a[8:11], v[224:227]
s_waitcnt vmcnt(19)
s_nop 0
ds_read_b128 v[84:87], v80 offset:8192
v_mfma_f32_16x16x32_bf16 v[228:231], v[76:79], a[8:11], v[228:231]
ds_read_b128 a[8:11], v4 offset:43008
s_waitcnt lgkmcnt(10)
s_waitcnt lgkmcnt(9)
v_mfma_f32_16x16x32_bf16 v[240:243], v[48:51], v[60:63], v[240:243]
v_mfma_f32_16x16x32_bf16 v[244:247], v[52:55], v[60:63], v[244:247]
v_mfma_f32_16x16x32_bf16 v[168:171], v[64:67], a[12:15], v[168:171]
ds_write_b64 v6, a[32:33] offset:12288
v_mfma_f32_16x16x32_bf16 v[172:175], v[68:71], a[12:15], v[172:175]
ds_read_b128 a[12:15], v7 offset:50176
v_mfma_f32_16x16x32_bf16 v[120:123], v[64:67], a[16:19], v[120:123]
s_mov_b32 s68, 696320
buffer_load_dwordx4 a[104:107], v9, s[32:35], s68 offen offset:0 sc1
v_mfma_f32_16x16x32_bf16 v[124:127], v[68:71], a[16:19], v[124:127]
v_mfma_f32_16x16x32_bf16 v[232:235], v[72:75], a[16:19], v[232:235]
v_mfma_f32_16x16x32_bf16 v[236:239], v[76:79], a[16:19], v[236:239]
ds_read_b128 a[16:19], v4 offset:44032
v_mfma_f32_16x16x32_bf16 v[176:179], v[64:67], a[20:23], v[176:179]
ds_write_b64 v6, a[34:35] offset:12296
v_mfma_f32_16x16x32_bf16 v[180:183], v[68:71], a[20:23], v[180:183]
ds_read_b128 a[20:23], v7 offset:51200
s_waitcnt lgkmcnt(9)
s_nop 0
v_mfma_f32_16x16x32_bf16 v[128:131], v[64:67], a[24:27], v[128:131]
buffer_load_dwordx4 a[108:111], v9, s[32:35], s68 offen offset:1024 sc1
v_mfma_f32_16x16x32_bf16 v[132:135], v[68:71], a[24:27], v[132:135]
v_mfma_f32_16x16x32_bf16 v[240:243], v[72:75], a[24:27], v[240:243]
v_mfma_f32_16x16x32_bf16 v[244:247], v[76:79], a[24:27], v[244:247]
ds_read_b128 a[24:27], v4 offset:45056
v_mfma_f32_16x16x32_bf16 v[184:187], v[64:67], a[28:31], v[184:187]
ds_write_b64 v6, a[36:37] offset:12800
v_mfma_f32_16x16x32_bf16 v[188:191], v[68:71], a[28:31], v[188:191]
ds_read_b128 a[28:31], v7 offset:52224
s_waitcnt vmcnt(12)
ds_read_b128 v[56:59], v80 offset:0
s_waitcnt lgkmcnt(10)
v_mfma_f32_16x16x32_bf16 v[184:187], v[48:51], v[84:87], v[184:187]
buffer_load_dwordx4 a[112:115], v10, s[32:35], s68 offen offset:0 sc1
v_mfma_f32_16x16x32_bf16 v[188:191], v[52:55], v[84:87], v[188:191]
v_mfma_f32_16x16x32_bf16 v[136:139], v[64:67], a[0:3], v[136:139]
v_mfma_f32_16x16x32_bf16 v[140:143], v[68:71], a[0:3], v[140:143]
v_mfma_f32_16x16x32_bf16 v[248:251], v[72:75], a[0:3], v[248:251]
ds_write_b64 v6, a[38:39] offset:12808
v_mfma_f32_16x16x32_bf16 v[252:255], v[76:79], a[0:3], v[252:255]
ds_read_b128 a[0:3], v4 offset:46080
s_waitcnt lgkmcnt(9)
s_nop 0
v_mfma_f32_16x16x32_bf16 v[192:195], v[64:67], a[4:7], v[192:195]
buffer_load_dwordx4 a[116:119], v10, s[32:35], s68 offen offset:1024 sc1
v_mfma_f32_16x16x32_bf16 v[196:199], v[68:71], a[4:7], v[196:199]
ds_read_b128 a[4:7], v7 offset:53248
v_mfma_f32_16x16x32_bf16 v[88:91], v[16:19], a[8:11], v[88:91]
v_mfma_f32_16x16x32_bf16 v[92:95], v[20:23], a[8:11], v[92:95]
v_mfma_f32_16x16x32_bf16 v[200:203], v[24:27], a[8:11], v[200:203]
buffer_load_dwordx4 v[64:67], v9, s[32:35], s67 offen offset:2048 sc1
v_mfma_f32_16x16x32_bf16 v[204:207], v[28:31], a[8:11], v[204:207]
ds_read_b128 a[8:11], v4 offset:47104
v_mfma_f32_16x16x32_bf16 v[144:147], v[16:19], a[12:15], v[144:147]
v_mfma_f32_16x16x32_bf16 v[148:151], v[20:23], a[12:15], v[148:151]
ds_read_b128 a[12:15], v7 offset:54272
s_waitcnt lgkmcnt(8)
v_mfma_f32_16x16x32_bf16 v[96:99], v[16:19], a[16:19], v[96:99]
s_waitcnt vmcnt(14)
ds_read_b128 v[60:63], v80 offset:1024
v_mfma_f32_16x16x32_bf16 v[100:103], v[20:23], a[16:19], v[100:103]
v_mfma_f32_16x16x32_bf16 v[208:211], v[24:27], a[16:19], v[208:211]
buffer_load_dwordx4 v[68:71], v9, s[32:35], s67 offen offset:3072 sc1
v_mfma_f32_16x16x32_bf16 v[212:215], v[28:31], a[16:19], v[212:215]
ds_read_b128 a[16:19], v4 offset:48128
s_waitcnt lgkmcnt(7)
s_nop 0
v_mfma_f32_16x16x32_bf16 v[136:139], v[48:51], v[56:59], v[136:139]
v_mfma_f32_16x16x32_bf16 v[140:143], v[52:55], v[56:59], v[140:143]
v_mfma_f32_16x16x32_bf16 v[152:155], v[16:19], a[20:23], v[152:155]
v_mfma_f32_16x16x32_bf16 v[156:159], v[20:23], a[20:23], v[156:159]
ds_read_b128 a[20:23], v7 offset:55296
v_mfma_f32_16x16x32_bf16 v[104:107], v[16:19], a[24:27], v[104:107]
v_mfma_f32_16x16x32_bf16 v[108:111], v[20:23], a[24:27], v[108:111]
buffer_load_dwordx4 v[72:75], v10, s[32:35], s67 offen offset:2048 sc1
v_mfma_f32_16x16x32_bf16 v[216:219], v[24:27], a[24:27], v[216:219]
v_mfma_f32_16x16x32_bf16 v[220:223], v[28:31], a[24:27], v[220:223]
ds_read_b128 a[24:27], v4 offset:49152
s_waitcnt lgkmcnt(6)
s_nop 0
v_mfma_f32_16x16x32_bf16 v[160:163], v[16:19], a[28:31], v[160:163]
v_mfma_f32_16x16x32_bf16 v[164:167], v[20:23], a[28:31], v[164:167]
ds_read_b128 a[28:31], v7 offset:56320
v_mfma_f32_16x16x32_bf16 v[112:115], v[16:19], a[0:3], v[112:115]
s_waitcnt vmcnt(15)
s_nop 0
ds_read_b128 v[84:87], v80 offset:2048
v_mfma_f32_16x16x32_bf16 v[116:119], v[20:23], a[0:3], v[116:119]
buffer_load_dwordx4 v[76:79], v10, s[32:35], s67 offen offset:3072 sc1
v_mfma_f32_16x16x32_bf16 v[224:227], v[24:27], a[0:3], v[224:227]
v_mfma_f32_16x16x32_bf16 v[228:231], v[28:31], a[0:3], v[228:231]
s_waitcnt lgkmcnt(5)
s_nop 0
v_mfma_f32_16x16x32_bf16 v[248:251], v[48:51], v[60:63], v[248:251]
v_mfma_f32_16x16x32_bf16 v[252:255], v[52:55], v[60:63], v[252:255]
v_mfma_f32_16x16x32_bf16 v[168:171], v[16:19], a[4:7], v[168:171]
buffer_load_dwordx4 a[120:123], v9, s[32:35], s68 offen offset:2048 sc1
v_mfma_f32_16x16x32_bf16 v[172:175], v[20:23], a[4:7], v[172:175]
s_waitcnt lgkmcnt(4)
s_nop 0
v_mfma_f32_16x16x32_bf16 v[120:123], v[16:19], a[8:11], v[120:123]
v_mfma_f32_16x16x32_bf16 v[124:127], v[20:23], a[8:11], v[124:127]
v_mfma_f32_16x16x32_bf16 v[232:235], v[24:27], a[8:11], v[232:235]
v_mfma_f32_16x16x32_bf16 v[236:239], v[28:31], a[8:11], v[236:239]
s_waitcnt lgkmcnt(0)
s_barrier
ds_read_b128 a[0:3], v13 offset:0
ds_read_b128 a[4:7], v15 offset:7168
ds_read_b128 a[8:11], v13 offset:1024
v_mfma_f32_16x16x32_bf16 v[176:179], v[16:19], a[12:15], v[176:179]
buffer_load_dwordx4 a[124:127], v9, s[32:35], s68 offen offset:3072 sc1
v_mfma_f32_16x16x32_bf16 v[180:183], v[20:23], a[12:15], v[180:183]
ds_read_b128 a[12:15], v15 offset:8192
v_mfma_f32_16x16x32_bf16 v[128:131], v[16:19], a[16:19], v[128:131]
v_mfma_f32_16x16x32_bf16 v[132:135], v[20:23], a[16:19], v[132:135]
v_mfma_f32_16x16x32_bf16 v[240:243], v[24:27], a[16:19], v[240:243]
v_mfma_f32_16x16x32_bf16 v[244:247], v[28:31], a[16:19], v[244:247]
ds_read_b128 a[16:19], v13 offset:2048
v_mfma_f32_16x16x32_bf16 v[192:195], v[48:51], v[84:87], v[192:195]
v_mfma_f32_16x16x32_bf16 v[196:199], v[52:55], v[84:87], v[196:199]
buffer_load_dwordx4 a[128:131], v10, s[32:35], s68 offen offset:2048 sc1
v_mfma_f32_16x16x32_bf16 v[184:187], v[16:19], a[20:23], v[184:187]
v_mfma_f32_16x16x32_bf16 v[188:191], v[20:23], a[20:23], v[188:191]
ds_read_b128 a[20:23], v15 offset:9216
v_mfma_f32_16x16x32_bf16 v[136:139], v[16:19], a[24:27], v[136:139]
v_mfma_f32_16x16x32_bf16 v[140:143], v[20:23], a[24:27], v[140:143]
v_mfma_f32_16x16x32_bf16 v[248:251], v[24:27], a[24:27], v[248:251]
buffer_load_dwordx4 a[132:135], v10, s[32:35], s68 offen offset:3072 sc1
v_mfma_f32_16x16x32_bf16 v[252:255], v[28:31], a[24:27], v[252:255]
ds_read_b128 a[24:27], v13 offset:3072
v_mfma_f32_16x16x32_bf16 v[192:195], v[16:19], a[28:31], v[192:195]
v_mfma_f32_16x16x32_bf16 v[196:199], v[20:23], a[28:31], v[196:199]
ds_read_b128 a[28:31], v15 offset:10240
s_waitcnt vmcnt(12) lgkmcnt(5)
s_nop 0
v_mfma_f32_16x16x32_bf16 v[88:91], v[32:35], a[0:3], v[88:91]
v_mfma_f32_16x16x32_bf16 v[92:95], v[36:39], a[0:3], v[92:95]
s_mov_b32 s67, 684032
buffer_load_dwordx4 v[16:19], v9, s[32:35], s67 offen offset:0 sc1
v_mfma_f32_16x16x32_bf16 v[200:203], v[40:43], a[0:3], v[200:203]
ds_write_b64 v5, a[48:49] offset:0
v_mfma_f32_16x16x32_bf16 v[204:207], v[44:47], a[0:3], v[204:207]
ds_read_b128 a[0:3], v13 offset:4096
v_mfma_f32_16x16x32_bf16 v[144:147], v[32:35], a[4:7], v[144:147]
v_mfma_f32_16x16x32_bf16 v[148:151], v[36:39], a[4:7], v[148:151]
ds_read_b128 a[4:7], v15 offset:11264
v_mfma_f32_16x16x32_bf16 v[96:99], v[32:35], a[8:11], v[96:99]
ds_write_b64 v5, a[50:51] offset:8
v_mfma_f32_16x16x32_bf16 v[100:103], v[36:39], a[8:11], v[100:103]
buffer_load_dwordx4 v[20:23], v9, s[32:35], s67 offen offset:1024 sc1
v_mfma_f32_16x16x32_bf16 v[208:211], v[40:43], a[8:11], v[208:211]
v_mfma_f32_16x16x32_bf16 v[212:215], v[44:47], a[8:11], v[212:215]
ds_read_b128 a[8:11], v13 offset:5120
s_waitcnt lgkmcnt(7)
s_nop 0
v_mfma_f32_16x16x32_bf16 v[152:155], v[32:35], a[12:15], v[152:155]
ds_write_b64 v5, a[52:53] offset:512
v_mfma_f32_16x16x32_bf16 v[156:159], v[36:39], a[12:15], v[156:159]
ds_read_b128 a[12:15], v15 offset:12288
v_mfma_f32_16x16x32_bf16 v[104:107], v[32:35], a[16:19], v[104:107]
v_mfma_f32_16x16x32_bf16 v[108:111], v[36:39], a[16:19], v[108:111]
buffer_load_dwordx4 v[24:27], v10, s[32:35], s67 offen offset:0 sc1
v_mfma_f32_16x16x32_bf16 v[216:219], v[40:43], a[16:19], v[216:219]
ds_write_b64 v5, a[54:55] offset:520
v_mfma_f32_16x16x32_bf16 v[220:223], v[44:47], a[16:19], v[220:223]
ds_read_b128 a[16:19], v13 offset:6144
v_mfma_f32_16x16x32_bf16 v[160:163], v[32:35], a[20:23], v[160:163]
v_mfma_f32_16x16x32_bf16 v[164:167], v[36:39], a[20:23], v[164:167]
ds_read_b128 a[20:23], v15 offset:13312
s_waitcnt lgkmcnt(8)
s_nop 0
v_mfma_f32_16x16x32_bf16 v[112:115], v[32:35], a[24:27], v[112:115]
ds_write_b64 v5, a[56:57] offset:2048
v_mfma_f32_16x16x32_bf16 v[116:119], v[36:39], a[24:27], v[116:119]
buffer_load_dwordx4 v[28:31], v10, s[32:35], s67 offen offset:1024 sc1
v_mfma_f32_16x16x32_bf16 v[224:227], v[40:43], a[24:27], v[224:227]
v_mfma_f32_16x16x32_bf16 v[228:231], v[44:47], a[24:27], v[228:231]
ds_read_b128 a[24:27], v13 offset:14336
v_mfma_f32_16x16x32_bf16 v[168:171], v[32:35], a[28:31], v[168:171]
ds_write_b64 v5, a[58:59] offset:2056
v_mfma_f32_16x16x32_bf16 v[172:175], v[36:39], a[28:31], v[172:175]
ds_read_b128 a[28:31], v15 offset:21504
v_mfma_f32_16x16x32_bf16 v[120:123], v[32:35], a[0:3], v[120:123]
s_mov_b32 s68, 700416
buffer_load_dwordx4 a[136:139], v9, s[32:35], s68 offen offset:0 sc1
v_mfma_f32_16x16x32_bf16 v[124:127], v[36:39], a[0:3], v[124:127]
v_mfma_f32_16x16x32_bf16 v[232:235], v[40:43], a[0:3], v[232:235]
ds_write_b64 v5, a[60:61] offset:2560
v_mfma_f32_16x16x32_bf16 v[236:239], v[44:47], a[0:3], v[236:239]
ds_read_b128 a[0:3], v13 offset:15360
s_waitcnt lgkmcnt(9)
s_nop 0
v_mfma_f32_16x16x32_bf16 v[176:179], v[32:35], a[4:7], v[176:179]
buffer_load_dwordx4 a[140:143], v9, s[32:35], s68 offen offset:1024 sc1
v_mfma_f32_16x16x32_bf16 v[180:183], v[36:39], a[4:7], v[180:183]
ds_read_b128 a[4:7], v15 offset:22528
v_mfma_f32_16x16x32_bf16 v[128:131], v[32:35], a[8:11], v[128:131]
v_mfma_f32_16x16x32_bf16 v[132:135], v[36:39], a[8:11], v[132:135]
ds_write_b64 v5, a[62:63] offset:2568
v_mfma_f32_16x16x32_bf16 v[240:243], v[40:43], a[8:11], v[240:243]
buffer_load_dwordx4 a[32:35], v10, s[32:35], s68 offen offset:0 sc1
v_mfma_f32_16x16x32_bf16 v[244:247], v[44:47], a[8:11], v[244:247]
ds_read_b128 a[8:11], v13 offset:16384
v_mfma_f32_16x16x32_bf16 v[184:187], v[32:35], a[12:15], v[184:187]
ds_write_b64 v5, a[64:65] offset:4096
v_mfma_f32_16x16x32_bf16 v[188:191], v[36:39], a[12:15], v[188:191]
ds_read_b128 a[12:15], v15 offset:23552
s_waitcnt lgkmcnt(9)
s_nop 0
v_mfma_f32_16x16x32_bf16 v[136:139], v[32:35], a[16:19], v[136:139]
v_mfma_f32_16x16x32_bf16 v[140:143], v[36:39], a[16:19], v[140:143]
v_mfma_f32_16x16x32_bf16 v[248:251], v[40:43], a[16:19], v[248:251]
ds_write_b64 v5, a[66:67] offset:4104
v_mfma_f32_16x16x32_bf16 v[252:255], v[44:47], a[16:19], v[252:255]
ds_read_b128 a[16:19], v13 offset:17408
v_mfma_f32_16x16x32_bf16 v[192:195], v[32:35], a[20:23], v[192:195]
buffer_load_dwordx4 a[36:39], v10, s[32:35], s68 offen offset:1024 sc1
v_mfma_f32_16x16x32_bf16 v[196:199], v[36:39], a[20:23], v[196:199]
ds_read_b128 a[20:23], v15 offset:24576
s_waitcnt vmcnt(12)
s_nop 0
v_mfma_f32_16x16x32_bf16 v[88:91], v[64:67], a[24:27], v[88:91]
v_mfma_f32_16x16x32_bf16 v[92:95], v[68:71], a[24:27], v[92:95]
buffer_load_dwordx4 v[32:35], v9, s[32:35], s67 offen offset:2048 sc1
v_mfma_f32_16x16x32_bf16 v[200:203], v[72:75], a[24:27], v[200:203]
ds_write_b64 v5, a[68:69] offset:4608
v_mfma_f32_16x16x32_bf16 v[204:207], v[76:79], a[24:27], v[204:207]
ds_read_b128 a[24:27], v13 offset:18432
s_waitcnt lgkmcnt(9)
s_nop 0
v_mfma_f32_16x16x32_bf16 v[144:147], v[64:67], a[28:31], v[144:147]
v_mfma_f32_16x16x32_bf16 v[148:151], v[68:71], a[28:31], v[148:151]
ds_read_b128 a[28:31], v15 offset:25600
v_mfma_f32_16x16x32_bf16 v[96:99], v[64:67], a[0:3], v[96:99]
ds_write_b64 v5, a[70:71] offset:4616
v_mfma_f32_16x16x32_bf16 v[100:103], v[68:71], a[0:3], v[100:103]
buffer_load_dwordx4 v[36:39], v9, s[32:35], s67 offen offset:3072 sc1
v_mfma_f32_16x16x32_bf16 v[208:211], v[72:75], a[0:3], v[208:211]
v_mfma_f32_16x16x32_bf16 v[212:215], v[76:79], a[0:3], v[212:215]
ds_read_b128 a[0:3], v13 offset:19456
v_mfma_f32_16x16x32_bf16 v[152:155], v[64:67], a[4:7], v[152:155]
ds_write_b64 v5, a[72:73] offset:6144
v_mfma_f32_16x16x32_bf16 v[156:159], v[68:71], a[4:7], v[156:159]
ds_read_b128 a[4:7], v15 offset:26624
s_waitcnt lgkmcnt(8)
s_nop 0
v_mfma_f32_16x16x32_bf16 v[104:107], v[64:67], a[8:11], v[104:107]
v_mfma_f32_16x16x32_bf16 v[108:111], v[68:71], a[8:11], v[108:111]
buffer_load_dwordx4 v[40:43], v10, s[32:35], s67 offen offset:2048 sc1
v_mfma_f32_16x16x32_bf16 v[216:219], v[72:75], a[8:11], v[216:219]
ds_write_b64 v5, a[74:75] offset:6152
v_mfma_f32_16x16x32_bf16 v[220:223], v[76:79], a[8:11], v[220:223]
ds_read_b128 a[8:11], v13 offset:20480
v_mfma_f32_16x16x32_bf16 v[160:163], v[64:67], a[12:15], v[160:163]
v_mfma_f32_16x16x32_bf16 v[164:167], v[68:71], a[12:15], v[164:167]
ds_read_b128 a[12:15], v15 offset:27648
v_mfma_f32_16x16x32_bf16 v[112:115], v[64:67], a[16:19], v[112:115]
ds_write_b64 v5, a[76:77] offset:6656
v_mfma_f32_16x16x32_bf16 v[116:119], v[68:71], a[16:19], v[116:119]
buffer_load_dwordx4 v[44:47], v10, s[32:35], s67 offen offset:3072 sc1
v_mfma_f32_16x16x32_bf16 v[224:227], v[72:75], a[16:19], v[224:227]
v_mfma_f32_16x16x32_bf16 v[228:231], v[76:79], a[16:19], v[228:231]
ds_read_b128 a[16:19], v13 offset:28672
s_waitcnt lgkmcnt(9)
s_nop 0
v_mfma_f32_16x16x32_bf16 v[168:171], v[64:67], a[20:23], v[168:171]
ds_write_b64 v5, a[78:79] offset:6664
v_mfma_f32_16x16x32_bf16 v[172:175], v[68:71], a[20:23], v[172:175]
ds_read_b128 a[20:23], v15 offset:35840
v_mfma_f32_16x16x32_bf16 v[120:123], v[64:67], a[24:27], v[120:123]
buffer_load_dwordx4 a[48:51], v9, s[32:35], s68 offen offset:2048 sc1
v_mfma_f32_16x16x32_bf16 v[124:127], v[68:71], a[24:27], v[124:127]
v_mfma_f32_16x16x32_bf16 v[232:235], v[72:75], a[24:27], v[232:235]
ds_write_b64 v5, a[80:81] offset:8192
v_mfma_f32_16x16x32_bf16 v[236:239], v[76:79], a[24:27], v[236:239]
ds_read_b128 a[24:27], v13 offset:29696
v_mfma_f32_16x16x32_bf16 v[176:179], v[64:67], a[28:31], v[176:179]
buffer_load_dwordx4 a[52:55], v9, s[32:35], s68 offen offset:3072 sc1
v_mfma_f32_16x16x32_bf16 v[180:183], v[68:71], a[28:31], v[180:183]
ds_read_b128 a[28:31], v15 offset:36864
s_waitcnt lgkmcnt(8)
s_nop 0
v_mfma_f32_16x16x32_bf16 v[128:131], v[64:67], a[0:3], v[128:131]
v_mfma_f32_16x16x32_bf16 v[132:135], v[68:71], a[0:3], v[132:135]
ds_write_b64 v5, a[82:83] offset:8200
v_mfma_f32_16x16x32_bf16 v[240:243], v[72:75], a[0:3], v[240:243]
buffer_load_dwordx4 a[56:59], v10, s[32:35], s68 offen offset:2048 sc1
v_mfma_f32_16x16x32_bf16 v[244:247], v[76:79], a[0:3], v[244:247]
ds_read_b128 a[0:3], v13 offset:30720
v_mfma_f32_16x16x32_bf16 v[184:187], v[64:67], a[4:7], v[184:187]
ds_write_b64 v5, a[84:85] offset:8704
v_mfma_f32_16x16x32_bf16 v[188:191], v[68:71], a[4:7], v[188:191]
ds_read_b128 a[4:7], v15 offset:37888
v_mfma_f32_16x16x32_bf16 v[136:139], v[64:67], a[8:11], v[136:139]
v_mfma_f32_16x16x32_bf16 v[140:143], v[68:71], a[8:11], v[140:143]
v_mfma_f32_16x16x32_bf16 v[248:251], v[72:75], a[8:11], v[248:251]
ds_write_b64 v5, a[86:87] offset:8712
v_mfma_f32_16x16x32_bf16 v[252:255], v[76:79], a[8:11], v[252:255]
ds_read_b128 a[8:11], v13 offset:31744
s_waitcnt lgkmcnt(9)
s_nop 0
v_mfma_f32_16x16x32_bf16 v[192:195], v[64:67], a[12:15], v[192:195]
buffer_load_dwordx4 a[60:63], v10, s[32:35], s68 offen offset:3072 sc1
v_mfma_f32_16x16x32_bf16 v[196:199], v[68:71], a[12:15], v[196:199]
ds_read_b128 a[12:15], v15 offset:38912
s_waitcnt vmcnt(12)
s_nop 0
v_mfma_f32_16x16x32_bf16 v[88:91], v[16:19], a[16:19], v[88:91]
v_mfma_f32_16x16x32_bf16 v[92:95], v[20:23], a[16:19], v[92:95]
v_mfma_f32_16x16x32_bf16 v[200:203], v[24:27], a[16:19], v[200:203]
ds_write_b64 v5, a[88:89] offset:10240
v_mfma_f32_16x16x32_bf16 v[204:207], v[28:31], a[16:19], v[204:207]
ds_read_b128 a[16:19], v13 offset:32768
v_mfma_f32_16x16x32_bf16 v[144:147], v[16:19], a[20:23], v[144:147]
v_mfma_f32_16x16x32_bf16 v[148:151], v[20:23], a[20:23], v[148:151]
ds_read_b128 a[20:23], v15 offset:39936
s_waitcnt lgkmcnt(8)
s_nop 0
v_mfma_f32_16x16x32_bf16 v[96:99], v[16:19], a[24:27], v[96:99]
v_mfma_f32_16x16x32_bf16 v[100:103], v[20:23], a[24:27], v[100:103]
ds_write_b64 v5, a[90:91] offset:10248
v_mfma_f32_16x16x32_bf16 v[208:211], v[24:27], a[24:27], v[208:211]
v_mfma_f32_16x16x32_bf16 v[212:215], v[28:31], a[24:27], v[212:215]
ds_read_b128 a[24:27], v13 offset:33792
v_mfma_f32_16x16x32_bf16 v[152:155], v[16:19], a[28:31], v[152:155]
v_mfma_f32_16x16x32_bf16 v[156:159], v[20:23], a[28:31], v[156:159]
ds_read_b128 a[28:31], v15 offset:40960
v_mfma_f32_16x16x32_bf16 v[104:107], v[16:19], a[0:3], v[104:107]
v_mfma_f32_16x16x32_bf16 v[108:111], v[20:23], a[0:3], v[108:111]
ds_write_b64 v5, a[92:93] offset:10752
v_mfma_f32_16x16x32_bf16 v[216:219], v[24:27], a[0:3], v[216:219]
v_mfma_f32_16x16x32_bf16 v[220:223], v[28:31], a[0:3], v[220:223]
ds_read_b128 a[0:3], v13 offset:34816
s_waitcnt lgkmcnt(8)
s_nop 0
v_mfma_f32_16x16x32_bf16 v[160:163], v[16:19], a[4:7], v[160:163]
v_mfma_f32_16x16x32_bf16 v[164:167], v[20:23], a[4:7], v[164:167]
ds_read_b128 a[4:7], v15 offset:41984
v_mfma_f32_16x16x32_bf16 v[112:115], v[16:19], a[8:11], v[112:115]
ds_write_b64 v5, a[94:95] offset:10760
v_mfma_f32_16x16x32_bf16 v[116:119], v[20:23], a[8:11], v[116:119]
v_mfma_f32_16x16x32_bf16 v[224:227], v[24:27], a[8:11], v[224:227]
v_mfma_f32_16x16x32_bf16 v[228:231], v[28:31], a[8:11], v[228:231]
ds_read_b128 a[8:11], v13 offset:43008
v_mfma_f32_16x16x32_bf16 v[168:171], v[16:19], a[12:15], v[168:171]
ds_write_b64 v5, a[144:145] offset:12288
v_mfma_f32_16x16x32_bf16 v[172:175], v[20:23], a[12:15], v[172:175]
ds_read_b128 a[12:15], v15 offset:50176
s_waitcnt lgkmcnt(8)
s_nop 0
v_mfma_f32_16x16x32_bf16 v[120:123], v[16:19], a[16:19], v[120:123]
v_mfma_f32_16x16x32_bf16 v[124:127], v[20:23], a[16:19], v[124:127]
v_mfma_f32_16x16x32_bf16 v[232:235], v[24:27], a[16:19], v[232:235]
v_mfma_f32_16x16x32_bf16 v[236:239], v[28:31], a[16:19], v[236:239]
ds_read_b128 a[16:19], v13 offset:44032
v_mfma_f32_16x16x32_bf16 v[176:179], v[16:19], a[20:23], v[176:179]
ds_write_b64 v5, a[146:147] offset:12296
v_mfma_f32_16x16x32_bf16 v[180:183], v[20:23], a[20:23], v[180:183]
ds_read_b128 a[20:23], v15 offset:51200
v_mfma_f32_16x16x32_bf16 v[128:131], v[16:19], a[24:27], v[128:131]
v_mfma_f32_16x16x32_bf16 v[132:135], v[20:23], a[24:27], v[132:135]
v_mfma_f32_16x16x32_bf16 v[240:243], v[24:27], a[24:27], v[240:243]
v_mfma_f32_16x16x32_bf16 v[244:247], v[28:31], a[24:27], v[244:247]
ds_read_b128 a[24:27], v13 offset:45056
s_waitcnt lgkmcnt(8)
s_nop 0
v_mfma_f32_16x16x32_bf16 v[184:187], v[16:19], a[28:31], v[184:187]
ds_write_b64 v5, a[148:149] offset:12800
v_mfma_f32_16x16x32_bf16 v[188:191], v[20:23], a[28:31], v[188:191]
ds_read_b128 a[28:31], v15 offset:52224
v_mfma_f32_16x16x32_bf16 v[136:139], v[16:19], a[0:3], v[136:139]
v_mfma_f32_16x16x32_bf16 v[140:143], v[20:23], a[0:3], v[140:143]
v_mfma_f32_16x16x32_bf16 v[248:251], v[24:27], a[0:3], v[248:251]
ds_write_b64 v5, a[150:151] offset:12808
v_mfma_f32_16x16x32_bf16 v[252:255], v[28:31], a[0:3], v[252:255]
ds_read_b128 a[0:3], v13 offset:46080
v_mfma_f32_16x16x32_bf16 v[192:195], v[16:19], a[4:7], v[192:195]
v_mfma_f32_16x16x32_bf16 v[196:199], v[20:23], a[4:7], v[196:199]
ds_read_b128 a[4:7], v15 offset:53248
s_waitcnt vmcnt(4) lgkmcnt(8)
s_nop 0
v_mfma_f32_16x16x32_bf16 v[88:91], v[32:35], a[8:11], v[88:91]
v_mfma_f32_16x16x32_bf16 v[92:95], v[36:39], a[8:11], v[92:95]
v_mfma_f32_16x16x32_bf16 v[200:203], v[40:43], a[8:11], v[200:203]
v_mfma_f32_16x16x32_bf16 v[204:207], v[44:47], a[8:11], v[204:207]
ds_read_b128 a[8:11], v13 offset:47104
v_mfma_f32_16x16x32_bf16 v[144:147], v[32:35], a[12:15], v[144:147]
v_mfma_f32_16x16x32_bf16 v[148:151], v[36:39], a[12:15], v[148:151]
ds_read_b128 a[12:15], v15 offset:54272
v_mfma_f32_16x16x32_bf16 v[96:99], v[32:35], a[16:19], v[96:99]
v_mfma_f32_16x16x32_bf16 v[100:103], v[36:39], a[16:19], v[100:103]
v_mfma_f32_16x16x32_bf16 v[208:211], v[40:43], a[16:19], v[208:211]
v_mfma_f32_16x16x32_bf16 v[212:215], v[44:47], a[16:19], v[212:215]
ds_read_b128 a[16:19], v13 offset:48128
s_waitcnt lgkmcnt(6)
s_nop 0
v_mfma_f32_16x16x32_bf16 v[152:155], v[32:35], a[20:23], v[152:155]
v_mfma_f32_16x16x32_bf16 v[156:159], v[36:39], a[20:23], v[156:159]
ds_read_b128 a[20:23], v15 offset:55296
v_mfma_f32_16x16x32_bf16 v[104:107], v[32:35], a[24:27], v[104:107]
v_mfma_f32_16x16x32_bf16 v[108:111], v[36:39], a[24:27], v[108:111]
v_mfma_f32_16x16x32_bf16 v[216:219], v[40:43], a[24:27], v[216:219]
v_mfma_f32_16x16x32_bf16 v[220:223], v[44:47], a[24:27], v[220:223]
ds_read_b128 a[24:27], v13 offset:49152
v_mfma_f32_16x16x32_bf16 v[160:163], v[32:35], a[28:31], v[160:163]
v_mfma_f32_16x16x32_bf16 v[164:167], v[36:39], a[28:31], v[164:167]
ds_read_b128 a[28:31], v15 offset:56320
s_waitcnt lgkmcnt(5)
s_nop 0
v_mfma_f32_16x16x32_bf16 v[112:115], v[32:35], a[0:3], v[112:115]
v_mfma_f32_16x16x32_bf16 v[116:119], v[36:39], a[0:3], v[116:119]
v_mfma_f32_16x16x32_bf16 v[224:227], v[40:43], a[0:3], v[224:227]
v_mfma_f32_16x16x32_bf16 v[228:231], v[44:47], a[0:3], v[228:231]
v_mfma_f32_16x16x32_bf16 v[168:171], v[32:35], a[4:7], v[168:171]
v_mfma_f32_16x16x32_bf16 v[172:175], v[36:39], a[4:7], v[172:175]
v_mfma_f32_16x16x32_bf16 v[120:123], v[32:35], a[8:11], v[120:123]
v_mfma_f32_16x16x32_bf16 v[124:127], v[36:39], a[8:11], v[124:127]
v_mfma_f32_16x16x32_bf16 v[232:235], v[40:43], a[8:11], v[232:235]
v_mfma_f32_16x16x32_bf16 v[236:239], v[44:47], a[8:11], v[236:239]
s_waitcnt lgkmcnt(0)
s_barrier
ds_read_b128 a[0:3], v4 offset:0
ds_read_b128 a[4:7], v7 offset:7168
ds_read_b128 a[8:11], v4 offset:1024
v_mfma_f32_16x16x32_bf16 v[176:179], v[32:35], a[12:15], v[176:179]
v_mfma_f32_16x16x32_bf16 v[180:183], v[36:39], a[12:15], v[180:183]
ds_read_b128 a[12:15], v7 offset:8192
v_mfma_f32_16x16x32_bf16 v[128:131], v[32:35], a[16:19], v[128:131]
v_mfma_f32_16x16x32_bf16 v[132:135], v[36:39], a[16:19], v[132:135]
v_mfma_f32_16x16x32_bf16 v[240:243], v[40:43], a[16:19], v[240:243]
v_mfma_f32_16x16x32_bf16 v[244:247], v[44:47], a[16:19], v[244:247]
ds_read_b128 a[16:19], v4 offset:2048
v_mfma_f32_16x16x32_bf16 v[184:187], v[32:35], a[20:23], v[184:187]
v_mfma_f32_16x16x32_bf16 v[188:191], v[36:39], a[20:23], v[188:191]
ds_read_b128 a[20:23], v7 offset:9216
s_waitcnt lgkmcnt(5)
s_nop 0
v_mfma_f32_16x16x32_bf16 v[136:139], v[32:35], a[24:27], v[136:139]
v_mfma_f32_16x16x32_bf16 v[140:143], v[36:39], a[24:27], v[140:143]
v_mfma_f32_16x16x32_bf16 v[248:251], v[40:43], a[24:27], v[248:251]
v_mfma_f32_16x16x32_bf16 v[252:255], v[44:47], a[24:27], v[252:255]
ds_read_b128 a[24:27], v4 offset:14336
v_mfma_f32_16x16x32_bf16 v[192:195], v[32:35], a[28:31], v[192:195]
v_mfma_f32_16x16x32_bf16 v[196:199], v[36:39], a[28:31], v[196:199]
ds_read_b128 a[28:31], v7 offset:21504
v_mfma_f32_16x16x32_bf16 v[88:91], a[192:195], a[0:3], v[88:91]
ds_write_b64 v6, a[40:41] offset:0
v_mfma_f32_16x16x32_bf16 v[92:95], a[196:199], a[0:3], v[92:95]
v_mfma_f32_16x16x32_bf16 v[200:203], a[200:203], a[0:3], v[200:203]
ds_write_b64 v6, a[42:43] offset:8
v_mfma_f32_16x16x32_bf16 v[204:207], a[204:207], a[0:3], v[204:207]
ds_read_b128 a[0:3], v4 offset:15360
s_waitcnt lgkmcnt(7)
s_nop 0
v_mfma_f32_16x16x32_bf16 v[144:147], a[192:195], a[4:7], v[144:147]
ds_write_b64 v6, a[44:45] offset:512
v_mfma_f32_16x16x32_bf16 v[148:151], a[196:199], a[4:7], v[148:151]
ds_read_b128 a[4:7], v7 offset:22528
v_mfma_f32_16x16x32_bf16 v[96:99], a[192:195], a[8:11], v[96:99]
ds_write_b64 v6, a[46:47] offset:520
v_mfma_f32_16x16x32_bf16 v[100:103], a[196:199], a[8:11], v[100:103]
ds_write_b64 v6, a[160:161] offset:2048
v_mfma_f32_16x16x32_bf16 v[208:211], a[200:203], a[8:11], v[208:211]
ds_write_b64 v6, a[162:163] offset:2056
v_mfma_f32_16x16x32_bf16 v[212:215], a[204:207], a[8:11], v[212:215]
ds_read_b128 a[8:11], v4 offset:16384
v_mfma_f32_16x16x32_bf16 v[152:155], a[192:195], a[12:15], v[152:155]
ds_write_b64 v6, a[164:165] offset:2560
v_mfma_f32_16x16x32_bf16 v[156:159], a[196:199], a[12:15], v[156:159]
ds_read_b128 a[12:15], v7 offset:23552
s_waitcnt lgkmcnt(12)
s_nop 0
v_mfma_f32_16x16x32_bf16 v[104:107], a[192:195], a[16:19], v[104:107]
ds_write_b64 v6, a[166:167] offset:2568
v_mfma_f32_16x16x32_bf16 v[108:111], a[196:199], a[16:19], v[108:111]
v_mfma_f32_16x16x32_bf16 v[216:219], a[200:203], a[16:19], v[216:219]
ds_write_b64 v6, a[168:169] offset:4096
v_mfma_f32_16x16x32_bf16 v[220:223], a[204:207], a[16:19], v[220:223]
ds_read_b128 a[16:19], v4 offset:28672
v_mfma_f32_16x16x32_bf16 v[160:163], a[192:195], a[20:23], v[160:163]
ds_write_b64 v6, a[170:171] offset:4104
v_mfma_f32_16x16x32_bf16 v[164:167], a[196:199], a[20:23], v[164:167]
ds_read_b128 a[20:23], v7 offset:35840
v_mfma_f32_16x16x32_bf16 v[88:91], a[208:211], a[24:27], v[88:91]
ds_write_b64 v6, a[172:173] offset:4608
v_mfma_f32_16x16x32_bf16 v[92:95], a[212:215], a[24:27], v[92:95]
ds_write_b64 v6, a[174:175] offset:4616
v_mfma_f32_16x16x32_bf16 v[200:203], a[216:219], a[24:27], v[200:203]
ds_write_b64 v6, a[176:177] offset:6144
v_mfma_f32_16x16x32_bf16 v[204:207], a[220:223], a[24:27], v[204:207]
ds_read_b128 a[24:27], v4 offset:29696
s_waitcnt lgkmcnt(15)
s_nop 0
v_mfma_f32_16x16x32_bf16 v[144:147], a[208:211], a[28:31], v[144:147]
ds_write_b64 v6, a[178:179] offset:6152
v_mfma_f32_16x16x32_bf16 v[148:151], a[212:215], a[28:31], v[148:151]
ds_read_b128 a[28:31], v7 offset:36864
v_mfma_f32_16x16x32_bf16 v[96:99], a[208:211], a[0:3], v[96:99]
ds_write_b64 v6, a[180:181] offset:6656
v_mfma_f32_16x16x32_bf16 v[100:103], a[212:215], a[0:3], v[100:103]
v_mfma_f32_16x16x32_bf16 v[208:211], a[216:219], a[0:3], v[208:211]
ds_write_b64 v6, a[182:183] offset:6664
v_mfma_f32_16x16x32_bf16 v[212:215], a[220:223], a[0:3], v[212:215]
ds_read_b128 a[0:3], v4 offset:30720
v_mfma_f32_16x16x32_bf16 v[152:155], a[208:211], a[4:7], v[152:155]
ds_write_b64 v6, a[248:249] offset:8192
v_mfma_f32_16x16x32_bf16 v[156:159], a[212:215], a[4:7], v[156:159]
ds_read_b128 a[4:7], v7 offset:37888
s_waitcnt lgkmcnt(13)
s_nop 0
v_mfma_f32_16x16x32_bf16 v[104:107], a[208:211], a[8:11], v[104:107]
ds_write_b64 v6, a[250:251] offset:8200
v_mfma_f32_16x16x32_bf16 v[108:111], a[212:215], a[8:11], v[108:111]
ds_write_b64 v6, a[252:253] offset:8704
v_mfma_f32_16x16x32_bf16 v[216:219], a[216:219], a[8:11], v[216:219]
ds_write_b64 v6, a[254:255] offset:8712
v_mfma_f32_16x16x32_bf16 v[220:223], a[220:223], a[8:11], v[220:223]
ds_read_b128 a[8:11], v4 offset:43008
v_mfma_f32_16x16x32_bf16 v[160:163], a[208:211], a[12:15], v[160:163]
ds_write_b64 v6, a[152:153] offset:10240
v_mfma_f32_16x16x32_bf16 v[164:167], a[212:215], a[12:15], v[164:167]
ds_read_b128 a[12:15], v7 offset:50176
v_mfma_f32_16x16x32_bf16 v[88:91], a[224:227], a[16:19], v[88:91]
ds_write_b64 v6, a[154:155] offset:10248
v_mfma_f32_16x16x32_bf16 v[92:95], a[228:231], a[16:19], v[92:95]
v_mfma_f32_16x16x32_bf16 v[200:203], a[232:235], a[16:19], v[200:203]
ds_write_b64 v6, a[156:157] offset:10752
v_mfma_f32_16x16x32_bf16 v[204:207], a[236:239], a[16:19], v[204:207]
ds_read_b128 a[16:19], v4 offset:44032
s_waitcnt lgkmcnt(14)
s_nop 0
v_mfma_f32_16x16x32_bf16 v[144:147], a[224:227], a[20:23], v[144:147]
ds_write_b64 v6, a[158:159] offset:10760
v_mfma_f32_16x16x32_bf16 v[148:151], a[228:231], a[20:23], v[148:151]
ds_read_b128 a[20:23], v7 offset:51200
v_mfma_f32_16x16x32_bf16 v[96:99], a[224:227], a[24:27], v[96:99]
ds_write_b64 v6, a[184:185] offset:12288
v_mfma_f32_16x16x32_bf16 v[100:103], a[228:231], a[24:27], v[100:103]
ds_write_b64 v6, a[186:187] offset:12296
v_mfma_f32_16x16x32_bf16 v[208:211], a[232:235], a[24:27], v[208:211]
ds_write_b64 v6, a[188:189] offset:12800
v_mfma_f32_16x16x32_bf16 v[212:215], a[236:239], a[24:27], v[212:215]
ds_read_b128 a[24:27], v4 offset:45056
v_mfma_f32_16x16x32_bf16 v[152:155], a[224:227], a[28:31], v[152:155]
ds_write_b64 v6, a[190:191] offset:12808
v_mfma_f32_16x16x32_bf16 v[156:159], a[228:231], a[28:31], v[156:159]
ds_read_b128 a[28:31], v7 offset:52224
s_waitcnt lgkmcnt(13)
s_nop 0
v_mfma_f32_16x16x32_bf16 v[104:107], a[224:227], a[0:3], v[104:107]
v_mfma_f32_16x16x32_bf16 v[108:111], a[228:231], a[0:3], v[108:111]
v_mfma_f32_16x16x32_bf16 v[216:219], a[232:235], a[0:3], v[216:219]
v_mfma_f32_16x16x32_bf16 v[220:223], a[236:239], a[0:3], v[220:223]
v_mfma_f32_16x16x32_bf16 v[160:163], a[224:227], a[4:7], v[160:163]
v_mfma_f32_16x16x32_bf16 v[164:167], a[228:231], a[4:7], v[164:167]
v_mfma_f32_16x16x32_bf16 v[88:91], a[240:243], a[8:11], v[88:91]
v_mfma_f32_16x16x32_bf16 v[92:95], a[244:247], a[8:11], v[92:95]
v_mfma_f32_16x16x32_bf16 v[200:203], a[96:99], a[8:11], v[200:203]
v_mfma_f32_16x16x32_bf16 v[204:207], a[100:103], a[8:11], v[204:207]
s_waitcnt lgkmcnt(0)
s_barrier
ds_read_b128 a[0:3], v13 offset:0
ds_read_b128 a[4:7], v13 offset:14336
ds_read_b128 a[8:11], v13 offset:28672
v_mfma_f32_16x16x32_bf16 v[144:147], a[240:243], a[12:15], v[144:147]
v_mfma_f32_16x16x32_bf16 v[148:151], a[244:247], a[12:15], v[148:151]
ds_read_b128 a[12:15], v13 offset:43008
v_mfma_f32_16x16x32_bf16 v[96:99], a[240:243], a[16:19], v[96:99]
v_mfma_f32_16x16x32_bf16 v[100:103], a[244:247], a[16:19], v[100:103]
v_mfma_f32_16x16x32_bf16 v[208:211], a[96:99], a[16:19], v[208:211]
v_mfma_f32_16x16x32_bf16 v[212:215], a[100:103], a[16:19], v[212:215]
ds_read_b128 a[16:19], v4 offset:3072
v_mfma_f32_16x16x32_bf16 v[152:155], a[240:243], a[20:23], v[152:155]
v_mfma_f32_16x16x32_bf16 v[156:159], a[244:247], a[20:23], v[156:159]
ds_read_b128 a[20:23], v4 offset:17408
s_waitcnt lgkmcnt(5)
s_nop 0
v_mfma_f32_16x16x32_bf16 v[104:107], a[240:243], a[24:27], v[104:107]
v_mfma_f32_16x16x32_bf16 v[108:111], a[244:247], a[24:27], v[108:111]
v_mfma_f32_16x16x32_bf16 v[216:219], a[96:99], a[24:27], v[216:219]
v_mfma_f32_16x16x32_bf16 v[220:223], a[100:103], a[24:27], v[220:223]
ds_read_b128 a[24:27], v4 offset:31744
v_mfma_f32_16x16x32_bf16 v[160:163], a[240:243], a[28:31], v[160:163]
v_mfma_f32_16x16x32_bf16 v[164:167], a[244:247], a[28:31], v[164:167]
ds_read_b128 a[28:31], v4 offset:46080
v_mfma_f32_16x16x32_bf16 v[88:91], a[104:107], a[0:3], v[88:91]
v_mfma_f32_16x16x32_bf16 v[92:95], a[108:111], a[0:3], v[92:95]
v_mfma_f32_16x16x32_bf16 v[200:203], a[112:115], a[0:3], v[200:203]
v_mfma_f32_16x16x32_bf16 v[204:207], a[116:119], a[0:3], v[204:207]
ds_read_b128 a[0:3], v13 offset:3072
s_waitcnt lgkmcnt(5)
s_nop 0
v_mfma_f32_16x16x32_bf16 v[88:91], a[120:123], a[4:7], v[88:91]
v_mfma_f32_16x16x32_bf16 v[92:95], a[124:127], a[4:7], v[92:95]
v_mfma_f32_16x16x32_bf16 v[200:203], a[128:131], a[4:7], v[200:203]
v_mfma_f32_16x16x32_bf16 v[204:207], a[132:135], a[4:7], v[204:207]
ds_read_b128 a[4:7], v13 offset:17408
s_waitcnt vmcnt(0)
s_nop 0
v_mfma_f32_16x16x32_bf16 v[88:91], a[136:139], a[8:11], v[88:91]
v_mfma_f32_16x16x32_bf16 v[92:95], a[140:143], a[8:11], v[92:95]
v_mfma_f32_16x16x32_bf16 v[200:203], a[32:35], a[8:11], v[200:203]
v_mfma_f32_16x16x32_bf16 v[204:207], a[36:39], a[8:11], v[204:207]
ds_read_b128 a[8:11], v13 offset:31744
v_mfma_f32_16x16x32_bf16 v[88:91], a[48:51], a[12:15], v[88:91]
v_mfma_f32_16x16x32_bf16 v[92:95], a[52:55], a[12:15], v[92:95]
v_mfma_f32_16x16x32_bf16 v[200:203], a[56:59], a[12:15], v[200:203]
v_mfma_f32_16x16x32_bf16 v[204:207], a[60:63], a[12:15], v[204:207]
ds_read_b128 a[12:15], v13 offset:46080
s_waitcnt lgkmcnt(5)
s_nop 0
v_mfma_f32_16x16x32_bf16 v[112:115], a[192:195], a[16:19], v[112:115]
v_mfma_f32_16x16x32_bf16 v[116:119], a[196:199], a[16:19], v[116:119]
v_mfma_f32_16x16x32_bf16 v[224:227], a[200:203], a[16:19], v[224:227]
v_mfma_f32_16x16x32_bf16 v[228:231], a[204:207], a[16:19], v[228:231]
ds_read_b128 a[16:19], v15 offset:7168
v_cvt_pk_bf16_f32 v16, v88, v89
v_mfma_f32_16x16x32_bf16 v[112:115], a[208:211], a[20:23], v[112:115]
v_cvt_pk_bf16_f32 v17, v90, v91
v_mfma_f32_16x16x32_bf16 v[116:119], a[212:215], a[20:23], v[116:119]
ds_write_b64 v81, v[16:17] offset:0
v_mfma_f32_16x16x32_bf16 v[224:227], a[216:219], a[20:23], v[224:227]
v_cvt_pk_bf16_f32 v18, v92, v93
v_cvt_pk_bf16_f32 v19, v94, v95
v_mfma_f32_16x16x32_bf16 v[228:231], a[220:223], a[20:23], v[228:231]
ds_read_b128 a[20:23], v15 offset:21504
v_mfma_f32_16x16x32_bf16 v[112:115], a[224:227], a[24:27], v[112:115]
ds_write_b64 v82, v[18:19] offset:0
v_mfma_f32_16x16x32_bf16 v[116:119], a[228:231], a[24:27], v[116:119]
ds_read_b128 v[28:31], v83 offset:0
v_cvt_pk_bf16_f32 v20, v200, v201
v_mfma_f32_16x16x32_bf16 v[224:227], a[232:235], a[24:27], v[224:227]
v_cvt_pk_bf16_f32 v21, v202, v203
v_mfma_f32_16x16x32_bf16 v[228:231], a[236:239], a[24:27], v[228:231]
ds_read_b128 a[24:27], v15 offset:35840
s_waitcnt lgkmcnt(8)
s_nop 0
v_mfma_f32_16x16x32_bf16 v[112:115], a[240:243], a[28:31], v[112:115]
ds_write_b64 v81, v[20:21] offset:1024
v_mfma_f32_16x16x32_bf16 v[116:119], a[244:247], a[28:31], v[116:119]
v_cvt_pk_bf16_f32 v22, v204, v205
v_cvt_pk_bf16_f32 v23, v206, v207
v_mfma_f32_16x16x32_bf16 v[224:227], a[96:99], a[28:31], v[224:227]
ds_write_b64 v82, v[22:23] offset:1024
v_mfma_f32_16x16x32_bf16 v[228:231], a[100:103], a[28:31], v[228:231]
ds_read_b128 a[28:31], v15 offset:50176
ds_read_b128 v[32:35], v83 offset:1024
v_mfma_f32_16x16x32_bf16 v[112:115], a[104:107], a[0:3], v[112:115]
v_mfma_f32_16x16x32_bf16 v[116:119], a[108:111], a[0:3], v[116:119]
v_mfma_f32_16x16x32_bf16 v[224:227], a[112:115], a[0:3], v[224:227]
v_mfma_f32_16x16x32_bf16 v[228:231], a[116:119], a[0:3], v[228:231]
ds_read_b128 a[0:3], v4 offset:4096
v_mfma_f32_16x16x32_bf16 v[112:115], a[120:123], a[4:7], v[112:115]
v_mfma_f32_16x16x32_bf16 v[116:119], a[124:127], a[4:7], v[116:119]
v_mfma_f32_16x16x32_bf16 v[224:227], a[128:131], a[4:7], v[224:227]
v_mfma_f32_16x16x32_bf16 v[228:231], a[132:135], a[4:7], v[228:231]
ds_read_b128 a[4:7], v4 offset:18432
s_waitcnt lgkmcnt(11)
v_mfma_f32_16x16x32_bf16 v[112:115], a[136:139], a[8:11], v[112:115]
s_waitcnt lgkmcnt(7)
buffer_store_dwordx4 v[28:31], v11, s[28:31], s4 offen sc1 nt
v_mfma_f32_16x16x32_bf16 v[116:119], a[140:143], a[8:11], v[116:119]
v_mfma_f32_16x16x32_bf16 v[224:227], a[32:35], a[8:11], v[224:227]
v_mfma_f32_16x16x32_bf16 v[228:231], a[36:39], a[8:11], v[228:231]
ds_read_b128 a[8:11], v4 offset:32768
v_mfma_f32_16x16x32_bf16 v[112:115], a[48:51], a[12:15], v[112:115]
v_mfma_f32_16x16x32_bf16 v[116:119], a[52:55], a[12:15], v[116:119]
v_mfma_f32_16x16x32_bf16 v[224:227], a[56:59], a[12:15], v[224:227]
v_mfma_f32_16x16x32_bf16 v[228:231], a[60:63], a[12:15], v[228:231]
ds_read_b128 a[12:15], v4 offset:47104
v_mfma_f32_16x16x32_bf16 v[144:147], a[104:107], a[16:19], v[144:147]
s_waitcnt lgkmcnt(4)
s_nop 0
buffer_store_dwordx4 v[32:35], v11, s[28:31], s18 offen sc1 nt
v_mfma_f32_16x16x32_bf16 v[148:151], a[108:111], a[16:19], v[148:151]
ds_read_b128 a[16:19], v13 offset:4096
v_mfma_f32_16x16x32_bf16 v[144:147], a[120:123], a[20:23], v[144:147]
v_mfma_f32_16x16x32_bf16 v[148:151], a[124:127], a[20:23], v[148:151]
ds_read_b128 a[20:23], v13 offset:18432
v_cvt_pk_bf16_f32 v24, v112, v113
v_mfma_f32_16x16x32_bf16 v[144:147], a[136:139], a[24:27], v[144:147]
v_cvt_pk_bf16_f32 v25, v114, v115
v_mfma_f32_16x16x32_bf16 v[148:151], a[140:143], a[24:27], v[148:151]
ds_read_b128 a[24:27], v13 offset:32768
v_mfma_f32_16x16x32_bf16 v[144:147], a[48:51], a[28:31], v[144:147]
ds_write_b64 v81, v[24:25] offset:2048
v_mfma_f32_16x16x32_bf16 v[148:151], a[52:55], a[28:31], v[148:151]
ds_read_b128 a[28:31], v13 offset:47104
s_waitcnt lgkmcnt(6)
s_nop 0
v_mfma_f32_16x16x32_bf16 v[120:123], a[192:195], a[0:3], v[120:123]
v_cvt_pk_bf16_f32 v26, v116, v117
v_cvt_pk_bf16_f32 v27, v118, v119
v_mfma_f32_16x16x32_bf16 v[124:127], a[196:199], a[0:3], v[124:127]
ds_write_b64 v82, v[26:27] offset:2048
v_mfma_f32_16x16x32_bf16 v[232:235], a[200:203], a[0:3], v[232:235]
ds_read_b128 v[36:39], v83 offset:2048
v_cvt_pk_bf16_f32 v16, v224, v225
v_mfma_f32_16x16x32_bf16 v[236:239], a[204:207], a[0:3], v[236:239]
ds_read_b128 a[0:3], v13 offset:1024
v_cvt_pk_bf16_f32 v17, v226, v227
v_mfma_f32_16x16x32_bf16 v[120:123], a[208:211], a[4:7], v[120:123]
ds_write_b64 v81, v[16:17] offset:3072
v_mfma_f32_16x16x32_bf16 v[124:127], a[212:215], a[4:7], v[124:127]
v_cvt_pk_bf16_f32 v18, v228, v229
v_cvt_pk_bf16_f32 v19, v230, v231
v_mfma_f32_16x16x32_bf16 v[232:235], a[216:219], a[4:7], v[232:235]
ds_write_b64 v82, v[18:19] offset:3072
v_mfma_f32_16x16x32_bf16 v[236:239], a[220:223], a[4:7], v[236:239]
ds_read_b128 a[4:7], v13 offset:15360
ds_read_b128 v[40:43], v83 offset:3072
v_mfma_f32_16x16x32_bf16 v[120:123], a[224:227], a[8:11], v[120:123]
v_cvt_pk_bf16_f32 v20, v144, v145
v_cvt_pk_bf16_f32 v21, v146, v147
v_mfma_f32_16x16x32_bf16 v[124:127], a[228:231], a[8:11], v[124:127]
ds_write_b64 v81, v[20:21] offset:4096
v_mfma_f32_16x16x32_bf16 v[232:235], a[232:235], a[8:11], v[232:235]
v_cvt_pk_bf16_f32 v22, v148, v149
v_cvt_pk_bf16_f32 v23, v150, v151
v_mfma_f32_16x16x32_bf16 v[236:239], a[236:239], a[8:11], v[236:239]
ds_read_b128 a[8:11], v13 offset:29696
s_waitcnt lgkmcnt(12)
s_nop 0
v_mfma_f32_16x16x32_bf16 v[120:123], a[240:243], a[12:15], v[120:123]
ds_write_b64 v82, v[22:23] offset:4096
v_mfma_f32_16x16x32_bf16 v[124:127], a[244:247], a[12:15], v[124:127]
ds_read_b128 v[44:47], v83 offset:4096
v_mfma_f32_16x16x32_bf16 v[232:235], a[96:99], a[12:15], v[232:235]
v_mfma_f32_16x16x32_bf16 v[236:239], a[100:103], a[12:15], v[236:239]
ds_read_b128 a[12:15], v13 offset:44032
v_mfma_f32_16x16x32_bf16 v[120:123], a[104:107], a[16:19], v[120:123]
s_waitcnt lgkmcnt(10)
s_nop 0
buffer_store_dwordx4 v[36:39], v11, s[28:31], s7 offen sc1 nt
v_mfma_f32_16x16x32_bf16 v[124:127], a[108:111], a[16:19], v[124:127]
v_mfma_f32_16x16x32_bf16 v[232:235], a[112:115], a[16:19], v[232:235]
v_mfma_f32_16x16x32_bf16 v[236:239], a[116:119], a[16:19], v[236:239]
ds_read_b128 a[16:19], v7 offset:10240
v_mfma_f32_16x16x32_bf16 v[120:123], a[120:123], a[20:23], v[120:123]
v_mfma_f32_16x16x32_bf16 v[124:127], a[124:127], a[20:23], v[124:127]
v_mfma_f32_16x16x32_bf16 v[232:235], a[128:131], a[20:23], v[232:235]
v_mfma_f32_16x16x32_bf16 v[236:239], a[132:135], a[20:23], v[236:239]
ds_read_b128 a[20:23], v7 offset:24576
s_waitcnt lgkmcnt(11)
v_mfma_f32_16x16x32_bf16 v[120:123], a[136:139], a[24:27], v[120:123]
s_waitcnt lgkmcnt(7)
buffer_store_dwordx4 v[40:43], v11, s[28:31], s21 offen sc1 nt
v_mfma_f32_16x16x32_bf16 v[124:127], a[140:143], a[24:27], v[124:127]
v_mfma_f32_16x16x32_bf16 v[232:235], a[32:35], a[24:27], v[232:235]
v_mfma_f32_16x16x32_bf16 v[236:239], a[36:39], a[24:27], v[236:239]
ds_read_b128 a[24:27], v7 offset:38912
v_mfma_f32_16x16x32_bf16 v[120:123], a[48:51], a[28:31], v[120:123]
v_mfma_f32_16x16x32_bf16 v[124:127], a[52:55], a[28:31], v[124:127]
v_mfma_f32_16x16x32_bf16 v[232:235], a[56:59], a[28:31], v[232:235]
v_mfma_f32_16x16x32_bf16 v[236:239], a[60:63], a[28:31], v[236:239]
ds_read_b128 a[28:31], v7 offset:53248
v_mfma_f32_16x16x32_bf16 v[96:99], a[104:107], a[0:3], v[96:99]
s_waitcnt lgkmcnt(5)
s_nop 0
buffer_store_dwordx4 v[44:47], v11, s[28:31], s11 offen sc1 nt
v_mfma_f32_16x16x32_bf16 v[100:103], a[108:111], a[0:3], v[100:103]
v_mfma_f32_16x16x32_bf16 v[208:211], a[112:115], a[0:3], v[208:211]
v_mfma_f32_16x16x32_bf16 v[212:215], a[116:119], a[0:3], v[212:215]
ds_read_b128 a[0:3], v15 offset:10240
s_waitcnt lgkmcnt(5)
s_nop 0
v_mfma_f32_16x16x32_bf16 v[96:99], a[120:123], a[4:7], v[96:99]
v_cvt_pk_bf16_f32 v24, v120, v121
v_cvt_pk_bf16_f32 v25, v122, v123
v_mfma_f32_16x16x32_bf16 v[100:103], a[124:127], a[4:7], v[100:103]
ds_write_b64 v81, v[24:25] offset:5120
v_mfma_f32_16x16x32_bf16 v[208:211], a[128:131], a[4:7], v[208:211]
v_cvt_pk_bf16_f32 v26, v124, v125
v_cvt_pk_bf16_f32 v27, v126, v127
v_mfma_f32_16x16x32_bf16 v[212:215], a[132:135], a[4:7], v[212:215]
ds_read_b128 a[4:7], v15 offset:24576
v_mfma_f32_16x16x32_bf16 v[96:99], a[136:139], a[8:11], v[96:99]
ds_write_b64 v82, v[26:27] offset:5120
v_mfma_f32_16x16x32_bf16 v[100:103], a[140:143], a[8:11], v[100:103]
ds_read_b128 v[48:51], v83 offset:5120
v_cvt_pk_bf16_f32 v16, v232, v233
v_mfma_f32_16x16x32_bf16 v[208:211], a[32:35], a[8:11], v[208:211]
v_cvt_pk_bf16_f32 v17, v234, v235
v_mfma_f32_16x16x32_bf16 v[212:215], a[36:39], a[8:11], v[212:215]
ds_read_b128 a[8:11], v15 offset:38912
v_mfma_f32_16x16x32_bf16 v[96:99], a[48:51], a[12:15], v[96:99]
ds_write_b64 v81, v[16:17] offset:6144
v_mfma_f32_16x16x32_bf16 v[100:103], a[52:55], a[12:15], v[100:103]
v_cvt_pk_bf16_f32 v18, v236, v237
v_cvt_pk_bf16_f32 v19, v238, v239
v_mfma_f32_16x16x32_bf16 v[208:211], a[56:59], a[12:15], v[208:211]
ds_write_b64 v82, v[18:19] offset:6144
v_mfma_f32_16x16x32_bf16 v[212:215], a[60:63], a[12:15], v[212:215]
ds_read_b128 a[12:15], v15 offset:53248
s_waitcnt lgkmcnt(10)
s_nop 0
v_mfma_f32_16x16x32_bf16 v[168:171], a[192:195], a[16:19], v[168:171]
ds_read_b128 v[52:55], v83 offset:6144
v_mfma_f32_16x16x32_bf16 v[172:175], a[196:199], a[16:19], v[172:175]
ds_read_b128 a[16:19], v15 offset:8192
v_mfma_f32_16x16x32_bf16 v[168:171], a[208:211], a[20:23], v[168:171]
v_mfma_f32_16x16x32_bf16 v[172:175], a[212:215], a[20:23], v[172:175]
ds_read_b128 a[20:23], v15 offset:22528
v_cvt_pk_bf16_f32 v20, v96, v97
v_mfma_f32_16x16x32_bf16 v[168:171], a[224:227], a[24:27], v[168:171]
v_cvt_pk_bf16_f32 v21, v98, v99
v_mfma_f32_16x16x32_bf16 v[172:175], a[228:231], a[24:27], v[172:175]
ds_read_b128 a[24:27], v15 offset:36864
s_waitcnt lgkmcnt(10)
s_nop 0
v_mfma_f32_16x16x32_bf16 v[168:171], a[240:243], a[28:31], v[168:171]
ds_write_b64 v81, v[20:21] offset:7168
v_mfma_f32_16x16x32_bf16 v[172:175], a[244:247], a[28:31], v[172:175]
ds_read_b128 a[28:31], v15 offset:51200
v_cvt_pk_bf16_f32 v22, v100, v101
v_mfma_f32_16x16x32_bf16 v[168:171], a[104:107], a[0:3], v[168:171]
s_waitcnt lgkmcnt(10)
s_nop 0
buffer_store_dwordx4 v[48:51], v11, s[28:31], s8 offen sc1 nt
v_mfma_f32_16x16x32_bf16 v[172:175], a[108:111], a[0:3], v[172:175]
ds_read_b128 a[0:3], v4 offset:5120
v_cvt_pk_bf16_f32 v23, v102, v103
v_mfma_f32_16x16x32_bf16 v[168:171], a[120:123], a[4:7], v[168:171]
ds_write_b64 v82, v[22:23] offset:7168
v_mfma_f32_16x16x32_bf16 v[172:175], a[124:127], a[4:7], v[172:175]
ds_read_b128 a[4:7], v4 offset:19456
s_waitcnt lgkmcnt(7)
s_nop 0
v_mfma_f32_16x16x32_bf16 v[168:171], a[136:139], a[8:11], v[168:171]
ds_read_b128 v[56:59], v83 offset:7168
v_cvt_pk_bf16_f32 v24, v208, v209
v_mfma_f32_16x16x32_bf16 v[172:175], a[140:143], a[8:11], v[172:175]
ds_read_b128 a[8:11], v4 offset:33792
v_cvt_pk_bf16_f32 v25, v210, v211
v_mfma_f32_16x16x32_bf16 v[168:171], a[48:51], a[12:15], v[168:171]
ds_write_b64 v81, v[24:25] offset:8192
v_mfma_f32_16x16x32_bf16 v[172:175], a[52:55], a[12:15], v[172:175]
ds_read_b128 a[12:15], v4 offset:48128
v_cvt_pk_bf16_f32 v26, v212, v213
v_mfma_f32_16x16x32_bf16 v[152:155], a[104:107], a[16:19], v[152:155]
buffer_store_dwordx4 v[52:55], v11, s[28:31], s58 offen sc1 nt
v_mfma_f32_16x16x32_bf16 v[156:159], a[108:111], a[16:19], v[156:159]
ds_read_b128 a[16:19], v13 offset:5120
s_waitcnt lgkmcnt(8)
s_nop 0
v_mfma_f32_16x16x32_bf16 v[152:155], a[120:123], a[20:23], v[152:155]
v_cvt_pk_bf16_f32 v27, v214, v215
v_mfma_f32_16x16x32_bf16 v[156:159], a[124:127], a[20:23], v[156:159]
ds_read_b128 a[20:23], v13 offset:19456
v_mfma_f32_16x16x32_bf16 v[152:155], a[136:139], a[24:27], v[152:155]
ds_write_b64 v82, v[26:27] offset:8192
v_mfma_f32_16x16x32_bf16 v[156:159], a[140:143], a[24:27], v[156:159]
ds_read_b128 a[24:27], v13 offset:33792
ds_read_b128 v[60:63], v83 offset:8192
v_mfma_f32_16x16x32_bf16 v[152:155], a[48:51], a[28:31], v[152:155]
v_cvt_pk_bf16_f32 v16, v168, v169
v_cvt_pk_bf16_f32 v17, v170, v171
v_mfma_f32_16x16x32_bf16 v[156:159], a[52:55], a[28:31], v[156:159]
ds_read_b128 a[28:31], v13 offset:48128
s_waitcnt lgkmcnt(8)
s_nop 0
v_mfma_f32_16x16x32_bf16 v[128:131], a[192:195], a[0:3], v[128:131]
ds_write_b64 v81, v[16:17] offset:0
v_mfma_f32_16x16x32_bf16 v[132:135], a[196:199], a[0:3], v[132:135]
v_cvt_pk_bf16_f32 v18, v172, v173
v_cvt_pk_bf16_f32 v19, v174, v175
v_mfma_f32_16x16x32_bf16 v[240:243], a[200:203], a[0:3], v[240:243]
buffer_store_dwordx4 v[56:59], v11, s[28:31], s5 offen sc1 nt
v_mfma_f32_16x16x32_bf16 v[244:247], a[204:207], a[0:3], v[244:247]
ds_read_b128 a[0:3], v13 offset:2048
v_mfma_f32_16x16x32_bf16 v[128:131], a[208:211], a[4:7], v[128:131]
ds_write_b64 v82, v[18:19] offset:0
v_mfma_f32_16x16x32_bf16 v[132:135], a[212:215], a[4:7], v[132:135]
ds_read_b128 v[28:31], v83 offset:0
v_cvt_pk_bf16_f32 v20, v152, v153
v_mfma_f32_16x16x32_bf16 v[240:243], a[216:219], a[4:7], v[240:243]
v_cvt_pk_bf16_f32 v21, v154, v155
v_mfma_f32_16x16x32_bf16 v[244:247], a[220:223], a[4:7], v[244:247]
ds_read_b128 a[4:7], v13 offset:16384
v_mfma_f32_16x16x32_bf16 v[128:131], a[224:227], a[8:11], v[128:131]
ds_write_b64 v81, v[20:21] offset:1024
v_mfma_f32_16x16x32_bf16 v[132:135], a[228:231], a[8:11], v[132:135]
v_cvt_pk_bf16_f32 v22, v156, v157
v_cvt_pk_bf16_f32 v23, v158, v159
v_mfma_f32_16x16x32_bf16 v[240:243], a[232:235], a[8:11], v[240:243]
ds_write_b64 v82, v[22:23] offset:1024
v_mfma_f32_16x16x32_bf16 v[244:247], a[236:239], a[8:11], v[244:247]
ds_read_b128 a[8:11], v13 offset:30720
s_waitcnt lgkmcnt(12)
v_mfma_f32_16x16x32_bf16 v[128:131], a[240:243], a[12:15], v[128:131]
s_waitcnt lgkmcnt(9)
buffer_store_dwordx4 v[60:63], v11, s[28:31], s19 offen sc1 nt
v_mfma_f32_16x16x32_bf16 v[132:135], a[244:247], a[12:15], v[132:135]
ds_read_b128 v[32:35], v83 offset:1024
v_mfma_f32_16x16x32_bf16 v[240:243], a[96:99], a[12:15], v[240:243]
v_mfma_f32_16x16x32_bf16 v[244:247], a[100:103], a[12:15], v[244:247]
ds_read_b128 a[12:15], v13 offset:45056
v_mfma_f32_16x16x32_bf16 v[128:131], a[104:107], a[16:19], v[128:131]
v_mfma_f32_16x16x32_bf16 v[132:135], a[108:111], a[16:19], v[132:135]
v_mfma_f32_16x16x32_bf16 v[240:243], a[112:115], a[16:19], v[240:243]
v_mfma_f32_16x16x32_bf16 v[244:247], a[116:119], a[16:19], v[244:247]
ds_read_b128 a[16:19], v7 offset:11264
v_mfma_f32_16x16x32_bf16 v[128:131], a[120:123], a[20:23], v[128:131]
s_waitcnt lgkmcnt(7)
s_nop 0
buffer_store_dwordx4 v[28:31], v11, s[28:31], s14 offen sc1 nt
v_mfma_f32_16x16x32_bf16 v[132:135], a[124:127], a[20:23], v[132:135]
v_mfma_f32_16x16x32_bf16 v[240:243], a[128:131], a[20:23], v[240:243]
v_mfma_f32_16x16x32_bf16 v[244:247], a[132:135], a[20:23], v[244:247]
ds_read_b128 a[20:23], v7 offset:25600
v_mfma_f32_16x16x32_bf16 v[128:131], a[136:139], a[24:27], v[128:131]
v_mfma_f32_16x16x32_bf16 v[132:135], a[140:143], a[24:27], v[132:135]
v_mfma_f32_16x16x32_bf16 v[240:243], a[32:35], a[24:27], v[240:243]
v_mfma_f32_16x16x32_bf16 v[244:247], a[36:39], a[24:27], v[244:247]
ds_read_b128 a[24:27], v7 offset:39936
v_mfma_f32_16x16x32_bf16 v[128:131], a[48:51], a[28:31], v[128:131]
s_waitcnt lgkmcnt(4)
s_nop 0
buffer_store_dwordx4 v[32:35], v11, s[28:31], s12 offen sc1 nt
v_mfma_f32_16x16x32_bf16 v[132:135], a[52:55], a[28:31], v[132:135]
v_mfma_f32_16x16x32_bf16 v[240:243], a[56:59], a[28:31], v[240:243]
v_mfma_f32_16x16x32_bf16 v[244:247], a[60:63], a[28:31], v[244:247]
ds_read_b128 a[28:31], v7 offset:54272
v_mfma_f32_16x16x32_bf16 v[104:107], a[104:107], a[0:3], v[104:107]
v_mfma_f32_16x16x32_bf16 v[108:111], a[108:111], a[0:3], v[108:111]
v_mfma_f32_16x16x32_bf16 v[216:219], a[112:115], a[0:3], v[216:219]
v_mfma_f32_16x16x32_bf16 v[220:223], a[116:119], a[0:3], v[220:223]
ds_read_b128 a[0:3], v15 offset:11264
s_waitcnt lgkmcnt(5)
s_nop 0
v_mfma_f32_16x16x32_bf16 v[104:107], a[120:123], a[4:7], v[104:107]
v_cvt_pk_bf16_f32 v24, v128, v129
v_cvt_pk_bf16_f32 v25, v130, v131
v_mfma_f32_16x16x32_bf16 v[108:111], a[124:127], a[4:7], v[108:111]
ds_write_b64 v81, v[24:25] offset:2048
v_mfma_f32_16x16x32_bf16 v[216:219], a[128:131], a[4:7], v[216:219]
v_cvt_pk_bf16_f32 v26, v132, v133
v_cvt_pk_bf16_f32 v27, v134, v135
v_mfma_f32_16x16x32_bf16 v[220:223], a[132:135], a[4:7], v[220:223]
ds_read_b128 a[4:7], v15 offset:25600
v_mfma_f32_16x16x32_bf16 v[104:107], a[136:139], a[8:11], v[104:107]
ds_write_b64 v82, v[26:27] offset:2048
v_mfma_f32_16x16x32_bf16 v[108:111], a[140:143], a[8:11], v[108:111]
ds_read_b128 v[36:39], v83 offset:2048
v_cvt_pk_bf16_f32 v16, v240, v241
v_mfma_f32_16x16x32_bf16 v[216:219], a[32:35], a[8:11], v[216:219]
v_cvt_pk_bf16_f32 v17, v242, v243
v_mfma_f32_16x16x32_bf16 v[220:223], a[36:39], a[8:11], v[220:223]
ds_read_b128 a[8:11], v15 offset:39936
v_mfma_f32_16x16x32_bf16 v[104:107], a[48:51], a[12:15], v[104:107]
ds_write_b64 v81, v[16:17] offset:3072
v_mfma_f32_16x16x32_bf16 v[108:111], a[52:55], a[12:15], v[108:111]
v_cvt_pk_bf16_f32 v18, v244, v245
v_cvt_pk_bf16_f32 v19, v246, v247
v_mfma_f32_16x16x32_bf16 v[216:219], a[56:59], a[12:15], v[216:219]
ds_write_b64 v82, v[18:19] offset:3072
v_mfma_f32_16x16x32_bf16 v[220:223], a[60:63], a[12:15], v[220:223]
ds_read_b128 a[12:15], v15 offset:54272
s_waitcnt lgkmcnt(10)
s_nop 0
v_mfma_f32_16x16x32_bf16 v[176:179], a[192:195], a[16:19], v[176:179]
ds_read_b128 v[40:43], v83 offset:3072
v_mfma_f32_16x16x32_bf16 v[180:183], a[196:199], a[16:19], v[180:183]
ds_read_b128 a[16:19], v15 offset:9216
v_mfma_f32_16x16x32_bf16 v[176:179], a[208:211], a[20:23], v[176:179]
v_mfma_f32_16x16x32_bf16 v[180:183], a[212:215], a[20:23], v[180:183]
ds_read_b128 a[20:23], v15 offset:23552
v_cvt_pk_bf16_f32 v20, v104, v105
v_mfma_f32_16x16x32_bf16 v[176:179], a[224:227], a[24:27], v[176:179]
v_cvt_pk_bf16_f32 v21, v106, v107
v_mfma_f32_16x16x32_bf16 v[180:183], a[228:231], a[24:27], v[180:183]
ds_read_b128 a[24:27], v15 offset:37888
s_waitcnt lgkmcnt(10)
s_nop 0
v_mfma_f32_16x16x32_bf16 v[176:179], a[240:243], a[28:31], v[176:179]
ds_write_b64 v81, v[20:21] offset:4096
v_mfma_f32_16x16x32_bf16 v[180:183], a[244:247], a[28:31], v[180:183]
ds_read_b128 a[28:31], v15 offset:52224
v_cvt_pk_bf16_f32 v22, v108, v109
v_mfma_f32_16x16x32_bf16 v[176:179], a[104:107], a[0:3], v[176:179]
s_waitcnt lgkmcnt(10)
s_nop 0
buffer_store_dwordx4 v[36:39], v11, s[28:31], s9 offen sc1 nt
v_mfma_f32_16x16x32_bf16 v[180:183], a[108:111], a[0:3], v[180:183]
ds_read_b128 a[0:3], v4 offset:6144
v_cvt_pk_bf16_f32 v23, v110, v111
v_mfma_f32_16x16x32_bf16 v[176:179], a[120:123], a[4:7], v[176:179]
ds_write_b64 v82, v[22:23] offset:4096
v_mfma_f32_16x16x32_bf16 v[180:183], a[124:127], a[4:7], v[180:183]
ds_read_b128 a[4:7], v4 offset:20480
s_waitcnt lgkmcnt(7)
s_nop 0
v_mfma_f32_16x16x32_bf16 v[176:179], a[136:139], a[8:11], v[176:179]
ds_read_b128 v[44:47], v83 offset:4096
v_cvt_pk_bf16_f32 v24, v216, v217
v_mfma_f32_16x16x32_bf16 v[180:183], a[140:143], a[8:11], v[180:183]
ds_read_b128 a[8:11], v4 offset:34816
v_cvt_pk_bf16_f32 v25, v218, v219
v_mfma_f32_16x16x32_bf16 v[176:179], a[48:51], a[12:15], v[176:179]
ds_write_b64 v81, v[24:25] offset:5120
v_mfma_f32_16x16x32_bf16 v[180:183], a[52:55], a[12:15], v[180:183]
ds_read_b128 a[12:15], v4 offset:49152
v_cvt_pk_bf16_f32 v26, v220, v221
v_mfma_f32_16x16x32_bf16 v[160:163], a[104:107], a[16:19], v[160:163]
buffer_store_dwordx4 v[40:43], v11, s[28:31], s59 offen sc1 nt
v_mfma_f32_16x16x32_bf16 v[164:167], a[108:111], a[16:19], v[164:167]
ds_read_b128 a[16:19], v13 offset:6144
s_waitcnt lgkmcnt(8)
s_nop 0
v_mfma_f32_16x16x32_bf16 v[160:163], a[120:123], a[20:23], v[160:163]
v_cvt_pk_bf16_f32 v27, v222, v223
v_mfma_f32_16x16x32_bf16 v[164:167], a[124:127], a[20:23], v[164:167]
ds_read_b128 a[20:23], v13 offset:20480
v_mfma_f32_16x16x32_bf16 v[160:163], a[136:139], a[24:27], v[160:163]
ds_write_b64 v82, v[26:27] offset:5120
v_mfma_f32_16x16x32_bf16 v[164:167], a[140:143], a[24:27], v[164:167]
ds_read_b128 a[24:27], v13 offset:34816
ds_read_b128 v[48:51], v83 offset:5120
v_mfma_f32_16x16x32_bf16 v[160:163], a[48:51], a[28:31], v[160:163]
v_cvt_pk_bf16_f32 v16, v176, v177
v_cvt_pk_bf16_f32 v17, v178, v179
v_mfma_f32_16x16x32_bf16 v[164:167], a[52:55], a[28:31], v[164:167]
ds_read_b128 a[28:31], v13 offset:49152
s_waitcnt lgkmcnt(8)
s_nop 0
v_mfma_f32_16x16x32_bf16 v[136:139], a[192:195], a[0:3], v[136:139]
ds_write_b64 v81, v[16:17] offset:6144
v_mfma_f32_16x16x32_bf16 v[140:143], a[196:199], a[0:3], v[140:143]
v_cvt_pk_bf16_f32 v18, v180, v181
v_cvt_pk_bf16_f32 v19, v182, v183
v_mfma_f32_16x16x32_bf16 v[248:251], a[200:203], a[0:3], v[248:251]
buffer_store_dwordx4 v[44:47], v11, s[28:31], s6 offen sc1 nt
v_mfma_f32_16x16x32_bf16 v[252:255], a[204:207], a[0:3], v[252:255]
ds_read_b128 a[0:3], v7 offset:12288
v_mfma_f32_16x16x32_bf16 v[136:139], a[208:211], a[4:7], v[136:139]
ds_write_b64 v82, v[18:19] offset:6144
v_mfma_f32_16x16x32_bf16 v[140:143], a[212:215], a[4:7], v[140:143]
ds_read_b128 v[52:55], v83 offset:6144
v_cvt_pk_bf16_f32 v20, v160, v161
v_mfma_f32_16x16x32_bf16 v[248:251], a[216:219], a[4:7], v[248:251]
v_cvt_pk_bf16_f32 v21, v162, v163
v_mfma_f32_16x16x32_bf16 v[252:255], a[220:223], a[4:7], v[252:255]
ds_read_b128 a[4:7], v7 offset:26624
v_mfma_f32_16x16x32_bf16 v[136:139], a[224:227], a[8:11], v[136:139]
ds_write_b64 v81, v[20:21] offset:7168
v_mfma_f32_16x16x32_bf16 v[140:143], a[228:231], a[8:11], v[140:143]
v_cvt_pk_bf16_f32 v22, v164, v165
v_cvt_pk_bf16_f32 v23, v166, v167
v_mfma_f32_16x16x32_bf16 v[248:251], a[232:235], a[8:11], v[248:251]
ds_write_b64 v82, v[22:23] offset:7168
v_mfma_f32_16x16x32_bf16 v[252:255], a[236:239], a[8:11], v[252:255]
ds_read_b128 a[8:11], v7 offset:40960
s_waitcnt lgkmcnt(12)
v_mfma_f32_16x16x32_bf16 v[136:139], a[240:243], a[12:15], v[136:139]
s_waitcnt lgkmcnt(9)
buffer_store_dwordx4 v[48:51], v11, s[28:31], s20 offen sc1 nt
v_mfma_f32_16x16x32_bf16 v[140:143], a[244:247], a[12:15], v[140:143]
ds_read_b128 v[56:59], v83 offset:7168
v_mfma_f32_16x16x32_bf16 v[248:251], a[96:99], a[12:15], v[248:251]
v_mfma_f32_16x16x32_bf16 v[252:255], a[100:103], a[12:15], v[252:255]
ds_read_b128 a[12:15], v7 offset:55296
v_mfma_f32_16x16x32_bf16 v[136:139], a[104:107], a[16:19], v[136:139]
v_mfma_f32_16x16x32_bf16 v[140:143], a[108:111], a[16:19], v[140:143]
v_mfma_f32_16x16x32_bf16 v[248:251], a[112:115], a[16:19], v[248:251]
v_mfma_f32_16x16x32_bf16 v[252:255], a[116:119], a[16:19], v[252:255]
ds_read_b128 a[16:19], v15 offset:12288
v_mfma_f32_16x16x32_bf16 v[136:139], a[120:123], a[20:23], v[136:139]
s_waitcnt lgkmcnt(7)
s_nop 0
buffer_store_dwordx4 v[52:55], v11, s[28:31], s15 offen sc1 nt
v_mfma_f32_16x16x32_bf16 v[140:143], a[124:127], a[20:23], v[140:143]
v_mfma_f32_16x16x32_bf16 v[248:251], a[128:131], a[20:23], v[248:251]
v_mfma_f32_16x16x32_bf16 v[252:255], a[132:135], a[20:23], v[252:255]
ds_read_b128 a[20:23], v15 offset:26624
v_mfma_f32_16x16x32_bf16 v[136:139], a[136:139], a[24:27], v[136:139]
v_mfma_f32_16x16x32_bf16 v[140:143], a[140:143], a[24:27], v[140:143]
v_mfma_f32_16x16x32_bf16 v[248:251], a[32:35], a[24:27], v[248:251]
v_mfma_f32_16x16x32_bf16 v[252:255], a[36:39], a[24:27], v[252:255]
ds_read_b128 a[24:27], v15 offset:40960
v_mfma_f32_16x16x32_bf16 v[136:139], a[48:51], a[28:31], v[136:139]
s_waitcnt lgkmcnt(4)
s_nop 0
buffer_store_dwordx4 v[56:59], v11, s[28:31], s13 offen sc1 nt
v_mfma_f32_16x16x32_bf16 v[140:143], a[52:55], a[28:31], v[140:143]
v_mfma_f32_16x16x32_bf16 v[248:251], a[56:59], a[28:31], v[248:251]
v_mfma_f32_16x16x32_bf16 v[252:255], a[60:63], a[28:31], v[252:255]
ds_read_b128 a[28:31], v15 offset:55296
v_mfma_f32_16x16x32_bf16 v[184:187], a[192:195], a[0:3], v[184:187]
v_mfma_f32_16x16x32_bf16 v[188:191], a[196:199], a[0:3], v[188:191]
ds_read_b128 a[0:3], v7 offset:13312
s_waitcnt lgkmcnt(5)
s_nop 0
v_mfma_f32_16x16x32_bf16 v[184:187], a[208:211], a[4:7], v[184:187]
v_mfma_f32_16x16x32_bf16 v[188:191], a[212:215], a[4:7], v[188:191]
ds_read_b128 a[4:7], v7 offset:27648
v_cvt_pk_bf16_f32 v24, v136, v137
v_mfma_f32_16x16x32_bf16 v[184:187], a[224:227], a[8:11], v[184:187]
v_cvt_pk_bf16_f32 v25, v138, v139
v_mfma_f32_16x16x32_bf16 v[188:191], a[228:231], a[8:11], v[188:191]
ds_read_b128 a[8:11], v7 offset:41984
v_mfma_f32_16x16x32_bf16 v[184:187], a[240:243], a[12:15], v[184:187]
ds_write_b64 v81, v[24:25] offset:8192
v_mfma_f32_16x16x32_bf16 v[188:191], a[244:247], a[12:15], v[188:191]
ds_read_b128 a[12:15], v7 offset:56320
s_waitcnt lgkmcnt(6)
s_nop 0
v_mfma_f32_16x16x32_bf16 v[184:187], a[104:107], a[16:19], v[184:187]
v_cvt_pk_bf16_f32 v26, v140, v141
v_cvt_pk_bf16_f32 v27, v142, v143
v_mfma_f32_16x16x32_bf16 v[188:191], a[108:111], a[16:19], v[188:191]
ds_read_b128 a[16:19], v15 offset:13312
v_mfma_f32_16x16x32_bf16 v[184:187], a[120:123], a[20:23], v[184:187]
ds_write_b64 v82, v[26:27] offset:8192
v_mfma_f32_16x16x32_bf16 v[188:191], a[124:127], a[20:23], v[188:191]
ds_read_b128 a[20:23], v15 offset:27648
ds_read_b128 v[60:63], v83 offset:8192
v_mfma_f32_16x16x32_bf16 v[184:187], a[136:139], a[24:27], v[184:187]
v_cvt_pk_bf16_f32 v16, v248, v249
v_cvt_pk_bf16_f32 v17, v250, v251
v_mfma_f32_16x16x32_bf16 v[188:191], a[140:143], a[24:27], v[188:191]
ds_read_b128 a[24:27], v15 offset:41984
s_waitcnt lgkmcnt(8)
s_nop 0
v_mfma_f32_16x16x32_bf16 v[184:187], a[48:51], a[28:31], v[184:187]
ds_write_b64 v81, v[16:17] offset:0
v_mfma_f32_16x16x32_bf16 v[188:191], a[52:55], a[28:31], v[188:191]
ds_read_b128 a[28:31], v15 offset:56320
v_cvt_pk_bf16_f32 v18, v252, v253
v_mfma_f32_16x16x32_bf16 v[192:195], a[192:195], a[0:3], v[192:195]
v_cvt_pk_bf16_f32 v19, v254, v255
v_mfma_f32_16x16x32_bf16 v[196:199], a[196:199], a[0:3], v[196:199]
ds_write_b64 v82, v[18:19] offset:0
v_mfma_f32_16x16x32_bf16 v[192:195], a[208:211], a[4:7], v[192:195]
ds_read_b128 v[28:31], v83 offset:0
v_mfma_f32_16x16x32_bf16 v[196:199], a[212:215], a[4:7], v[196:199]
v_cvt_pk_bf16_f32 v20, v184, v185
s_waitcnt lgkmcnt(8)
v_mfma_f32_16x16x32_bf16 v[192:195], a[224:227], a[8:11], v[192:195]
s_waitcnt lgkmcnt(5)
buffer_store_dwordx4 v[60:63], v11, s[28:31], s10 offen sc1 nt
v_mfma_f32_16x16x32_bf16 v[196:199], a[228:231], a[8:11], v[196:199]
v_cvt_pk_bf16_f32 v21, v186, v187
v_mfma_f32_16x16x32_bf16 v[192:195], a[240:243], a[12:15], v[192:195]
ds_write_b64 v81, v[20:21] offset:1024
v_mfma_f32_16x16x32_bf16 v[196:199], a[244:247], a[12:15], v[196:199]
v_cvt_pk_bf16_f32 v22, v188, v189
v_cvt_pk_bf16_f32 v23, v190, v191
v_mfma_f32_16x16x32_bf16 v[192:195], a[104:107], a[16:19], v[192:195]
ds_write_b64 v82, v[22:23] offset:1024
v_mfma_f32_16x16x32_bf16 v[196:199], a[108:111], a[16:19], v[196:199]
ds_read_b128 v[32:35], v83 offset:1024
s_waitcnt lgkmcnt(5)
v_mfma_f32_16x16x32_bf16 v[192:195], a[120:123], a[20:23], v[192:195]
s_waitcnt lgkmcnt(3)
buffer_store_dwordx4 v[28:31], v11, s[28:31], s60 offen sc1 nt
v_mfma_f32_16x16x32_bf16 v[196:199], a[124:127], a[20:23], v[196:199]
v_mfma_f32_16x16x32_bf16 v[192:195], a[136:139], a[24:27], v[192:195]
v_mfma_f32_16x16x32_bf16 v[196:199], a[140:143], a[24:27], v[196:199]
v_mfma_f32_16x16x32_bf16 v[192:195], a[48:51], a[28:31], v[192:195]
v_mfma_f32_16x16x32_bf16 v[196:199], a[52:55], a[28:31], v[196:199]
s_waitcnt lgkmcnt(0)
buffer_store_dwordx4 v[32:35], v11, s[28:31], s16 offen sc1 nt
s_nop 4
v_cvt_pk_bf16_f32 v24, v192, v193
v_cvt_pk_bf16_f32 v25, v194, v195
ds_write_b64 v81, v[24:25] offset:2048
v_cvt_pk_bf16_f32 v26, v196, v197
v_cvt_pk_bf16_f32 v27, v198, v199
ds_write_b64 v82, v[26:27] offset:2048
ds_read_b128 v[36:39], v83 offset:2048
s_waitcnt lgkmcnt(0)
buffer_store_dwordx4 v[36:39], v11, s[28:31], s17 offen sc1 nt
s_endpgm
L_c1_cold:
s_mov_b32 s51, 20000
L_c1_loop:
buffer_load_dword v28, off, s[36:39], 0 offset:0 sc1
s_waitcnt vmcnt(0)
v_readfirstlane_b32 s50, v28
s_sub_u32 s51, s51, 1
s_cmp_ge_u32 s50, 26
s_cbranch_scc1 L_c1_done
s_cmp_lg_u32 s51, 0
s_cbranch_scc1 L_c1_loop
s_branch L_c1_done
L_c2_cold:
s_mov_b32 s51, 20000
L_c2_loop:
buffer_load_dword v12, off, s[36:39], 0 offset:128 sc1
s_waitcnt vmcnt(0)
v_readfirstlane_b32 s50, v12
s_sub_u32 s51, s51, 1
s_cmp_ge_u32 s50, 6
s_cbranch_scc1 L_c2_done
s_cmp_lg_u32 s51, 0
s_cbranch_scc1 L_c2_loop
s_branch L_c2_done
LM_pre_cold:
buffer_load_dword v12, off, s[32:35], s101 sc1
s_branch LM_pre
LM_c1_cold:
s_waitcnt vmcnt(6)
v_readfirstlane_b32 s61, v12
s_nop 0
s_cmp_lg_u32 s61, 0
s_cbranch_scc1 LM_c1_open
buffer_load_dword v12, off, s[32:35], s101 sc1
s_branch LM_c1_done
LM_c1_open:
s_lshl_b32 s100, s3, 10
s_add_u32 s100, s100, 590848
s_waitcnt vmcnt(1)
s_nop 0
buffer_load_dwordx4 v[48:51], v3, s[32:35], s100 offen sc1
s_add_u32 s100, s100, 4096
buffer_load_dwordx4 v[52:55], v3, s[32:35], s100 offen sc1
s_add_u32 s100, s100, 4096
buffer_load_dwordx4 v[56:59], v3, s[32:35], s100 offen sc1
s_add_u32 s100, s100, 4096
buffer_load_dwordx4 v[60:63], v3, s[32:35], s100 offen sc1
s_branch LM_c1_done
LM_c2_cold:
s_mov_b32 s51, 20000
s_waitcnt vmcnt(0)
LM_c2_loop:
v_readfirstlane_b32 s61, v12
s_nop 0
s_cmp_lg_u32 s61, 0
s_cbranch_scc1 LM_c2_open
buffer_load_dword v12, off, s[32:35], s101 sc1
s_waitcnt vmcnt(0)
s_sub_u32 s51, s51, 1
s_cmp_lg_u32 s51, 0
s_cbranch_scc1 LM_c2_loop
LM_c2_open:
s_lshl_b32 s100, s3, 10
s_nop 0
s_add_u32 s100, s100, 590848
buffer_load_dwordx4 v[48:51], v3, s[32:35], s100 offen sc1
s_add_u32 s100, s100, 4096
buffer_load_dwordx4 v[52:55], v3, s[32:35], s100 offen sc1
s_add_u32 s100, s100, 4096
buffer_load_dwordx4 v[56:59], v3, s[32:35], s100 offen sc1
s_add_u32 s100, s100, 4096
buffer_load_dwordx4 v[60:63], v3, s[32:35], s100 offen sc1
s_branch LM_c2_done
LM_scold:
s_mov_b32 s51, 20000
s_mov_b32 exec_lo, 0
LM_sloop:
s_lshl_b32 s100, s3, 10
s_nop 0
s_add_u32 s100, s100, 590848
buffer_load_dwordx4 v[48:51], v3, s[32:35], s100 offen sc1
s_add_u32 s100, s100, 4096
buffer_load_dwordx4 v[52:55], v3, s[32:35], s100 offen sc1
s_add_u32 s100, s100, 4096
buffer_load_dwordx4 v[56:59], v3, s[32:35], s100 offen sc1
s_add_u32 s100, s100, 4096
buffer_load_dwordx4 v[60:63], v3, s[32:35], s100 offen sc1
s_waitcnt vmcnt(2)
v_pk_add_f32 v[48:49], v[48:49], v[52:53]
v_pk_add_f32 v[50:51], v[50:51], v[54:55]
s_waitcnt vmcnt(0)
v_pk_add_f32 v[56:57], v[56:57], v[60:61]
v_pk_add_f32 v[58:59], v[58:59], v[62:63]
v_pk_add_f32 v[48:49], v[48:49], v[56:57]
v_pk_add_f32 v[50:51], v[50:51], v[58:59]
v_cmp_eq_f32 vcc, 0x43600000, v48
s_nop 0
s_cmp_eq_u32 vcc_hi, -1
s_cselect_b32 s51, 1, s51
s_sub_u32 s51, s51, 1
s_cmp_lg_u32 s51, 0
s_cbranch_scc1 LM_sloop
s_mov_b64 exec, -1
s_branch LM_sok
L_wc4:
s_mov_b32 s51, 20000
s_mov_b32 s50, 663552
L_wl4:
buffer_load_dwordx4 v[64:67], v9, s[32:35], s50 offen offset:0 sc1
buffer_load_dwordx4 v[68:71], v9, s[32:35], s50 offen offset:1024 sc1
buffer_load_dwordx4 v[72:75], v10, s[32:35], s50 offen offset:0 sc1
buffer_load_dwordx4 v[76:79], v10, s[32:35], s50 offen offset:1024 sc1
s_waitcnt vmcnt(0)
v_max3_u32 v12, v64, v68, v72
v_max_u32 v12, v12, v76
v_cmp_eq_u32 vcc, -1, v12
s_cbranch_vccz L_w4
s_sub_u32 s51, s51, 1
s_cmp_lg_u32 s51, 0
s_cbranch_scc1 L_wl4
s_branch L_w4
L_wc5:
s_mov_b32 s51, 20000
s_mov_b32 s50, 663552
L_wl5:
buffer_load_dwordx4 v[16:19], v9, s[32:35], s50 offen offset:2048 sc1
buffer_load_dwordx4 v[20:23], v9, s[32:35], s50 offen offset:3072 sc1
buffer_load_dwordx4 v[24:27], v10, s[32:35], s50 offen offset:2048 sc1
buffer_load_dwordx4 v[28:31], v10, s[32:35], s50 offen offset:3072 sc1
s_waitcnt vmcnt(0)
v_max3_u32 v12, v16, v20, v24
v_max_u32 v12, v12, v28
v_cmp_eq_u32 vcc, -1, v12
s_cbranch_vccz L_w5
s_sub_u32 s51, s51, 1
s_cmp_lg_u32 s51, 0
s_cbranch_scc1 L_wl5
s_branch L_w5
L_c3_cold:
s_mov_b32 s51, 20000
L_c3_loop:
buffer_load_dword v12, off, s[36:39], 0 offset:192 sc1
s_waitcnt vmcnt(0)
v_readfirstlane_b32 s50, v12
s_sub_u32 s51, s51, 1
s_cmp_ge_u32 s50, 6
s_cbranch_scc1 L_c3_done
s_cmp_lg_u32 s51, 0
s_cbranch_scc1 L_c3_loop
s_branch L_c3_done
L_wc6:
s_mov_b32 s51, 20000
s_mov_b32 s50, 667648
L_wl6:
buffer_load_dwordx4 v[32:35], v9, s[32:35], s50 offen offset:0 sc1
buffer_load_dwordx4 v[36:39], v9, s[32:35], s50 offen offset:1024 sc1
buffer_load_dwordx4 v[40:43], v10, s[32:35], s50 offen offset:0 sc1
buffer_load_dwordx4 v[44:47], v10, s[32:35], s50 offen offset:1024 sc1
s_waitcnt vmcnt(0)
v_max3_u32 v12, v32, v36, v40
v_max_u32 v12, v12, v44
v_cmp_eq_u32 vcc, -1, v12
s_cbranch_vccz L_w6
s_sub_u32 s51, s51, 1
s_cmp_lg_u32 s51, 0
s_cbranch_scc1 L_wl6
s_branch L_w6
L_wc7:
s_mov_b32 s51, 20000
s_mov_b32 s50, 667648
L_wl7:
buffer_load_dwordx4 v[64:67], v9, s[32:35], s50 offen offset:2048 sc1
buffer_load_dwordx4 v[68:71], v9, s[32:35], s50 offen offset:3072 sc1
buffer_load_dwordx4 v[72:75], v10, s[32:35], s50 offen offset:2048 sc1
buffer_load_dwordx4 v[76:79], v10, s[32:35], s50 offen offset:3072 sc1
s_waitcnt vmcnt(0)
v_max3_u32 v12, v64, v68, v72
v_max_u32 v12, v12, v76
v_cmp_eq_u32 vcc, -1, v12
s_cbranch_vccz L_w7
s_sub_u32 s51, s51, 1
s_cmp_lg_u32 s51, 0
s_cbranch_scc1 L_wl7
s_branch L_w7
s_nop 0
L_help:
v_and_b32 v2, 31, v0
v_lshrrev_b32_e64 v3, 5, v0
s_waitcnt lgkmcnt(0)
s_mov_b32 s32, s20
s_and_b32 s33, s21, 0xffff
s_mov_b32 s34, 1048576
s_mov_b32 s35, 0x00020000
s_mov_b32 s36, s18
s_nop 0
s_and_b32 s37, s19, 0xffff
s_mov_b32 s38, 256
s_mov_b32 s39, 0x00020000
s_cmp_lt_u32 s2, 6
s_cbranch_scc1 L_hw2
s_mov_b32 s40, s8
s_nop 0
s_and_b32 s41, s9, 0xffff
s_mov_b32 s42, 294912
s_mov_b32 s43, 0x00020000
v_mul_u32_u24 v4, 12288, v3
v_lshl_add_u32 v4, v2, 1, v4
v_add_u32 v5, 3072, v4
v_add_u32 v6, 6144, v4
v_add_u32 v7, 9216, v4
s_sub_u32 s52, s2, 6
s_lshl_b32 s53, s52, 2
s_add_u32 s53, s53, s3
s_add_u32 s54, s53, 0
s_min_u32 s54, s54, 287
s_mul_i32 s55, s54, 5462
s_lshr_b32 s55, s55, 16
s_mul_i32 s56, s55, 12
s_sub_u32 s56, s54, s56
s_mul_i32 s57, s56, 24576
s_lshl_b32 s55, s55, 6
s_add_u32 s60, s57, s55
s_lshl_b32 s64, s54, 10
buffer_load_ushort v144, v4, s[40:43], s60 offen offset:0
buffer_load_ushort v145, v4, s[40:43], s60 offen offset:1536
buffer_load_ushort v146, v5, s[40:43], s60 offen offset:0
buffer_load_ushort v147, v5, s[40:43], s60 offen offset:1536
buffer_load_ushort v148, v6, s[40:43], s60 offen offset:0
buffer_load_ushort v149, v6, s[40:43], s60 offen offset:1536
buffer_load_ushort v150, v7, s[40:43], s60 offen offset:0
buffer_load_ushort v151, v7, s[40:43], s60 offen offset:1536
s_add_u32 s54, s53, 104
s_min_u32 s54, s54, 287
s_mul_i32 s55, s54, 5462
s_lshr_b32 s55, s55, 16
s_mul_i32 s56, s55, 12
s_sub_u32 s56, s54, s56
s_mul_i32 s57, s56, 24576
s_lshl_b32 s55, s55, 6
s_add_u32 s61, s57, s55
s_lshl_b32 s65, s54, 10
buffer_load_ushort v152, v4, s[40:43], s61 offen offset:0
buffer_load_ushort v153, v4, s[40:43], s61 offen offset:1536
buffer_load_ushort v154, v5, s[40:43], s61 offen offset:0
buffer_load_ushort v155, v5, s[40:43], s61 offen offset:1536
buffer_load_ushort v156, v6, s[40:43], s61 offen offset:0
buffer_load_ushort v157, v6, s[40:43], s61 offen offset:1536
buffer_load_ushort v158, v7, s[40:43], s61 offen offset:0
buffer_load_ushort v159, v7, s[40:43], s61 offen offset:1536
s_add_u32 s54, s53, 208
s_min_u32 s54, s54, 287
s_mul_i32 s55, s54, 5462
s_lshr_b32 s55, s55, 16
s_mul_i32 s56, s55, 12
s_sub_u32 s56, s54, s56
s_mul_i32 s57, s56, 24576
s_lshl_b32 s55, s55, 6
s_add_u32 s62, s57, s55
s_lshl_b32 s66, s54, 10
buffer_load_ushort v160, v4, s[40:43], s62 offen offset:0
buffer_load_ushort v161, v4, s[40:43], s62 offen offset:1536
buffer_load_ushort v162, v5, s[40:43], s62 offen offset:0
buffer_load_ushort v163, v5, s[40:43], s62 offen offset:1536
buffer_load_ushort v164, v6, s[40:43], s62 offen offset:0
buffer_load_ushort v165, v6, s[40:43], s62 offen offset:1536
buffer_load_ushort v166, v7, s[40:43], s62 offen offset:0
buffer_load_ushort v167, v7, s[40:43], s62 offen offset:1536
v_mov_b32 v16, 0
v_mov_b32 v17, 0
v_mov_b32 v18, 0
v_mov_b32 v19, 0
s_lshl_b32 s54, s52, 1
s_and_b32 s55, s3, 1
s_add_u32 s54, s54, s55
s_lshl_b32 s54, s54, 10
s_add_u32 s54, s54, 590848
buffer_store_dwordx4 v[16:19], v1, s[32:35], s54 offen sc1
s_waitcnt vmcnt(23)
v_lshl_or_b32 v32, v145, 16, v144
s_waitcnt vmcnt(21)
v_lshl_or_b32 v33, v147, 16, v146
s_waitcnt vmcnt(19)
v_lshl_or_b32 v34, v149, 16, v148
s_waitcnt vmcnt(17)
v_lshl_or_b32 v35, v151, 16, v150
buffer_store_dwordx4 v[32:35], v1, s[32:35], s64 offen sc1
s_waitcnt vmcnt(16)
v_lshl_or_b32 v36, v153, 16, v152
s_waitcnt vmcnt(14)
v_lshl_or_b32 v37, v155, 16, v154
s_waitcnt vmcnt(12)
v_lshl_or_b32 v38, v157, 16, v156
s_waitcnt vmcnt(10)
v_lshl_or_b32 v39, v159, 16, v158
buffer_store_dwordx4 v[36:39], v1, s[32:35], s65 offen sc1
s_waitcnt vmcnt(9)
v_lshl_or_b32 v40, v161, 16, v160
s_waitcnt vmcnt(7)
v_lshl_or_b32 v41, v163, 16, v162
s_waitcnt vmcnt(5)
v_lshl_or_b32 v42, v165, 16, v164
s_waitcnt vmcnt(3)
v_lshl_or_b32 v43, v167, 16, v166
buffer_store_dwordx4 v[40:43], v1, s[32:35], s66 offen sc1
s_mov_b32 s55, 0
s_nop 2
L_hfin:
s_waitcnt vmcnt(0) lgkmcnt(0)
s_barrier
s_cmp_lg_u32 s3, 0
s_cbranch_scc1 L_exit
s_mov_b64 exec, 1
v_mov_b32 v8, 1
buffer_atomic_add v8, off, s[36:39], s55 sc1
s_waitcnt vmcnt(0)
L_exit:
s_endpgm
s_nop 0
L_hw2:
s_mov_b32 s40, s10
s_and_b32 s41, s11, 0xffff
s_mov_b32 s42, 294912
s_mov_b32 s43, 0x00020000
s_mov_b32 s44, s14
s_nop 0
s_and_b32 s45, s15, 0xffff
s_mov_b32 s46, 1536
s_mov_b32 s47, 0x00020000
v_lshrrev_b32 v9, 4, v0
v_lshlrev_b32 v6, 4, v3
v_and_b32_e64 v4, 1, v9
v_lshl_add_u32 v6, v4, 2, v6
v_mul_u32_u24 v4, 384, v6
v_and_b32_e64 v5, 15, v0
v_lshl_add_u32 v4, v5, 1, v4
s_lshl_b32 s50, s2, 6
v_add_u32 v4, s50, v4
v_add_u32 v5, 3072, v4
v_lshlrev_b32 v6, 1, v6
s_lshl_b32 s52, s3, 1
s_mul_i32 s53, s2, 48
s_add_u32 s53, s53, s52
s_mul_i32 s52, s3, 6
s_add_u32 s55, s52, 0
s_mul_i32 s60, s55, 12288
s_lshl_b32 s72, s55, 6
s_nop 0
buffer_load_ushort v144, v4, s[40:43], s60 offen offset:0
buffer_load_ushort v145, v4, s[40:43], s60 offen offset:384
buffer_load_ushort v146, v4, s[40:43], s60 offen offset:768
buffer_load_ushort v147, v4, s[40:43], s60 offen offset:1152
buffer_load_ushort v148, v5, s[40:43], s60 offen offset:0
buffer_load_ushort v149, v5, s[40:43], s60 offen offset:384
buffer_load_ushort v150, v5, s[40:43], s60 offen offset:768
buffer_load_ushort v151, v5, s[40:43], s60 offen offset:1152
buffer_load_ushort v152, v4, s[40:43], s60 offen offset:32
buffer_load_ushort v153, v4, s[40:43], s60 offen offset:416
buffer_load_ushort v154, v4, s[40:43], s60 offen offset:800
buffer_load_ushort v155, v4, s[40:43], s60 offen offset:1184
buffer_load_ushort v156, v5, s[40:43], s60 offen offset:32
buffer_load_ushort v157, v5, s[40:43], s60 offen offset:416
buffer_load_ushort v158, v5, s[40:43], s60 offen offset:800
buffer_load_ushort v159, v5, s[40:43], s60 offen offset:1184
buffer_load_dwordx2 v[96:97], v6, s[44:47], s72 offen
buffer_load_dwordx2 v[98:99], v6, s[44:47], s72 offen offset:16
s_add_u32 s55, s52, 1
s_mul_i32 s61, s55, 12288
s_lshl_b32 s73, s55, 6
buffer_load_ushort v160, v4, s[40:43], s61 offen offset:0
buffer_load_ushort v161, v4, s[40:43], s61 offen offset:384
buffer_load_ushort v162, v4, s[40:43], s61 offen offset:768
buffer_load_ushort v163, v4, s[40:43], s61 offen offset:1152
buffer_load_ushort v164, v5, s[40:43], s61 offen offset:0
buffer_load_ushort v165, v5, s[40:43], s61 offen offset:384
buffer_load_ushort v166, v5, s[40:43], s61 offen offset:768
buffer_load_ushort v167, v5, s[40:43], s61 offen offset:1152
buffer_load_ushort v168, v4, s[40:43], s61 offen offset:32
buffer_load_ushort v169, v4, s[40:43], s61 offen offset:416
buffer_load_ushort v170, v4, s[40:43], s61 offen offset:800
buffer_load_ushort v171, v4, s[40:43], s61 offen offset:1184
buffer_load_ushort v172, v5, s[40:43], s61 offen offset:32
buffer_load_ushort v173, v5, s[40:43], s61 offen offset:416
buffer_load_ushort v174, v5, s[40:43], s61 offen offset:800
buffer_load_ushort v175, v5, s[40:43], s61 offen offset:1184
buffer_load_dwordx2 v[100:101], v6, s[44:47], s73 offen
buffer_load_dwordx2 v[102:103], v6, s[44:47], s73 offen offset:16
s_waitcnt vmcnt(34)
v_lshl_or_b32 v32, v145, 16, v144
s_waitcnt vmcnt(32)
v_lshl_or_b32 v33, v147, 16, v146
s_waitcnt vmcnt(30)
v_lshl_or_b32 v34, v149, 16, v148
s_waitcnt vmcnt(28)
v_lshl_or_b32 v35, v151, 16, v150
s_add_u32 s54, s53, 0
s_lshl_b32 s54, s54, 10
s_add_u32 s54, s54, 294912
buffer_store_dwordx4 v[32:35], v1, s[32:35], s54 offen sc1
s_waitcnt vmcnt(19)
s_nop 0
v_mfma_f32_16x16x32_bf16 v[16:19], v[32:35], v[96:99], 0
v_lshl_or_b32 v36, v153, 16, v152
v_lshl_or_b32 v37, v155, 16, v154
v_lshl_or_b32 v38, v157, 16, v156
v_lshl_or_b32 v39, v159, 16, v158
s_add_u32 s54, s53, 1
s_lshl_b32 s54, s54, 10
s_add_u32 s54, s54, 294912
buffer_store_dwordx4 v[36:39], v1, s[32:35], s54 offen sc1
v_mfma_f32_16x16x32_bf16 v[20:23], v[36:39], v[96:99], 0
s_waitcnt vmcnt(18)
v_lshl_or_b32 v40, v161, 16, v160
s_waitcnt vmcnt(16)
v_lshl_or_b32 v41, v163, 16, v162
s_waitcnt vmcnt(14)
v_lshl_or_b32 v42, v165, 16, v164
s_waitcnt vmcnt(12)
v_lshl_or_b32 v43, v167, 16, v166
s_add_u32 s54, s53, 8
s_lshl_b32 s54, s54, 10
s_add_u32 s54, s54, 294912
buffer_store_dwordx4 v[40:43], v1, s[32:35], s54 offen sc1
s_waitcnt vmcnt(3)
s_nop 0
v_mfma_f32_16x16x32_bf16 v[16:19], v[40:43], v[100:103], v[16:19]
v_lshl_or_b32 v44, v169, 16, v168
v_lshl_or_b32 v45, v171, 16, v170
v_lshl_or_b32 v46, v173, 16, v172
v_lshl_or_b32 v47, v175, 16, v174
s_add_u32 s54, s53, 9
s_lshl_b32 s54, s54, 10
s_add_u32 s54, s54, 294912
buffer_store_dwordx4 v[44:47], v1, s[32:35], s54 offen sc1
v_mfma_f32_16x16x32_bf16 v[20:23], v[44:47], v[100:103], v[20:23]
s_add_u32 s55, s52, 2
s_mul_i32 s62, s55, 12288
s_lshl_b32 s74, s55, 6
buffer_load_ushort v144, v4, s[40:43], s62 offen offset:0
buffer_load_ushort v145, v4, s[40:43], s62 offen offset:384
buffer_load_ushort v146, v4, s[40:43], s62 offen offset:768
buffer_load_ushort v147, v4, s[40:43], s62 offen offset:1152
buffer_load_ushort v148, v5, s[40:43], s62 offen offset:0
buffer_load_ushort v149, v5, s[40:43], s62 offen offset:384
buffer_load_ushort v150, v5, s[40:43], s62 offen offset:768
buffer_load_ushort v151, v5, s[40:43], s62 offen offset:1152
buffer_load_ushort v152, v4, s[40:43], s62 offen offset:32
buffer_load_ushort v153, v4, s[40:43], s62 offen offset:416
buffer_load_ushort v154, v4, s[40:43], s62 offen offset:800
buffer_load_ushort v155, v4, s[40:43], s62 offen offset:1184
buffer_load_ushort v156, v5, s[40:43], s62 offen offset:32
buffer_load_ushort v157, v5, s[40:43], s62 offen offset:416
buffer_load_ushort v158, v5, s[40:43], s62 offen offset:800
buffer_load_ushort v159, v5, s[40:43], s62 offen offset:1184
buffer_load_dwordx2 v[104:105], v6, s[44:47], s74 offen
buffer_load_dwordx2 v[106:107], v6, s[44:47], s74 offen offset:16
s_add_u32 s55, s52, 3
s_mul_i32 s63, s55, 12288
s_lshl_b32 s75, s55, 6
buffer_load_ushort v160, v4, s[40:43], s63 offen offset:0
buffer_load_ushort v161, v4, s[40:43], s63 offen offset:384
buffer_load_ushort v162, v4, s[40:43], s63 offen offset:768
buffer_load_ushort v163, v4, s[40:43], s63 offen offset:1152
buffer_load_ushort v164, v5, s[40:43], s63 offen offset:0
buffer_load_ushort v165, v5, s[40:43], s63 offen offset:384
buffer_load_ushort v166, v5, s[40:43], s63 offen offset:768
buffer_load_ushort v167, v5, s[40:43], s63 offen offset:1152
buffer_load_ushort v168, v4, s[40:43], s63 offen offset:32
buffer_load_ushort v169, v4, s[40:43], s63 offen offset:416
buffer_load_ushort v170, v4, s[40:43], s63 offen offset:800
buffer_load_ushort v171, v4, s[40:43], s63 offen offset:1184
buffer_load_ushort v172, v5, s[40:43], s63 offen offset:32
buffer_load_ushort v173, v5, s[40:43], s63 offen offset:416
buffer_load_ushort v174, v5, s[40:43], s63 offen offset:800
buffer_load_ushort v175, v5, s[40:43], s63 offen offset:1184
buffer_load_dwordx2 v[108:109], v6, s[44:47], s75 offen
buffer_load_dwordx2 v[110:111], v6, s[44:47], s75 offen offset:16
s_waitcnt vmcnt(34)
v_lshl_or_b32 v48, v145, 16, v144
s_waitcnt vmcnt(32)
v_lshl_or_b32 v49, v147, 16, v146
s_waitcnt vmcnt(30)
v_lshl_or_b32 v50, v149, 16, v148
s_waitcnt vmcnt(28)
v_lshl_or_b32 v51, v151, 16, v150
s_add_u32 s54, s53, 16
s_lshl_b32 s54, s54, 10
s_add_u32 s54, s54, 294912
buffer_store_dwordx4 v[48:51], v1, s[32:35], s54 offen sc1
s_waitcnt vmcnt(19)
s_nop 0
v_mfma_f32_16x16x32_bf16 v[16:19], v[48:51], v[104:107], v[16:19]
v_lshl_or_b32 v52, v153, 16, v152
v_lshl_or_b32 v53, v155, 16, v154
v_lshl_or_b32 v54, v157, 16, v156
v_lshl_or_b32 v55, v159, 16, v158
s_add_u32 s54, s53, 17
s_lshl_b32 s54, s54, 10
s_add_u32 s54, s54, 294912
buffer_store_dwordx4 v[52:55], v1, s[32:35], s54 offen sc1
v_mfma_f32_16x16x32_bf16 v[20:23], v[52:55], v[104:107], v[20:23]
s_waitcnt vmcnt(18)
v_lshl_or_b32 v56, v161, 16, v160
s_waitcnt vmcnt(16)
v_lshl_or_b32 v57, v163, 16, v162
s_waitcnt vmcnt(14)
v_lshl_or_b32 v58, v165, 16, v164
s_waitcnt vmcnt(12)
v_lshl_or_b32 v59, v167, 16, v166
s_add_u32 s54, s53, 24
s_lshl_b32 s54, s54, 10
s_add_u32 s54, s54, 294912
buffer_store_dwordx4 v[56:59], v1, s[32:35], s54 offen sc1
s_waitcnt vmcnt(3)
s_nop 0
v_mfma_f32_16x16x32_bf16 v[16:19], v[56:59], v[108:111], v[16:19]
v_lshl_or_b32 v60, v169, 16, v168
v_lshl_or_b32 v61, v171, 16, v170
v_lshl_or_b32 v62, v173, 16, v172
v_lshl_or_b32 v63, v175, 16, v174
s_add_u32 s54, s53, 25
s_lshl_b32 s54, s54, 10
s_add_u32 s54, s54, 294912
buffer_store_dwordx4 v[60:63], v1, s[32:35], s54 offen sc1
v_mfma_f32_16x16x32_bf16 v[20:23], v[60:63], v[108:111], v[20:23]
s_add_u32 s55, s52, 4
s_mul_i32 s64, s55, 12288
s_lshl_b32 s76, s55, 6
buffer_load_ushort v144, v4, s[40:43], s64 offen offset:0
buffer_load_ushort v145, v4, s[40:43], s64 offen offset:384
buffer_load_ushort v146, v4, s[40:43], s64 offen offset:768
buffer_load_ushort v147, v4, s[40:43], s64 offen offset:1152
buffer_load_ushort v148, v5, s[40:43], s64 offen offset:0
buffer_load_ushort v149, v5, s[40:43], s64 offen offset:384
buffer_load_ushort v150, v5, s[40:43], s64 offen offset:768
buffer_load_ushort v151, v5, s[40:43], s64 offen offset:1152
buffer_load_ushort v152, v4, s[40:43], s64 offen offset:32
buffer_load_ushort v153, v4, s[40:43], s64 offen offset:416
buffer_load_ushort v154, v4, s[40:43], s64 offen offset:800
buffer_load_ushort v155, v4, s[40:43], s64 offen offset:1184
buffer_load_ushort v156, v5, s[40:43], s64 offen offset:32
buffer_load_ushort v157, v5, s[40:43], s64 offen offset:416
buffer_load_ushort v158, v5, s[40:43], s64 offen offset:800
buffer_load_ushort v159, v5, s[40:43], s64 offen offset:1184
buffer_load_dwordx2 v[112:113], v6, s[44:47], s76 offen
buffer_load_dwordx2 v[114:115], v6, s[44:47], s76 offen offset:16
s_add_u32 s55, s52, 5
s_mul_i32 s65, s55, 12288
s_lshl_b32 s77, s55, 6
buffer_load_ushort v160, v4, s[40:43], s65 offen offset:0
buffer_load_ushort v161, v4, s[40:43], s65 offen offset:384
buffer_load_ushort v162, v4, s[40:43], s65 offen offset:768
buffer_load_ushort v163, v4, s[40:43], s65 offen offset:1152
buffer_load_ushort v164, v5, s[40:43], s65 offen offset:0
buffer_load_ushort v165, v5, s[40:43], s65 offen offset:384
buffer_load_ushort v166, v5, s[40:43], s65 offen offset:768
buffer_load_ushort v167, v5, s[40:43], s65 offen offset:1152
buffer_load_ushort v168, v4, s[40:43], s65 offen offset:32
buffer_load_ushort v169, v4, s[40:43], s65 offen offset:416
buffer_load_ushort v170, v4, s[40:43], s65 offen offset:800
buffer_load_ushort v171, v4, s[40:43], s65 offen offset:1184
buffer_load_ushort v172, v5, s[40:43], s65 offen offset:32
buffer_load_ushort v173, v5, s[40:43], s65 offen offset:416
buffer_load_ushort v174, v5, s[40:43], s65 offen offset:800
buffer_load_ushort v175, v5, s[40:43], s65 offen offset:1184
buffer_load_dwordx2 v[116:117], v6, s[44:47], s77 offen
buffer_load_dwordx2 v[118:119], v6, s[44:47], s77 offen offset:16
s_waitcnt vmcnt(34)
v_lshl_or_b32 v64, v145, 16, v144
s_waitcnt vmcnt(32)
v_lshl_or_b32 v65, v147, 16, v146
s_waitcnt vmcnt(30)
v_lshl_or_b32 v66, v149, 16, v148
s_waitcnt vmcnt(28)
v_lshl_or_b32 v67, v151, 16, v150
s_add_u32 s54, s53, 32
s_lshl_b32 s54, s54, 10
s_add_u32 s54, s54, 294912
buffer_store_dwordx4 v[64:67], v1, s[32:35], s54 offen sc1
s_waitcnt vmcnt(19)
s_nop 0
v_mfma_f32_16x16x32_bf16 v[16:19], v[64:67], v[112:115], v[16:19]
v_lshl_or_b32 v68, v153, 16, v152
v_lshl_or_b32 v69, v155, 16, v154
v_lshl_or_b32 v70, v157, 16, v156
v_lshl_or_b32 v71, v159, 16, v158
s_add_u32 s54, s53, 33
s_lshl_b32 s54, s54, 10
s_add_u32 s54, s54, 294912
buffer_store_dwordx4 v[68:71], v1, s[32:35], s54 offen sc1
v_mfma_f32_16x16x32_bf16 v[20:23], v[68:71], v[112:115], v[20:23]
s_waitcnt vmcnt(18)
v_lshl_or_b32 v72, v161, 16, v160
s_waitcnt vmcnt(16)
v_lshl_or_b32 v73, v163, 16, v162
s_waitcnt vmcnt(14)
v_lshl_or_b32 v74, v165, 16, v164
s_waitcnt vmcnt(12)
v_lshl_or_b32 v75, v167, 16, v166
s_add_u32 s54, s53, 40
s_lshl_b32 s54, s54, 10
s_add_u32 s54, s54, 294912
buffer_store_dwordx4 v[72:75], v1, s[32:35], s54 offen sc1
s_waitcnt vmcnt(3)
s_nop 0
v_mfma_f32_16x16x32_bf16 v[16:19], v[72:75], v[116:119], v[16:19]
v_lshl_or_b32 v76, v169, 16, v168
v_lshl_or_b32 v77, v171, 16, v170
v_lshl_or_b32 v78, v173, 16, v172
v_lshl_or_b32 v79, v175, 16, v174
s_add_u32 s54, s53, 41
s_lshl_b32 s54, s54, 10
s_add_u32 s54, s54, 294912
buffer_store_dwordx4 v[76:79], v1, s[32:35], s54 offen sc1
v_mfma_f32_16x16x32_bf16 v[20:23], v[76:79], v[116:119], v[20:23]
v_mov_b32 v144, -1
v_mov_b32 v145, -1
v_mov_b32 v146, -1
v_mov_b32_e64 v147, -1
s_lshl_b32 s54, s53, 10
s_add_u32 s54, s54, 663552
buffer_store_dwordx4 v[144:147], v1, s[32:35], s54 offen offset:0 sc1
buffer_store_dwordx4 v[144:147], v1, s[32:35], s54 offen offset:1024 sc1
v_lshlrev_b32 v7, 4, v9
s_lshl_b32 s54, s3, 7
v_add_u32_e64 v7, s54, v7
ds_write_b128 v7, v[16:19] offset:0
ds_write_b128 v7, v[20:23] offset:64
s_waitcnt lgkmcnt(0)
s_barrier
v_lshlrev_b32_e64 v7, 2, v2
ds_read_b32 v10, v7 offset:0
ds_read_b32 v11, v7 offset:128
ds_read_b32 v12, v7 offset:256
ds_read_b32 v13, v7 offset:384
s_waitcnt lgkmcnt(2)
v_add_f32 v10, v10, v11
s_waitcnt lgkmcnt(0)
v_add_f32 v12, v12, v13
v_add_f32 v8, v10, v12
s_lshl_b32 s54, s2, 7
s_add_u32 s54, s54, 589824
buffer_store_dword v8, v7, s[32:35], s54 offen sc1
s_waitcnt vmcnt(0) lgkmcnt(0)
s_barrier
s_cmp_eq_u32 s3, 0
s_cselect_b32 s55, 128, 0x40000000
s_mov_b64 exec, 2
buffer_atomic_add v0, off, s[36:39], s55 sc1
s_mov_b64 exec, -1
s_mov_b32 s84, s12
s_and_b32 s85, s13, 0xffff
s_mov_b32 s86, 1536
s_mov_b32 s87, 0x00020000
buffer_load_dword v8, off, s[36:39], 0 sc1
v_cmp_gt_u32_e64 s[88:89], 32, v0
v_mov_b32 v214, v1
v_and_b32 v215, 15, v0
v_lshlrev_b32_e64 v215, 7, v215
s_and_b32 s93, s2, 15
s_lshl_b32 s93, s93, 7
s_add_u32 s93, s93, 623744
s_mul_i32 s50, s3, 192
v_lshl_add_u32 v210, v0, 2, 2
v_lshlrev_b32 v211, 1, v0
v_add_u32 v211, 64, v211
v_min_u32 v210, v210, v211
v_add_u32 v210, s50, v210
v_cmp_gt_u32_e64 s[90:91], 64, v0
v_lshl_add_u32 v211, v210, 1, -4
buffer_load_dwordx2 v[208:209], v211, s[84:87], 0 offen
v_lshrrev_b32 v212, 1, v210
v_xor_b32 v212, v212, v210
v_and_b32 v212, 4, v212
v_mul_u32_u24 v212, 3, v212
v_xor_b32 v210, v210, v212
v_lshlrev_b32 v210, 2, v210
v_add_u32 v210, 151552, v210
v_mov_b32 v212, 155648
v_add_u32_e64 v213, -8, v210
v_cndmask_b32_e64 v210, v212, v210, s[90:91]
v_cndmask_b32_e64 v211, v212, v213, s[88:89]
v_lshlrev_b32_e64 v9, 5, v9
v_add_u32 v9, 156672, v9
s_lshl_b32 s54, s73, 1
v_add_u32 v17, s54, v9
s_add_u32 s54, s53, 8
s_lshl_b32 s54, s54, 10
s_add_u32 s65, s54, 655360
s_lshl_b32 s54, s74, 1
v_add_u32 v18, s54, v9
s_add_u32 s54, s53, 16
s_lshl_b32 s54, s54, 10
s_add_u32 s66, s54, 655360
s_lshl_b32 s54, s75, 1
v_add_u32 v19, s54, v9
s_add_u32 s54, s53, 24
s_lshl_b32 s54, s54, 10
s_add_u32 s67, s54, 655360
s_lshl_b32 s54, s76, 1
v_add_u32 v20, s54, v9
s_add_u32 s54, s53, 32
s_lshl_b32 s54, s54, 10
s_add_u32 s68, s54, 655360
s_lshl_b32 s54, s77, 1
v_add_u32 v21, s54, v9
s_add_u32 s54, s53, 40
s_lshl_b32 s54, s54, 10
s_add_u32 s69, s54, 655360
s_getpc_b64 s[80:81]
L_hpf:
s_nop 0
s_and_b32 s81, s81, 0xffff
s_mov_b32 s82, L_end-L_hpf
s_mov_b32 s83, 0x00020000
v_lshlrev_b32_e64 v22, 6, v0
buffer_load_dword v23, v22, s[80:83], 0 offen
s_waitcnt vmcnt(0)
v_readfirstlane_b32 s50, v8
s_nop 0
s_cmp_lt_u32 s50, 26
s_cbranch_scc1 L_h1_cold
L_h1_done:
buffer_load_dword v216, off, s[32:35], s93 sc1
s_branch LH_c0_cold
LH_c0_done:
v_lshlrev_b32_e64 v220, 16, v208
v_and_b32 v221, 0xffff0000, v208
v_lshlrev_b32_e64 v222, 16, v209
v_and_b32 v223, 0xffff0000, v209
s_waitcnt vmcnt(0)
s_nop 0
v_pk_add_f32 v[176:177], v[176:177], v[180:181]
v_pk_add_f32 v[178:179], v[178:179], v[182:183]
v_pk_add_f32 v[184:185], v[184:185], v[188:189]
v_pk_add_f32 v[186:187], v[186:187], v[190:191]
v_pk_add_f32 v[176:177], v[176:177], v[184:185]
v_pk_add_f32 v[178:179], v[178:179], v[186:187]
v_cmp_eq_f32 vcc, 0x43600000, v176
s_nop 0
s_cmp_eq_u32 vcc_hi, -1
s_cbranch_scc0 LH_scold
LH_sok:
s_nop 0
v_mov_b32 v180, 0x358637bd
v_fmamk_f32 v176, v176, 0x4091afa4, v180
v_fmamk_f32 v177, v177, 0x4091afa4, v180
v_fmamk_f32 v178, v178, 0x4091afa4, v180
v_fmamk_f32 v179, v179, 0x4091afa4, v180
v_sqrt_f32 v176, v176
v_sqrt_f32 v177, v177
v_sqrt_f32 v178, v178
v_sqrt_f32_e64 v179, v179
s_lshl_b32 s92, s3, 2
s_add_u32 s92, s92, 154624
v_add_f32 v180, v176, v177
v_add_f32 v181, v178, v179
v_cndmask_b32_e64 v180, 0, v180, s[88:89]
v_cndmask_b32_e64 v181, 0, v181, s[90:91]
v_add_f32 v180, v180, v181
v_mul_f32 v176, v176, v220
v_mul_f32_e64 v177, v177, v221
v_add_f32_dpp v180, v180, v180 row_ror:8 row_mask:0xf bank_mask:0xf
v_mul_f32 v178, v178, v222
v_mul_f32 v179, v179, v223
v_add_f32_dpp v180, v180, v180 row_ror:4 row_mask:0xf bank_mask:0xf
ds_write_b64 v211, v[176:177]
ds_write_b64 v210, v[178:179]
v_add_f32_dpp v180, v180, v180 row_ror:2 row_mask:0xf bank_mask:0xf
v_mov_b32_e64 v182, s92
v_mov_b32 v183, 154624
v_add_f32_dpp v180, v180, v180 row_ror:1 row_mask:0xf bank_mask:0xf
v_mov_b32 v181, v180
s_nop 1
v_permlane32_swap_b32 v180, v181
v_add_f32 v180, v180, v181
v_mov_b32 v181, v180
s_nop 1
v_permlane16_swap_b32 v180, v181
v_add_f32 v180, v180, v181
ds_write_b32 v182, v180
v_mov_b32 v180, 0x34fb9d56
v_mov_b32 v181, 0x40088e99
s_waitcnt lgkmcnt(0)
s_barrier
ds_read_b128 v[220:223], v183
s_waitcnt lgkmcnt(0)
v_add_f32 v220, v220, v221
v_add_f32 v222, v222, v223
v_add_f32 v220, v220, v222
v_fmac_f32 v180, 0x3a1ff8e5, v220
v_rcp_f32 v180, v180
s_nop 0
v_pk_fma_f32 v[176:177], v[176:177], v[180:181], v[180:181] op_sel:[0,0,1] op_sel_hi:[1,0,1]
v_pk_fma_f32 v[178:179], v[178:179], v[180:181], v[180:181] op_sel:[0,0,1] op_sel_hi:[1,0,1]
ds_write_b64 v211, v[176:177] offset:5120
ds_write_b64 v210, v[178:179] offset:5120
s_waitcnt lgkmcnt(0)
s_barrier
ds_read_b128 v[104:107], v17
ds_read_b128 v[108:111], v17 offset:16
ds_read_b128 v[112:115], v18
ds_read_b128 v[116:119], v18 offset:16
ds_read_b128 v[120:123], v19
ds_read_b128 v[124:127], v19 offset:16
ds_read_b128 v[128:131], v20
ds_read_b128 v[132:135], v20 offset:16
ds_read_b128 v[136:139], v21
ds_read_b128 v[140:143], v21 offset:16
v_lshlrev_b32 v208, 16, v40
v_lshlrev_b32 v209, 16, v41
v_lshlrev_b32 v210, 16, v42
v_lshlrev_b32 v211, 16, v43
v_and_b32 v40, 0xffff0000, v40
v_and_b32 v41, 0xffff0000, v41
v_and_b32 v42, 0xffff0000, v42
v_and_b32 v43, 0xffff0000, v43
s_waitcnt lgkmcnt(9)
v_mul_f32 v208, v104, v208
v_mul_f32 v40, v105, v40
v_mul_f32 v209, v106, v209
v_mul_f32 v41, v107, v41
s_waitcnt lgkmcnt(8)
v_mul_f32 v210, v108, v210
v_mul_f32 v42, v109, v42
v_mul_f32 v211, v110, v211
v_mul_f32 v43, v111, v43
v_cvt_pk_bf16_f32 v40, v208, v40
v_cvt_pk_bf16_f32 v41, v209, v41
v_cvt_pk_bf16_f32 v42, v210, v42
v_cvt_pk_bf16_f32 v43, v211, v43
v_min_u32_e64 v40, -2, v40
buffer_store_dwordx4 v[40:43], v1, s[32:35], s65 offen offset:0 sc1
v_lshlrev_b32 v212, 16, v44
v_lshlrev_b32 v213, 16, v45
v_lshlrev_b32 v214, 16, v46
v_lshlrev_b32 v215, 16, v47
v_and_b32 v44, 0xffff0000, v44
v_and_b32 v45, 0xffff0000, v45
v_and_b32 v46, 0xffff0000, v46
v_and_b32 v47, 0xffff0000, v47
v_mul_f32 v212, v104, v212
v_mul_f32 v44, v105, v44
v_mul_f32 v213, v106, v213
v_mul_f32 v45, v107, v45
v_mul_f32 v214, v108, v214
v_mul_f32 v46, v109, v46
v_mul_f32 v215, v110, v215
v_mul_f32 v47, v111, v47
v_cvt_pk_bf16_f32 v44, v212, v44
v_cvt_pk_bf16_f32 v45, v213, v45
v_cvt_pk_bf16_f32 v46, v214, v46
v_cvt_pk_bf16_f32 v47, v215, v47
v_min_u32_e64 v44, -2, v44
buffer_store_dwordx4 v[44:47], v1, s[32:35], s65 offen offset:1024 sc1
v_lshlrev_b32 v208, 16, v48
v_lshlrev_b32 v209, 16, v49
v_lshlrev_b32 v210, 16, v50
v_lshlrev_b32 v211, 16, v51
v_and_b32 v48, 0xffff0000, v48
v_and_b32 v49, 0xffff0000, v49
v_and_b32 v50, 0xffff0000, v50
v_and_b32 v51, 0xffff0000, v51
s_waitcnt lgkmcnt(7)
v_mul_f32 v208, v112, v208
v_mul_f32 v48, v113, v48
v_mul_f32 v209, v114, v209
v_mul_f32 v49, v115, v49
s_waitcnt lgkmcnt(6)
v_mul_f32 v210, v116, v210
v_mul_f32 v50, v117, v50
v_mul_f32 v211, v118, v211
v_mul_f32 v51, v119, v51
v_cvt_pk_bf16_f32 v48, v208, v48
v_cvt_pk_bf16_f32 v49, v209, v49
v_cvt_pk_bf16_f32 v50, v210, v50
v_cvt_pk_bf16_f32 v51, v211, v51
buffer_store_dwordx4 v[48:51], v1, s[32:35], s66 offen offset:0 sc1
v_lshlrev_b32 v212, 16, v52
v_lshlrev_b32 v213, 16, v53
v_lshlrev_b32 v214, 16, v54
v_lshlrev_b32 v215, 16, v55
v_and_b32 v52, 0xffff0000, v52
v_and_b32 v53, 0xffff0000, v53
v_and_b32 v54, 0xffff0000, v54
v_and_b32 v55, 0xffff0000, v55
v_mul_f32 v212, v112, v212
v_mul_f32 v52, v113, v52
v_mul_f32 v213, v114, v213
v_mul_f32 v53, v115, v53
v_mul_f32 v214, v116, v214
v_mul_f32 v54, v117, v54
v_mul_f32 v215, v118, v215
v_mul_f32 v55, v119, v55
v_cvt_pk_bf16_f32 v52, v212, v52
v_cvt_pk_bf16_f32 v53, v213, v53
v_cvt_pk_bf16_f32 v54, v214, v54
v_cvt_pk_bf16_f32 v55, v215, v55
buffer_store_dwordx4 v[52:55], v1, s[32:35], s66 offen offset:1024 sc1
v_lshlrev_b32 v208, 16, v56
v_lshlrev_b32 v209, 16, v57
v_lshlrev_b32 v210, 16, v58
v_lshlrev_b32 v211, 16, v59
v_and_b32 v56, 0xffff0000, v56
v_and_b32 v57, 0xffff0000, v57
v_and_b32 v58, 0xffff0000, v58
v_and_b32 v59, 0xffff0000, v59
s_waitcnt lgkmcnt(5)
v_mul_f32 v208, v120, v208
v_mul_f32 v56, v121, v56
v_mul_f32 v209, v122, v209
v_mul_f32 v57, v123, v57
s_waitcnt lgkmcnt(4)
v_mul_f32 v210, v124, v210
v_mul_f32 v58, v125, v58
v_mul_f32 v211, v126, v211
v_mul_f32 v59, v127, v59
v_cvt_pk_bf16_f32 v56, v208, v56
v_cvt_pk_bf16_f32 v57, v209, v57
v_cvt_pk_bf16_f32 v58, v210, v58
v_cvt_pk_bf16_f32 v59, v211, v59
buffer_store_dwordx4 v[56:59], v1, s[32:35], s67 offen offset:0 sc1
v_lshlrev_b32 v212, 16, v60
v_lshlrev_b32 v213, 16, v61
v_lshlrev_b32 v214, 16, v62
v_lshlrev_b32 v215, 16, v63
v_and_b32 v60, 0xffff0000, v60
v_and_b32 v61, 0xffff0000, v61
v_and_b32 v62, 0xffff0000, v62
v_and_b32 v63, 0xffff0000, v63
v_mul_f32 v212, v120, v212
v_mul_f32 v60, v121, v60
v_mul_f32 v213, v122, v213
v_mul_f32 v61, v123, v61
v_mul_f32 v214, v124, v214
v_mul_f32 v62, v125, v62
v_mul_f32 v215, v126, v215
v_mul_f32 v63, v127, v63
v_cvt_pk_bf16_f32 v60, v212, v60
v_cvt_pk_bf16_f32 v61, v213, v61
v_cvt_pk_bf16_f32 v62, v214, v62
v_cvt_pk_bf16_f32 v63, v215, v63
buffer_store_dwordx4 v[60:63], v1, s[32:35], s67 offen offset:1024 sc1
v_lshlrev_b32 v208, 16, v64
v_lshlrev_b32 v209, 16, v65
v_lshlrev_b32 v210, 16, v66
v_lshlrev_b32 v211, 16, v67
v_and_b32 v64, 0xffff0000, v64
v_and_b32 v65, 0xffff0000, v65
v_and_b32 v66, 0xffff0000, v66
v_and_b32 v67, 0xffff0000, v67
s_waitcnt lgkmcnt(3)
v_mul_f32 v208, v128, v208
v_mul_f32 v64, v129, v64
v_mul_f32 v209, v130, v209
v_mul_f32 v65, v131, v65
s_waitcnt lgkmcnt(2)
v_mul_f32 v210, v132, v210
v_mul_f32 v66, v133, v66
v_mul_f32 v211, v134, v211
v_mul_f32 v67, v135, v67
v_cvt_pk_bf16_f32 v64, v208, v64
v_cvt_pk_bf16_f32 v65, v209, v65
v_cvt_pk_bf16_f32 v66, v210, v66
v_cvt_pk_bf16_f32 v67, v211, v67
buffer_store_dwordx4 v[64:67], v1, s[32:35], s68 offen offset:0 sc1
v_lshlrev_b32 v212, 16, v68
v_lshlrev_b32 v213, 16, v69
v_lshlrev_b32 v214, 16, v70
v_lshlrev_b32 v215, 16, v71
v_and_b32 v68, 0xffff0000, v68
v_and_b32 v69, 0xffff0000, v69
v_and_b32 v70, 0xffff0000, v70
v_and_b32 v71, 0xffff0000, v71
v_mul_f32 v212, v128, v212
v_mul_f32 v68, v129, v68
v_mul_f32 v213, v130, v213
v_mul_f32 v69, v131, v69
v_mul_f32 v214, v132, v214
v_mul_f32 v70, v133, v70
v_mul_f32 v215, v134, v215
v_mul_f32 v71, v135, v71
v_cvt_pk_bf16_f32 v68, v212, v68
v_cvt_pk_bf16_f32 v69, v213, v69
v_cvt_pk_bf16_f32 v70, v214, v70
v_cvt_pk_bf16_f32 v71, v215, v71
buffer_store_dwordx4 v[68:71], v1, s[32:35], s68 offen offset:1024 sc1
v_lshlrev_b32 v208, 16, v72
v_lshlrev_b32 v209, 16, v73
v_lshlrev_b32 v210, 16, v74
v_lshlrev_b32 v211, 16, v75
v_and_b32 v72, 0xffff0000, v72
v_and_b32 v73, 0xffff0000, v73
v_and_b32 v74, 0xffff0000, v74
v_and_b32 v75, 0xffff0000, v75
s_waitcnt lgkmcnt(1)
v_mul_f32 v208, v136, v208
v_mul_f32 v72, v137, v72
v_mul_f32 v209, v138, v209
v_mul_f32 v73, v139, v73
s_waitcnt lgkmcnt(0)
v_mul_f32 v210, v140, v210
v_mul_f32 v74, v141, v74
v_mul_f32 v211, v142, v211
v_mul_f32 v75, v143, v75
v_cvt_pk_bf16_f32 v72, v208, v72
v_cvt_pk_bf16_f32 v73, v209, v73
v_cvt_pk_bf16_f32 v74, v210, v74
v_cvt_pk_bf16_f32 v75, v211, v75
buffer_store_dwordx4 v[72:75], v1, s[32:35], s69 offen offset:0 sc1
v_lshlrev_b32 v212, 16, v76
v_lshlrev_b32 v213, 16, v77
v_lshlrev_b32 v214, 16, v78
v_lshlrev_b32 v215, 16, v79
v_and_b32 v76, 0xffff0000, v76
v_and_b32 v77, 0xffff0000, v77
v_and_b32 v78, 0xffff0000, v78
v_and_b32 v79, 0xffff0000, v79
v_mul_f32 v212, v136, v212
v_mul_f32 v76, v137, v76
v_mul_f32 v213, v138, v213
v_mul_f32 v77, v139, v77
v_mul_f32 v214, v140, v214
v_mul_f32 v78, v141, v78
v_mul_f32 v215, v142, v215
v_mul_f32 v79, v143, v79
v_cvt_pk_bf16_f32 v76, v212, v76
v_cvt_pk_bf16_f32 v77, v213, v77
v_cvt_pk_bf16_f32 v78, v214, v78
v_cvt_pk_bf16_f32 v79, v215, v79
buffer_store_dwordx4 v[76:79], v1, s[32:35], s69 offen offset:1024 sc1
s_movk_i32 s55, 192
s_branch L_hfin
L_h1_cold:
s_mov_b32 s51, 20000
L_h1_loop:
buffer_load_dword v8, off, s[36:39], 0 offset:0 sc1
s_waitcnt vmcnt(0)
v_readfirstlane_b32 s50, v8
s_sub_u32 s51, s51, 1
s_cmp_ge_u32 s50, 26
s_cbranch_scc1 L_h1_done
s_cmp_lg_u32 s51, 0
s_cbranch_scc1 L_h1_loop
s_branch L_h1_done
LH_c0_cold:
s_mov_b32 s51, 20000
s_waitcnt vmcnt(0)
LH_c0_loop:
v_readfirstlane_b32 s61, v216
s_nop 0
s_cmp_lg_u32 s61, 0
s_cbranch_scc1 LH_c0_open
buffer_load_dword v216, off, s[32:35], s93 sc1
s_waitcnt vmcnt(0)
s_sub_u32 s51, s51, 1
s_cmp_lg_u32 s51, 0
s_cbranch_scc1 LH_c0_loop
LH_c0_open:
s_lshl_b32 s92, s3, 10
s_add_u32 s92, s92, 590848
buffer_load_dwordx4 v[176:179], v214, s[32:35], s92 offen sc1
s_add_u32 s92, s92, 4096
buffer_load_dwordx4 v[180:183], v214, s[32:35], s92 offen sc1
s_add_u32 s92, s92, 4096
buffer_load_dwordx4 v[184:187], v214, s[32:35], s92 offen sc1
s_add_u32 s92, s92, 4096
buffer_load_dwordx4 v[188:191], v214, s[32:35], s92 offen sc1
s_branch LH_c0_done
LH_scold:
s_mov_b32 s51, 20000
s_mov_b32 exec_lo, 0
LH_sloop:
s_lshl_b32 s92, s3, 10
s_nop 0
s_add_u32 s92, s92, 590848
buffer_load_dwordx4 v[176:179], v214, s[32:35], s92 offen sc1
s_add_u32 s92, s92, 4096
buffer_load_dwordx4 v[180:183], v214, s[32:35], s92 offen sc1
s_add_u32 s92, s92, 4096
buffer_load_dwordx4 v[184:187], v214, s[32:35], s92 offen sc1
s_add_u32 s92, s92, 4096
buffer_load_dwordx4 v[188:191], v214, s[32:35], s92 offen sc1
s_waitcnt vmcnt(2)
v_pk_add_f32 v[176:177], v[176:177], v[180:181]
v_pk_add_f32 v[178:179], v[178:179], v[182:183]
s_waitcnt vmcnt(0)
v_pk_add_f32 v[184:185], v[184:185], v[188:189]
v_pk_add_f32 v[186:187], v[186:187], v[190:191]
v_pk_add_f32 v[176:177], v[176:177], v[184:185]
v_pk_add_f32 v[178:179], v[178:179], v[186:187]
v_cmp_eq_f32 vcc, 0x43600000, v176
s_nop 0
s_cmp_eq_u32 vcc_hi, -1
s_cselect_b32 s51, 1, s51
s_sub_u32 s51, s51, 1
s_cmp_lg_u32 s51, 0
s_cbranch_scc1 LH_sloop
s_mov_b64 exec, -1
s_branch LH_sok
s_endpgm
L_end:
.section .rodata,"a"
.p2align 6
.amdhsa_kernel standalone__modern_conv_block_convnext_v2__vision_kernel
  .amdhsa_next_free_vgpr 512
  .amdhsa_next_free_sgpr 102
  .amdhsa_accum_offset 256
  .amdhsa_group_segment_fixed_size 0
  .amdhsa_kernarg_size 72
  .amdhsa_user_sgpr_count 2
  .amdhsa_user_sgpr_kernarg_segment_ptr 1
  .amdhsa_system_sgpr_workgroup_id_x 1
.end_amdhsa_kernel
```
